```python
import torch

def _softmax(x, axis=-1):
    return torch.softmax(x, dim=axis)

def _gelu(x):
    return torch.nn.functional.gelu(x, approximate='tanh')

def _silu(x):
    return torch.nn.functional.silu(x)

def _sigmoid(x):
    return torch.sigmoid(x)

def _layernorm(x, axis=-1, eps=1e-05):
    m = x.mean(dim=axis, keepdim=True)
    v = x.var(dim=axis, keepdim=True, unbiased=False)
    return (x - m) / torch.sqrt(v + eps)

def _scatter_add(tgt, idx, src, axis=0):
    return tgt.clone().index_add_(axis, idx, src)

def _segment_sum(src, seg, n):
    out = torch.zeros((n,) + src.shape[1:], dtype=src.dtype)
    return out.index_add_(0, seg, src)

def _pad(x, pw):
    flat = tuple((v for pair in reversed(pw) for v in pair))
    return torch.nn.functional.pad(x, flat)
kernel_name = 'adaLN_cond__linear_kernel_hedgehog__geglu_ffn__prompt'

def setup_inputs():

    _w = lambda a: (lambda t: t.to(torch.bfloat16) if t.is_floating_point() else t)(torch.as_tensor(a))

    def _A_setup():
        B, S, D, H = (1, 2048, 512, 32)
        Dh = D // H
        return {'x': _w((lambda *s: torch.randn(*s, dtype=torch.bfloat16) * 0.1)(B, S, D)), 'wqkv': _w((lambda *s: torch.randn(*s, dtype=torch.bfloat16) * 0.2)(D, 3 * D)), 'w_phi': _w((lambda *s: torch.randn(*s, dtype=torch.bfloat16) * 0.2)(H, Dh, Dh) * Dh ** (-0.5)), 'wo': _w((lambda *s: torch.randn(*s, dtype=torch.bfloat16) * 0.2)(D, D))}
    _A_in = _A_setup()

    def _B_setup():
        B, S, D, F = (1, 2048, 512, 1376)
        return {'x': _w((lambda *s: torch.randn(*s, dtype=torch.bfloat16) * 0.1)(B, S, D)), 'w_gate': _w((lambda *s: torch.randn(*s, dtype=torch.bfloat16) * 0.8)(D, F)), 'w_up': _w((lambda *s: torch.randn(*s, dtype=torch.bfloat16) * 0.8)(D, F)), 'w_down': _w((lambda *s: torch.randn(*s, dtype=torch.bfloat16) * 0.8)(F, D))}
    _B_in = _B_setup()
    return {'A_x': _A_in['x'], 'A_wqkv': _A_in['wqkv'], 'A_w_phi': _A_in['w_phi'], 'A_wo': _A_in['wo'], 'B_x': _B_in['x'], 'B_w_gate': _B_in['w_gate'], 'B_w_up': _B_in['w_up'], 'B_w_down': _B_in['w_down'], 'c': _w((lambda *s: torch.randn(*s, dtype=torch.bfloat16) * 0.4)(1, 512) * 8.0), 'w_mod': _w((lambda *s: torch.randn(*s, dtype=torch.bfloat16) * 0.4)(512, 6 * 512) * 512 ** (-0.5) * 8.0)}

def reference(A_x, A_wqkv, A_w_phi, A_wo, B_x, B_w_gate, B_w_up, B_w_down, c, w_mod):

    def _A_ref(x, wqkv, w_phi, wo):
        B, S, D = x.shape
        H = 32
        Dh = D // H
        qkv = (lambda x, *d: x.permute(*d))((x @ wqkv).reshape(B, S, 3, H, Dh), 2, 0, 3, 1, 4)
        q, k, v = (qkv[0], qkv[1], qkv[2])
        pq = torch.einsum('bhsd,hdf->bhsf', q, w_phi)
        pk = torch.einsum('bhsd,hdf->bhsf', k, w_phi)
        phi_q = torch.concatenate([_softmax(pq, axis=-1), _softmax(-pq, axis=-1)], axis=-1)
        phi_k = torch.concatenate([_softmax(pk, axis=-1), _softmax(-pk, axis=-1)], axis=-1)
        kv = torch.einsum('bhsf,bhsd->bhfd', phi_k, v)
        z = torch.einsum('bhsf->bhf', phi_k)
        num = torch.einsum('bhqf,bhfd->bhqd', phi_q, kv)
        den = torch.einsum('bhqf,bhf->bhq', phi_q, z)[..., None] + 1e-06
        o = num / den
        return (lambda x, *d: x.permute(*d))(o, 0, 2, 1, 3).reshape(B, S, D) @ wo

    def _B_ref(x, w_gate, w_up, w_down):
        return _gelu(x @ w_gate) * (x @ w_up) @ w_down
    x = A_x
    mod = (_silu(c) @ w_mod).reshape(c.shape[0], 6, 1, -1)
    sa, ca, ga, sb, cb, gb = (mod[:, 0].clone(), mod[:, 1].clone(), mod[:, 2].clone(), mod[:, 3].clone(), mod[:, 4].clone(), mod[:, 5].clone())
    h = _layernorm(x, axis=-1) * (1 + ca) + sa
    x = x + ga * _A_ref(h, A_wqkv, A_w_phi, A_wo)
    h = _layernorm(x, axis=-1) * (1 + cb) + sb
    x = x + gb * _B_ref(h, B_w_gate, B_w_up, B_w_down)
    return x
```

```asm
; @launch grid=(256,1,1) block=(256,1,1) lds=163840
.amdgcn_target "amdgcn-amd-amdhsa--gfx950"
.text
.globl adaLN_cond__linear_kernel_hedgehog__geglu_ffn__prompt_kernel
.p2align 8
.type adaLN_cond__linear_kernel_hedgehog__geglu_ffn__prompt_kernel,@function
adaLN_cond__linear_kernel_hedgehog__geglu_ffn__prompt_kernel:
    s_cmpk_ge_u32 s2, 256
    s_cbranch_scc1 END
    s_load_dwordx4 s[28:31], s[0:1], 64
    s_load_dwordx4 s[4:7], s[0:1], 0
    s_load_dwordx2 s[36:37], s[0:1], 96
    s_getpc_b64 s[56:57]
    s_and_b32 s58, s2, -8
    v_lshrrev_b32 v12, 5, v0
    v_add_lshl_u32 v12, v12, s58, 1
    v_mad_u64_u32 v[12:13], vcc, v12, 64, s[56:57]
    v_lshrrev_b32 v14, 6, v0
    global_load_dword v11, v[12:13], off
    v_readfirstlane_b32 s47, v14
    v_lshrrev_b32 v16, 3, v0
    v_and_b32 v15, 7, v0
    s_and_b32 s45, s2, 7
    s_lshr_b32 s46, s2, 3
    s_and_b32 s62, s2, 3
    s_and_b32 s56, s2, 4
    s_lshl3_add_u32 s61, s56, s46
    s_lshl_b32 s56, s62, 5
    v_add_u32 v17, s56, v16
    v_lshlrev_b32 v21, 3, v17
    v_mul_u32_u24 v17, 24576, v17
    s_lshl3_add_u32 s56, s61, 192
    v_add_lshl_u32 v18, v15, s56, 4
    v_add_u32 v20, v17, v18
    v_add_u32 v17, 12288, v20
    s_lshl_b32 s60, s45, 5
    s_add_u32 s60, s60, s46
    s_lshl_b32 s56, s60, 13
    v_lshl_add_u32 v12, v0, 4, s56
    v_add_u32 v13, 4096, v12
    s_mul_i32 s57, s47, 1056
    s_add_u32 m0, s57, 32768
    v_lshrrev_b32 v19, 2, v0
    v_min_u32 v18, 47, v19
    s_mul_i32 s57, s2, 48
    v_add_lshl_u32 v18, v18, s57, 7
    s_bitset1_b32 s56, 21
    v_lshl_add_u32 v19, v19, 7, s56
    s_cmp_ge_u32 s61, 48
    s_waitcnt lgkmcnt(0)
    s_load_dword s44, s[36:37], 0
    s_cbranch_scc1 A_NOJOB
    global_load_dwordx2 v[32:33], v21, s[28:29]
    global_load_dwordx4 v[64:67], v20, s[30:31] offset:-3072 nt
    global_load_dwordx4 v[68:71], v20, s[30:31] offset:3072 nt
    global_load_dwordx4 v[72:75], v17, s[30:31] offset:-3072 nt
    global_load_dwordx4 v[76:79], v17, s[30:31] offset:3072 nt
A_NOJOB:
    global_load_lds_dwordx4 v12, s[4:5] nt
    s_addk_i32 m0, 4224
    global_load_dword v11, v18, s[6:7]
    global_load_lds_dwordx4 v13, s[4:5] nt
B0END:
    s_load_dwordx2 s[42:43], s[0:1], 16
    s_load_dwordx2 s[12:13], s[0:1], 24
    s_load_dwordx2 s[16:17], s[0:1], 40
    s_load_dwordx2 s[20:21], s[0:1], 48
    s_load_dwordx2 s[24:25], s[0:1], 56
    s_load_dwordx2 s[32:33], s[0:1], 80
    s_mov_b64 s[8:9], s[6:7]
    s_mov_b32 s38, 9437184
    s_mov_b32 s39, 0x20000
    s_mov_b32 s10, 1572864
    s_mov_b32 s11, 0x20000
    v_and_b32 v1, 63, v0
    s_lshr_b32 s48, s46, 4
    s_and_b32 s49, s46, 15
    s_xor_b32 s49, s49, 3
    s_lshr_b32 s50, s46, 3
    s_and_b32 s51, s46, 7
    v_lshlrev_b32 v2, 4, v1
    v_lshlrev_b32 v22, 7, v1
    v_and_b32 v7, 31, v1
    v_lshrrev_b32 v8, 5, v1
    v_lshrrev_b32 v9, 4, v1
    v_and_b32 v10, 15, v1
    v_lshrrev_b32 v14, 3, v1
    v_lshrrev_b32 v12, 2, v1
    v_mul_u32_u24 v12, 3072, v12
    v_and_b32 v13, 3, v1
    v_lshl_add_u32 v31, v13, 4, v12
    s_mul_i32 s79, s47, 393216
    s_lshl_b32 s63, s49, 6
    s_add_u32 s79, s79, s63
    s_lshl_b32 s80, s47, 13
    s_cmp_eq_u32 s48, 0
    s_cselect_b32 s28, 0, 196608
    s_bitcmp0_b32 s49, 0
    s_cselect_b32 s63, 0, 1024
    s_add_u32 s28, s28, s63
    s_add_u32 s28, s28, s79
    s_cmp_eq_u32 s48, 0
    s_cselect_b32 s29, 0, 4294574080
    s_add_u32 s29, s29, 196608
    s_cmp_eq_u32 s48, 0
    s_cselect_b32 s30, 0, 393216
    s_bitcmp0_b32 s49, 0
    s_cselect_b32 s63, 0, 4294965248
    s_add_u32 s30, s30, s63
    s_add_u32 s30, s30, 4294771712
    s_cmp_eq_u32 s48, 0
    s_cselect_b32 s31, 0, 4096
    s_bitcmp0_b32 s49, 0
    s_cselect_b32 s63, 0, 32768
    s_add_u32 s31, s31, s63
    s_add_u32 s31, s31, s80
    s_xor_b32 m0, s31, 65536
    s_add_u32 s81, s28, 1024
    buffer_load_dwordx4 v31, s[8:11], s81 offen offset:0 lds
    v_and_b32 v12, 1, v1
    v_lshlrev_b32 v12, 4, v12
    v_mov_b32 v13, 0xffff
    v_lshlrev_b32 v12, v12, v13
    v_lshrrev_b32 v13, 1, v15
    v_cmp_eq_u32 vcc, 0, v13
    s_lshl_b32 s56, s47, 9
    s_add_u32 s56, s56, 43008
    v_cndmask_b32 v36, 0, v12, vcc
    v_cmp_eq_u32 vcc, 1, v13
    v_lshl_add_u32 v23, v8, 8, s56
    v_lshl_add_u32 v23, v15, 5, v23
    v_cndmask_b32 v37, 0, v12, vcc
    v_cmp_eq_u32 vcc, 2, v13
    v_and_b32 v17, 16, v1
    v_add_u32 v23, v23, v17
    v_cndmask_b32 v38, 0, v12, vcc
    v_cmp_eq_u32 vcc, 3, v13
    s_lshl_b32 s59, s61, 8
    s_mul_i32 s63, s62, 12288
    s_add_u32 s59, s59, s63
    s_add_u32 s59, s59, 131072
    v_cndmask_b32 v39, 0, v12, vcc
    s_getreg_b32 s67, hwreg(HW_REG_XCC_ID, 0, 4)
    s_lshl_b32 s56, s60, 7
    s_add_u32 s56, s56, 32768
    s_mov_b32 s14, 524288
    s_mov_b32 s15, 0x20000
    s_mov_b32 s18, 1409024
    s_mov_b32 s19, 0x20000
    s_mov_b32 s22, 1409024
    s_mov_b32 s23, 0x20000
    s_mov_b32 s26, 1409024
    s_mov_b32 s27, 0x20000
    s_mov_b32 s34, 2097152
    s_mov_b32 s35, 0x20000
    s_mov_b32 s54, 1409024
    s_mov_b32 s55, 0x20000
    v_mov_b32 v81, s67
    s_cmp_eq_u32 s47, 1
    s_cselect_b32 s56, s56, 0x7fff0000
    s_add_u32 s83, s56, 65536
    s_waitcnt lgkmcnt(0)
    s_add_u32 s44, s44, 0x9E3779B1
    v_mov_b32 v80, s44
    s_mov_b64 exec, 1
    buffer_store_dwordx2 v[80:81], off, s[36:39], s56 sc1
    s_mov_b64 exec, -1
    v_mov_b32 v3, s44
    s_bfe_u32 s0, s44, 0x80000
    s_bfe_u32 s1, s44, 0x80008
    s_bfe_u32 s40, s44, 0x80010
    s_bfe_u32 s41, s44, 0x80018
    s_bitcmp0_b32 s47, 0
    s_cselect_b64 s[52:53], s[16:17], s[20:21]
    s_cmp_ge_u32 s61, 48
    s_cbranch_scc1 A_NOJOB2
    s_waitcnt vmcnt(9)
    v_lshlrev_b32 v44, 16, v32
    v_and_b32 v45, 0xffff0000, v32
    v_lshlrev_b32 v46, 16, v33
    v_and_b32 v47, 0xffff0000, v33
    v_mul_f32 v48, 0xbfb8aa3b, v44
    v_mul_f32 v49, 0xbfb8aa3b, v45
    v_mul_f32 v50, 0xbfb8aa3b, v46
    v_mul_f32 v51, 0xbfb8aa3b, v47
    v_exp_f32 v48, v48
    v_exp_f32 v49, v49
    v_exp_f32 v50, v50
    v_exp_f32 v51, v51
    v_add_f32 v48, 1.0, v48
    v_add_f32 v49, 1.0, v49
    v_add_f32 v50, 1.0, v50
    v_add_f32 v51, 1.0, v51
    v_rcp_f32 v52, v48
    v_rcp_f32 v53, v49
    v_rcp_f32 v54, v50
    v_rcp_f32 v55, v51
    v_min_f32 v48, 0x7f000000, v48
    v_min_f32 v49, 0x7f000000, v49
    v_min_f32 v50, 0x7f000000, v50
    v_min_f32 v51, 0x7f000000, v51
    v_mul_f32 v96, v44, v52
    v_mul_f32 v97, v45, v53
    v_mul_f32 v98, v46, v54
    v_mul_f32 v99, v47, v55
    v_fma_f32 v44, -v96, v48, v44
    v_fma_f32 v45, -v97, v49, v45
    v_fma_f32 v46, -v98, v50, v46
    v_fma_f32 v47, -v99, v51, v47
    v_fma_f32 v44, v44, v52, v96
    v_fma_f32 v45, v45, v53, v97
    v_fma_f32 v46, v46, v54, v98
    v_fma_f32 v47, v47, v55, v99
    v_cvt_pk_bf16_f32 v44, v44, v44
    v_cvt_pk_bf16_f32 v45, v45, v45
    v_cvt_pk_bf16_f32 v46, v46, v46
    v_cvt_pk_bf16_f32 v47, v47, v47
    v_and_b32 v100, v44, v36
    v_and_b32 v101, v44, v37
    v_and_b32 v102, v44, v38
    v_and_b32 v103, v44, v39
    v_and_b32 v104, v45, v36
    v_and_b32 v105, v45, v37
    v_and_b32 v106, v45, v38
    v_and_b32 v107, v45, v39
    v_and_b32 v108, v46, v36
    v_and_b32 v109, v46, v37
    v_and_b32 v110, v46, v38
    v_and_b32 v111, v46, v39
    v_and_b32 v112, v47, v36
    v_and_b32 v113, v47, v37
    v_and_b32 v114, v47, v38
    v_and_b32 v115, v47, v39
    s_waitcnt vmcnt(8)
    v_mfma_f32_16x16x32_bf16 v[96:99], v[100:103], v[64:67], 0
    s_waitcnt vmcnt(7)
    v_mfma_f32_16x16x32_bf16 v[96:99], v[104:107], v[68:71], v[96:99]
    s_waitcnt vmcnt(6)
    v_mfma_f32_16x16x32_bf16 v[96:99], v[108:111], v[72:75], v[96:99]
    s_waitcnt vmcnt(5)
    v_mfma_f32_16x16x32_bf16 v[96:99], v[112:115], v[76:79], v[96:99]
    s_mov_b32 exec_lo, 0x00ff00ff
    s_mov_b32 exec_hi, 0xff00ff00
    s_nop 5
    ds_write_b128 v23, v[96:99]
    s_mov_b64 exec, -1
    s_cmp_eq_u32 s47, 0
    s_waitcnt lgkmcnt(0)
    s_barrier
    s_cbranch_scc0 A_NOJOB2
    s_mov_b64 exec, 0xffff
    ds_read_b128 v[96:99], v2 offset:43008
    ds_read_b128 v[100:103], v2 offset:43264
    ds_read_b128 v[104:107], v2 offset:43520
    ds_read_b128 v[108:111], v2 offset:43776
    ds_read_b128 v[112:115], v2 offset:44032
    ds_read_b128 v[116:119], v2 offset:44288
    ds_read_b128 v[120:123], v2 offset:44544
    ds_read_b128 v[124:127], v2 offset:44800
    v_mov_b32 v12, 0xffffff00
    s_waitcnt lgkmcnt(6)
    v_pk_add_f32 v[96:97], v[96:97], v[100:101]
    v_pk_add_f32 v[98:99], v[98:99], v[102:103]
    s_waitcnt lgkmcnt(5)
    v_pk_add_f32 v[96:97], v[96:97], v[104:105]
    v_pk_add_f32 v[98:99], v[98:99], v[106:107]
    s_waitcnt lgkmcnt(4)
    v_pk_add_f32 v[96:97], v[96:97], v[108:109]
    v_pk_add_f32 v[98:99], v[98:99], v[110:111]
    s_waitcnt lgkmcnt(3)
    v_pk_add_f32 v[96:97], v[96:97], v[112:113]
    v_pk_add_f32 v[98:99], v[98:99], v[114:115]
    s_waitcnt lgkmcnt(2)
    v_pk_add_f32 v[96:97], v[96:97], v[116:117]
    v_pk_add_f32 v[98:99], v[98:99], v[118:119]
    s_waitcnt lgkmcnt(1)
    v_pk_add_f32 v[96:97], v[96:97], v[120:121]
    v_pk_add_f32 v[98:99], v[98:99], v[122:123]
    s_waitcnt lgkmcnt(0)
    v_pk_add_f32 v[96:97], v[96:97], v[124:125]
    v_pk_add_f32 v[98:99], v[98:99], v[126:127]
    v_and_or_b32 v96, v96, v12, s0
    v_and_or_b32 v97, v97, v12, s1
    v_and_or_b32 v98, v98, v12, s40
    v_and_or_b32 v99, v99, v12, s41
    buffer_store_dwordx4 v[96:99], v2, s[36:39], s59 offen sc1
    s_mov_b64 exec, -1
    s_nop 0
A_NOJOB2:
    global_load_dword v11, v19, s[36:37] nt
    s_lshl_b32 s56, s45, 18
    s_lshl_b32 s63, s50, 16
    s_add_u32 s56, s56, s63
    s_lshl_b32 s63, s51, 7
    s_add_u32 s56, s56, s63
    v_lshl_add_u32 v12, v15, 4, s56
    v_lshl_add_u32 v12, v16, 10, v12
    s_lshl_b32 s57, s47, 10
    s_add_u32 s57, s57, 57344
    s_mov_b32 m0, s57
    v_add_u32 v13, 32768, v12
    global_load_lds_dwordx4 v12, s[4:5]
    s_addk_i32 m0, 4096
    s_lshl_b32 s66, s45, 12
    s_add_u32 s66, s66, 65536
    global_load_lds_dwordx4 v13, s[4:5]
    s_lshl_b32 s56, s46, 7
    s_add_u32 s56, s56, s66
    s_mov_b64 exec, 0x1
    buffer_load_dword v11, v22, s[36:39], s56 offen
    s_lshl_b32 s56, s47, 8
    s_add_u32 s56, s56, 160256
    s_lshl_b32 s57, s49, 10
    s_lshl_b32 s63, s47, 8
    s_add_u32 s57, s57, s63
    s_mov_b32 m0, s56
    s_mov_b64 exec, 0xffff
    v_add_u32 v12, s57, v2
    global_load_lds_dwordx4 v12, s[42:43]
    s_mov_b64 exec, -1
    s_lshl_b32 s56, s49, 6
    s_lshl_b32 s63, s47, 4
    s_add_u32 s56, s56, s63
    s_lshl_b32 s63, s45, 1
    s_add_u32 s56, s56, s63
    s_add_u32 s56, s56, s48
    s_lshl_b32 s57, s49, 11
    s_lshl_b32 s63, s45, 8
    s_add_u32 s57, s57, s63
    s_lshl_b32 s63, s48, 7
    s_add_u32 s57, s57, s63
    s_lshl_b32 s63, s47, 5
    s_add_u32 s57, s57, s63
    s_add_u32 s57, s57, 262144
    s_lshl_b32 s56, s56, 9
    s_add_u32 s56, s56, 1048576
    v_lshl_add_u32 v12, v8, 8, s56
    v_lshl_add_u32 v12, v10, 4, v12
    v_lshl_add_u32 v13, v8, 4, s57
    v_cmp_eq_u32 vcc, 0, v17
    v_mov_b32 v44, -1
    v_mov_b32 v45, -1
    v_mov_b32 v46, -1
    v_mov_b32 v47, -1
    v_cndmask_b32 v0, v13, v12, vcc
    s_mov_b32 exec_lo, 0x1ffff
    s_mov_b32 exec_hi, 0x1ffff
    buffer_store_dwordx4 v[44:47], v0, s[36:39], 0 offen sc1
    s_mov_b64 exec, -1
    s_xor_b32 m0, s31, 65536
    s_add_u32 s81, s28, 49152
    buffer_load_dwordx4 v31, s[8:11], s81 offen offset:1024 lds
    s_mov_b32 s65, 0x3fb8aa3b
    v_lshlrev_b32 v4, 2, v1
    v_mul_u32_u24 v12, 1056, v15
    v_lshl_add_u32 v24, v14, 4, v12
    v_lshlrev_b32 v12, 4, v7
    v_lshl_add_u32 v25, v8, 11, v12
    v_lshlrev_b32 v12, 4, v15
    v_lshl_add_u32 v27, v14, 9, v12
    s_lshl_b32 s56, s47, 10
    s_add_u32 s56, s56, 45056
    v_add_u32 v40, s56, v2
    v_lshl_add_u32 v41, v14, 5, s56
    v_cvt_f32_u32 v42, v8
    v_mov_b32 v43, v42
    s_lshl_b32 s56, s45, 12
    s_lshl_b32 s63, s47, 10
    s_add_u32 s56, s56, s63
    s_add_u32 s56, s56, 32768
    v_lshl_add_u32 v26, v15, 7, s56
    s_waitcnt vmcnt(9)
    s_barrier
    ds_read_b128 v[128:131], v24 offset:32768
    ds_read_b128 v[132:135], v24 offset:32896
    ds_read_b128 v[136:139], v24 offset:33024
    ds_read_b128 v[140:143], v24 offset:33152
    ds_read_b128 v[144:147], v24 offset:33280
    ds_read_b128 v[148:151], v24 offset:33408
    ds_read_b128 v[152:155], v24 offset:33536
    ds_read_b128 v[156:159], v24 offset:33664
    s_lshl_b32 s56, s47, 8
    v_add_u32 v12, s56, v24
    ds_read_b128 v[160:163], v12 offset:32768
    ds_read_b128 v[164:167], v12 offset:32896
    s_add_u32 s81, s28, 97280
    buffer_load_dwordx4 v31, s[8:11], s81 offen offset:2048 lds
    v_mov_b32 v13, 0x3f803f80
    v_mov_b32 v44, 0
    v_mov_b32 v45, 0
    v_mov_b32 v46, 0
    v_mov_b32 v47, 0
    s_waitcnt lgkmcnt(9)
    v_dot2c_f32_bf16 v44, v128, v13
    v_dot2c_f32_bf16 v46, v128, v128
    v_dot2c_f32_bf16 v45, v129, v13
    v_dot2c_f32_bf16 v47, v129, v129
    v_dot2c_f32_bf16 v44, v130, v13
    v_dot2c_f32_bf16 v46, v130, v130
    v_dot2c_f32_bf16 v45, v131, v13
    v_dot2c_f32_bf16 v47, v131, v131
    s_waitcnt lgkmcnt(8)
    v_dot2c_f32_bf16 v44, v132, v13
    s_add_u32 s81, s28, 145408
    buffer_load_dwordx4 v31, s[8:11], s81 offen offset:3072 lds
    v_dot2c_f32_bf16 v46, v132, v132
    v_dot2c_f32_bf16 v45, v133, v13
    v_dot2c_f32_bf16 v47, v133, v133
    v_dot2c_f32_bf16 v44, v134, v13
    v_dot2c_f32_bf16 v46, v134, v134
    v_dot2c_f32_bf16 v45, v135, v13
    v_dot2c_f32_bf16 v47, v135, v135
    s_waitcnt lgkmcnt(7)
    v_dot2c_f32_bf16 v44, v136, v13
    v_dot2c_f32_bf16 v46, v136, v136
    v_dot2c_f32_bf16 v45, v137, v13
    v_dot2c_f32_bf16 v47, v137, v137
    v_dot2c_f32_bf16 v44, v138, v13
    v_dot2c_f32_bf16 v46, v138, v138
    v_dot2c_f32_bf16 v45, v139, v13
    s_xor_b32 m0, s31, 69632
    s_add_u32 s28, s28, s29
    s_add_u32 s81, s28, 1024
    buffer_load_dwordx4 v31, s[8:11], s81 offen offset:0 lds
    v_dot2c_f32_bf16 v47, v139, v139
    s_waitcnt lgkmcnt(6)
    v_dot2c_f32_bf16 v44, v140, v13
    v_dot2c_f32_bf16 v46, v140, v140
    v_dot2c_f32_bf16 v45, v141, v13
    v_dot2c_f32_bf16 v47, v141, v141
    v_dot2c_f32_bf16 v44, v142, v13
    v_dot2c_f32_bf16 v46, v142, v142
    v_dot2c_f32_bf16 v45, v143, v13
    v_dot2c_f32_bf16 v47, v143, v143
    s_waitcnt lgkmcnt(5)
    v_dot2c_f32_bf16 v44, v144, v13
    v_dot2c_f32_bf16 v46, v144, v144
    v_dot2c_f32_bf16 v45, v145, v13
    v_dot2c_f32_bf16 v47, v145, v145
    v_dot2c_f32_bf16 v44, v146, v13
    s_add_u32 s81, s28, 49152
    buffer_load_dwordx4 v31, s[8:11], s81 offen offset:1024 lds
    v_dot2c_f32_bf16 v46, v146, v146
    v_dot2c_f32_bf16 v45, v147, v13
    v_dot2c_f32_bf16 v47, v147, v147
    s_waitcnt lgkmcnt(4)
    v_dot2c_f32_bf16 v44, v148, v13
    v_dot2c_f32_bf16 v46, v148, v148
    v_dot2c_f32_bf16 v45, v149, v13
    v_dot2c_f32_bf16 v47, v149, v149
    v_dot2c_f32_bf16 v44, v150, v13
    v_dot2c_f32_bf16 v46, v150, v150
    v_dot2c_f32_bf16 v45, v151, v13
    v_dot2c_f32_bf16 v47, v151, v151
    s_waitcnt lgkmcnt(3)
    v_dot2c_f32_bf16 v44, v152, v13
    v_dot2c_f32_bf16 v46, v152, v152
    v_dot2c_f32_bf16 v45, v153, v13
    s_add_u32 s81, s28, 97280
    buffer_load_dwordx4 v31, s[8:11], s81 offen offset:2048 lds
    v_dot2c_f32_bf16 v47, v153, v153
    v_dot2c_f32_bf16 v44, v154, v13
    v_dot2c_f32_bf16 v46, v154, v154
    v_dot2c_f32_bf16 v45, v155, v13
    v_dot2c_f32_bf16 v47, v155, v155
    s_waitcnt lgkmcnt(2)
    v_dot2c_f32_bf16 v44, v156, v13
    v_dot2c_f32_bf16 v46, v156, v156
    v_dot2c_f32_bf16 v45, v157, v13
    v_dot2c_f32_bf16 v47, v157, v157
    v_dot2c_f32_bf16 v44, v158, v13
    v_dot2c_f32_bf16 v46, v158, v158
    v_dot2c_f32_bf16 v45, v159, v13
    v_dot2c_f32_bf16 v47, v159, v159
    s_waitcnt lgkmcnt(0)
    v_lshlrev_b32 v168, 16, v160
    s_add_u32 s81, s28, 145408
    buffer_load_dwordx4 v31, s[8:11], s81 offen offset:3072 lds
    v_and_b32 v169, 0xffff0000, v160
    v_lshlrev_b32 v170, 16, v161
    v_and_b32 v171, 0xffff0000, v161
    v_lshlrev_b32 v172, 16, v162
    v_and_b32 v173, 0xffff0000, v162
    v_lshlrev_b32 v174, 16, v163
    v_and_b32 v175, 0xffff0000, v163
    v_lshlrev_b32 v176, 16, v164
    v_and_b32 v177, 0xffff0000, v164
    v_lshlrev_b32 v178, 16, v165
    v_and_b32 v179, 0xffff0000, v165
    v_lshlrev_b32 v180, 16, v166
    v_and_b32 v181, 0xffff0000, v166
    v_lshlrev_b32 v182, 16, v167
    v_and_b32 v183, 0xffff0000, v167
    v_add_f32 v44, v44, v45
    v_add_f32 v46, v46, v47
    s_nop 0
    v_add_f32_dpp v44, v44, v44 row_ror:8 row_mask:0xf bank_mask:0xf
    v_add_f32_dpp v46, v46, v46 row_ror:8 row_mask:0xf bank_mask:0xf
    v_mov_b32 v45, v44
    v_mov_b32 v47, v46
    s_nop 0
    v_permlane16_swap_b32 v45, v44
    v_permlane16_swap_b32 v47, v46
    v_add_f32 v44, v44, v45
    v_add_f32 v46, v46, v47
    v_mov_b32 v45, v44
    v_mov_b32 v47, v46
    s_nop 0
    v_permlane32_swap_b32 v45, v44
    v_permlane32_swap_b32 v47, v46
    v_add_f32 v44, v44, v45
    v_add_f32 v46, v46, v47
    v_mul_f32 v44, 0x3b000000, v44
    v_mul_f32 v46, 0x3b000000, v46
    v_fma_f32 v46, -v44, v44, v46
    v_max_f32 v46, 0, v46
    v_add_f32 v46, 0x3727c5ac, v46
    v_rsq_f32 v45, v46
    s_nop 0
    v_mul_f32 v44, v44, v45
    v_pk_fma_f32 v[168:169], v[168:169], v[44:45], v[44:45] op_sel:[0,1,0] op_sel_hi:[1,1,0] neg_lo:[0,0,1] neg_hi:[0,0,1]
    v_pk_fma_f32 v[170:171], v[170:171], v[44:45], v[44:45] op_sel:[0,1,0] op_sel_hi:[1,1,0] neg_lo:[0,0,1] neg_hi:[0,0,1]
    v_pk_fma_f32 v[172:173], v[172:173], v[44:45], v[44:45] op_sel:[0,1,0] op_sel_hi:[1,1,0] neg_lo:[0,0,1] neg_hi:[0,0,1]
    v_pk_fma_f32 v[174:175], v[174:175], v[44:45], v[44:45] op_sel:[0,1,0] op_sel_hi:[1,1,0] neg_lo:[0,0,1] neg_hi:[0,0,1]
    v_pk_fma_f32 v[176:177], v[176:177], v[44:45], v[44:45] op_sel:[0,1,0] op_sel_hi:[1,1,0] neg_lo:[0,0,1] neg_hi:[0,0,1]
    v_pk_fma_f32 v[178:179], v[178:179], v[44:45], v[44:45] op_sel:[0,1,0] op_sel_hi:[1,1,0] neg_lo:[0,0,1] neg_hi:[0,0,1]
    v_pk_fma_f32 v[180:181], v[180:181], v[44:45], v[44:45] op_sel:[0,1,0] op_sel_hi:[1,1,0] neg_lo:[0,0,1] neg_hi:[0,0,1]
    v_pk_fma_f32 v[182:183], v[182:183], v[44:45], v[44:45] op_sel:[0,1,0] op_sel_hi:[1,1,0] neg_lo:[0,0,1] neg_hi:[0,0,1]
    s_lshl_b32 s56, s47, 9
    s_add_u32 s56, s56, 131072
    s_add_u32 s57, s56, 12288
    s_add_u32 s58, s56, 24576
    s_add_u32 s59, s56, 36864
    s_mov_b32 s64, 30000
    buffer_load_dwordx2 v[80:81], v26, s[36:39], 0 offen sc1
    buffer_load_dwordx4 v[64:67], v25, s[36:39], s56 offen
    buffer_load_dwordx4 v[68:71], v25, s[36:39], s57 offen
    buffer_load_dwordx4 v[72:75], v25, s[36:39], s58 offen
    buffer_load_dwordx4 v[76:79], v25, s[36:39], s59 offen
    v_bfe_u32 v12, v1, 2, 2
    v_lshlrev_b32 v12, 6, v12
    v_lshl_add_u32 v12, v8, 9, v12
    v_and_b32 v13, 3, v1
    s_xor_b32 m0, s31, 98304
    s_add_u32 s28, s28, s30
    s_add_u32 s81, s28, 1024
    buffer_load_dwordx4 v31, s[8:11], s81 offen offset:0 lds
    v_and_b32 v14, 1, v9
    v_lshl_add_u32 v15, v14, 2, v13
    v_lshl_add_u32 v5, v15, 3, v12
    v_and_b32 v16, 1, v15
    v_lshrrev_b32 v17, 1, v15
    v_lshl_add_u32 v16, v16, 2, v17
    v_lshl_add_u32 v6, v16, 3, v12
    v_and_b32 v14, 1, v9
    v_lshlrev_b32 v12, 3, v14
    v_sub_u32 v12, v10, v12
    v_and_b32 v13, 1, v12
    v_lshlrev_b32 v13, 4, v13
    v_mov_b32 v15, 0x3f80
    v_lshlrev_b32 v13, v13, v15
    v_ashrrev_i32 v12, 1, v12
    v_cmp_eq_u32 s[68:69], 0, v12
    v_cmp_eq_u32 s[70:71], 1, v12
    v_cmp_eq_u32 s[72:73], 2, v12
    v_cmp_eq_u32 s[74:75], 3, v12
    v_cndmask_b32 v56, 0, v13, s[68:69]
    s_add_u32 s81, s28, 49152
    buffer_load_dwordx4 v31, s[8:11], s81 offen offset:1024 lds
    v_cndmask_b32 v57, 0, v13, s[70:71]
    v_cndmask_b32 v58, 0, v13, s[72:73]
    v_cndmask_b32 v59, 0, v13, s[74:75]
    v_bfe_u32 v12, v1, 2, 3
    v_lshlrev_b32 v12, 10, v12
    v_lshl_add_u32 v12, v8, 6, v12
    v_and_b32 v13, 3, v1
    v_lshl_add_u32 v62, v13, 4, v12
    v_lshrrev_b32 v12, 3, v1
    v_mul_u32_u24 v12, 896, v12
    v_add_u32 v63, v12, v2
    s_lshl_b32 s3, s45, 18
    s_lshl_b32 s63, s50, 16
    s_add_u32 s3, s3, s63
    s_lshl_b32 s63, s47, 13
    s_add_u32 s3, s3, s63
    s_lshl_b32 s63, s51, 7
    s_add_u32 s3, s3, s63
    v_add_u32 v12, 0, v1
    v_mul_u32_u24 v13, 5462, v12
    s_add_u32 s81, s28, 97280
    buffer_load_dwordx4 v31, s[8:11], s81 offen offset:2048 lds
    v_lshrrev_b32 v13, 16, v13
    v_mul_u32_u24 v16, 12, v13
    v_sub_u32 v12, v12, v16
    v_mul_u32_u24 v13, 2752, v13
    v_lshl_add_u32 v28, v12, 4, v13
    v_add_u32 v12, 64, v1
    v_mul_u32_u24 v13, 5462, v12
    v_lshrrev_b32 v13, 16, v13
    v_mul_u32_u24 v16, 12, v13
    v_sub_u32 v12, v12, v16
    v_lshrrev_b32 v16, 3, v13
    v_lshlrev_b32 v16, 1, v16
    v_xor_b32 v12, v12, v16
    v_mul_u32_u24 v13, 2752, v13
    v_lshl_add_u32 v29, v12, 4, v13
    v_subrev_u32 v29, 1024, v29
    v_add_u32 v12, 128, v1
    v_mul_u32_u24 v13, 5462, v12
    v_lshrrev_b32 v13, 16, v13
    v_mul_u32_u24 v16, 12, v13
    s_add_u32 s81, s28, 145408
    buffer_load_dwordx4 v31, s[8:11], s81 offen offset:3072 lds
    v_sub_u32 v12, v12, v16
    v_xor_b32 v12, 2, v12
    v_mul_u32_u24 v13, 2752, v13
    v_lshl_add_u32 v30, v12, 4, v13
    v_subrev_u32 v30, 2048, v30
    v_and_b32 v14, 1, v9
    v_bfe_u32 v13, v1, 2, 2
    v_lshl_add_u32 v13, v14, 3, v13
    v_mul_u32_u24 v13, 192, v13
    v_mul_u32_u24 v16, 6176, v8
    v_add_u32 v13, v13, v16
    v_lshlrev_b32 v12, 5, v14
    s_lshr_b32 s76, s47, 1
    s_mul_i32 s76, s76, 96
    s_and_b32 s77, s47, 1
    s_lshl_b32 s78, s77, 6
    s_add_u32 s78, s78, s76
    s_lshl4_add_u32 s77, s77, s76
    s_add_u32 s77, s77, 32
    v_and_b32 v16, 1, v1
    s_xor_b32 m0, s31, 102400
    s_add_u32 s28, s28, s29
    s_add_u32 s81, s28, 1024
    buffer_load_dwordx4 v31, s[8:11], s81 offen offset:0 lds
    v_bfe_u32 v17, v1, 1, 1
    v_lshl_add_u32 v18, v16, 1, v17
    v_lshl_add_u32 v18, v18, 3, s78
    v_xor_b32 v18, v18, v12
    v_add_u32 v60, v18, v13
    v_lshl_add_u32 v18, v16, 3, s77
    v_xor_b32 v18, v18, v12
    v_mul_u32_u24 v17, 3088, v17
    v_add3_u32 v61, v18, v13, v17
    s_lshl_b32 s60, s47, 2
    s_add_u32 s60, s60, 49152
    v_mov_b32 v52, s60
    v_mov_b32 v53, 49152
    s_lshr_b32 s62, s46, 2
    s_and_b32 s61, s46, 3
    s_lshl_b32 s60, s62, 15
    s_lshl_b32 s63, s45, 18
    s_add_u32 s60, s60, s63
    s_lshl_b32 s63, s47, 13
    s_add_u32 s60, s60, s63
    s_add_u32 s81, s28, 49152
    buffer_load_dwordx4 v31, s[8:11], s81 offen offset:1024 lds
    s_lshl_b32 s63, s61, 7
    s_add_u32 s60, s60, s63
    s_add_u32 s60, s60, 2097152
    s_lshl_b32 s82, s62, 7
    s_lshl_b32 s63, s61, 4
    s_add_u32 s82, s82, s63
    s_lshl_b32 s63, s47, 2
    s_add_u32 s82, s82, s63
    s_add_u32 s82, s82, s66
    s_add_u32 s61, s60, 4096
    s_add_u32 s81, s28, 97280
    buffer_load_dwordx4 v31, s[8:11], s81 offen offset:2048 lds
    s_add_u32 s81, s28, 145408
    buffer_load_dwordx4 v31, s[8:11], s81 offen offset:3072 lds
    s_waitcnt vmcnt(8)
PP_1:
    v_xor_b32 v64, s0, v64
    v_xor_b32 v65, s1, v65
    v_xor_b32 v66, s40, v66
    v_xor_b32 v67, s41, v67
    v_xor_b32 v68, s0, v68
    v_xor_b32 v69, s1, v69
    v_xor_b32 v70, s40, v70
    v_xor_b32 v71, s41, v71
    v_xor_b32 v72, s0, v72
    v_xor_b32 v73, s1, v73
    v_xor_b32 v74, s40, v74
    v_xor_b32 v75, s41, v75
    v_xor_b32 v76, s0, v76
    v_xor_b32 v77, s1, v77
    v_xor_b32 v78, s40, v78
    v_xor_b32 v79, s41, v79
    v_pk_add_f32 v[44:45], v[64:65], v[68:69]
    v_pk_add_f32 v[46:47], v[66:67], v[70:71]
    v_pk_add_f32 v[48:49], v[72:73], v[76:77]
    v_pk_add_f32 v[50:51], v[74:75], v[78:79]
    v_pk_add_f32 v[44:45], v[44:45], v[48:49]
    v_pk_add_f32 v[46:47], v[46:47], v[50:51]
    v_cvt_pk_bf16_f32 v48, v44, v45
    v_cvt_pk_bf16_f32 v49, v46, v47
    v_lshlrev_b32 v44, 16, v48
    v_and_b32 v45, 0xffff0000, v48
    v_lshlrev_b32 v46, 16, v49
    v_and_b32 v47, 0xffff0000, v49
    v_pk_add_f32 v[44:45], v[44:45], v[42:43]
    v_pk_add_f32 v[46:47], v[46:47], v[42:43]
    v_cvt_pk_bf16_f32 v48, v44, v45
    v_cvt_pk_bf16_f32 v49, v46, v47
    v_lshlrev_b32 v44, 16, v48
    v_and_b32 v45, 0xffff0000, v48
    v_lshlrev_b32 v46, 16, v49
    v_and_b32 v47, 0xffff0000, v49
    ds_write_b128 v40, v[44:47]
    v_cmp_ne_u32 vcc, s67, v81
    v_or3_b32 v12, v64, v65, v66
    v_or3_b32 v12, v12, v67, v68
    v_or3_b32 v12, v12, v69, v70
    v_or3_b32 v12, v12, v71, v72
    v_or3_b32 v12, v12, v73, v74
    v_or3_b32 v12, v12, v75, v76
    v_or3_b32 v12, v12, v77, v78
    v_or_b32 v12, v12, v79
    v_and_b32 v12, 0xff, v12
    v_mov_b32 v13, vcc_lo
    ds_write_b32 v52, v13
    v_xor_b32 v13, s44, v80
    v_or_b32 v12, v12, v13
    v_cmp_ne_u32 vcc, 0, v12
    s_cbranch_vccnz PR_3
PC_2:
    s_waitcnt lgkmcnt(0)
    s_barrier
    ds_read_b128 v[44:47], v53
    ds_read_b128 v[96:99], v41 offset:0
    ds_read_b128 v[104:107], v41 offset:512
    ds_read_b128 v[100:103], v41 offset:16
    ds_read_b128 v[108:111], v41 offset:528
    ds_read_b128 v[112:115], v41 offset:256
    ds_read_b128 v[120:123], v41 offset:768
    ds_read_b128 v[116:119], v41 offset:272
    ds_read_b128 v[124:127], v41 offset:784
    s_waitcnt lgkmcnt(8)
    v_or3_b32 v44, v44, v45, v46
    v_or_b32 v44, v44, v47
    s_nop 0
    v_readfirstlane_b32 s62, v44
    s_waitcnt lgkmcnt(6)
    v_pk_fma_f32 v[168:169], v[168:169], v[104:105], v[96:97]
    v_pk_fma_f32 v[170:171], v[170:171], v[106:107], v[98:99]
    s_waitcnt lgkmcnt(4)
    v_pk_fma_f32 v[172:173], v[172:173], v[108:109], v[100:101]
    v_pk_fma_f32 v[174:175], v[174:175], v[110:111], v[102:103]
    v_cvt_pk_bf16_f32 v32, v168, v169
    v_cvt_pk_bf16_f32 v33, v170, v171
    v_cvt_pk_bf16_f32 v34, v172, v173
    v_cvt_pk_bf16_f32 v35, v174, v175
    s_cmp_lg_u32 s62, 0
    s_nop 0
    s_cbranch_scc1 SLOW
    buffer_store_dwordx4 v[32:35], v27, s[36:39], s60 offen
    s_waitcnt lgkmcnt(2)
    v_pk_fma_f32 v[176:177], v[176:177], v[120:121], v[112:113]
    v_pk_fma_f32 v[178:179], v[178:179], v[122:123], v[114:115]
    s_waitcnt lgkmcnt(0)
    v_pk_fma_f32 v[180:181], v[180:181], v[124:125], v[116:117]
    v_pk_fma_f32 v[182:183], v[182:183], v[126:127], v[118:119]
    v_cvt_pk_bf16_f32 v36, v176, v177
    v_cvt_pk_bf16_f32 v37, v178, v179
    v_cvt_pk_bf16_f32 v38, v180, v181
    v_cvt_pk_bf16_f32 v39, v182, v183
    buffer_store_dwordx4 v[36:39], v27, s[36:39], s61 offen
    s_add_u32 s56, s56, 6144
    s_add_u32 s57, s57, 6144
    s_add_u32 s58, s58, 6144
    s_add_u32 s59, s59, 6144
    s_and_b32 s62, s47, 1
    s_mul_i32 s60, s62, 6144
    s_lshl_b32 s63, s51, 8
    s_add_u32 s60, s60, s63
    s_add_u32 s60, s60, 135168
    v_mul_u32_u24 v13, 12288, v9
    v_lshl_add_u32 v52, v10, 4, v13
    s_mov_b32 s64, 30000
    buffer_load_dwordx4 v[64:67], v25, s[36:39], s56 offen
    buffer_load_dwordx4 v[68:71], v25, s[36:39], s57 offen
    buffer_load_dwordx4 v[72:75], v25, s[36:39], s58 offen
    buffer_load_dwordx4 v[76:79], v25, s[36:39], s59 offen
    buffer_load_dwordx4 v[80:83], v52, s[36:39], s60 offen
    s_cmp_eq_u32 s48, 0
    s_cselect_b32 s78, 0, 0
    s_lshl_b32 s61, s47, 2
    s_xor_b32 s61, s61, s78
    s_lshl_b32 s61, s61, 6
    s_add_u32 s61, s61, 157184
    v_lshl_add_u32 v53, v8, 10, s61
    v_lshl_add_u32 v53, v7, 3, v53
    s_lshl_b32 s61, s51, 1
    s_xor_b32 s61, s61, s78
    s_lshl_b32 s61, s61, 6
    s_mul_i32 s63, s62, 3072
    s_add_u32 s61, s61, s63
    s_add_u32 s61, s61, 156160
    v_lshl_add_u32 v54, v10, 3, s61
    v_lshl_add_u32 v54, v9, 1, v54
    s_waitcnt vmcnt(5)
    s_mov_b64 exec, 1
    buffer_store_dword v3, off, s[36:39], s82 offset:0
    s_mov_b64 exec, -1
    s_mov_b64 exec, 1
    buffer_store_dword v3, off, s[36:39], s83 sc1
    s_mov_b64 exec, -1
    s_lshr_b32 s61, s47, 1
    s_lshl_b32 s61, s61, 12
    s_lshl_b32 s63, s62, 6
    s_add_u32 s61, s61, s63
    s_add_u32 s61, s61, 57344
    v_lshl_add_u32 v12, v7, 7, s61
    v_lshl_add_u32 v12, v8, 5, v12
    ds_read_b128 a[192:195], v12
    ds_read_b128 a[196:199], v12 offset:16
    s_add_u32 m0, s80, 0
    s_add_u32 s81, s79, 0
    buffer_load_dwordx4 v31, s[8:11], s81 offen offset:0 lds
    s_add_u32 s81, s79, 48128
    buffer_load_dwordx4 v31, s[8:11], s81 offen offset:1024 lds
    s_add_u32 s81, s79, 96256
    buffer_load_dwordx4 v31, s[8:11], s81 offen offset:2048 lds
    s_add_u32 s81, s79, 144384
    buffer_load_dwordx4 v31, s[8:11], s81 offen offset:3072 lds
    s_add_u32 m0, s80, 4096
    s_add_u32 s81, s79, 196608
    buffer_load_dwordx4 v31, s[8:11], s81 offen offset:0 lds
    s_waitcnt vmcnt(7)
PP_4:
    v_xor_b32 v64, s0, v64
    v_xor_b32 v65, s1, v65
    v_xor_b32 v66, s40, v66
    v_xor_b32 v67, s41, v67
    v_xor_b32 v68, s0, v68
    v_xor_b32 v69, s1, v69
    v_xor_b32 v70, s40, v70
    v_xor_b32 v71, s41, v71
    v_xor_b32 v72, s0, v72
    v_xor_b32 v73, s1, v73
    v_xor_b32 v74, s40, v74
    v_xor_b32 v75, s41, v75
    v_xor_b32 v76, s0, v76
    v_xor_b32 v77, s1, v77
    v_xor_b32 v78, s40, v78
    v_xor_b32 v79, s41, v79
    v_pk_add_f32 v[44:45], v[64:65], v[68:69]
    v_pk_add_f32 v[46:47], v[66:67], v[70:71]
    v_pk_add_f32 v[48:49], v[72:73], v[76:77]
    v_pk_add_f32 v[50:51], v[74:75], v[78:79]
    v_pk_add_f32 v[44:45], v[44:45], v[48:49]
    v_pk_add_f32 v[46:47], v[46:47], v[50:51]
    v_cvt_pk_bf16_f32 v48, v44, v45
    v_cvt_pk_bf16_f32 v49, v46, v47
    v_lshlrev_b32 v44, 16, v48
    v_and_b32 v45, 0xffff0000, v48
    v_lshlrev_b32 v46, 16, v49
    v_and_b32 v47, 0xffff0000, v49
    v_pk_add_f32 v[44:45], v[44:45], v[42:43]
    v_pk_add_f32 v[46:47], v[46:47], v[42:43]
    v_cvt_pk_bf16_f32 v48, v44, v45
    v_cvt_pk_bf16_f32 v49, v46, v47
    ds_write_b64 v53, v[48:49]
    v_xor_b32 v80, s0, v80
    v_xor_b32 v81, s1, v81
    v_xor_b32 v82, s40, v82
    v_xor_b32 v83, s41, v83
    v_or3_b32 v12, v64, v65, v66
    v_or3_b32 v12, v12, v67, v68
    v_or3_b32 v12, v12, v69, v70
    v_or3_b32 v12, v12, v71, v72
    v_or3_b32 v12, v12, v73, v74
    v_or3_b32 v12, v12, v75, v76
    v_or3_b32 v12, v12, v77, v78
    v_or3_b32 v12, v12, v79, v80
    v_or3_b32 v12, v12, v81, v82
    v_or_b32 v12, v12, v83
    v_and_b32 v12, 0xff, v12
    v_permlane32_swap_b32 v80, v82
    v_permlane32_swap_b32 v81, v83
    v_add_f32 v80, v80, v82
    v_add_f32 v81, v81, v83
    s_nop 1
    v_permlane16_swap_b32 v80, v81
    v_add_f32 v80, v80, v81
    v_cvt_pk_bf16_f32 v80, v80, v80
    ds_write_b16 v54, v80
    v_cmp_ne_u32 vcc, 0, v12
    s_cbranch_vccnz PR_6
PC_5:
    s_lshl_b32 s59, s48, 2
    s_add_u32 s59, s59, s47
    s_lshl_b32 s56, s59, 7
    s_add_u32 s56, s56, s66
    v_lshlrev_b32 v14, 2, v10
    s_mov_b32 s64, 30000
    buffer_load_dword v13, v14, s[36:39], s56 offen offset:0 sc1
    s_lshl_b32 s57, s45, 3
    s_add_u32 s57, s57, s59
    s_lshl_b32 s58, s57, 15
    s_add_u32 s58, s58, 2097152
    s_lshl_b32 s60, s57, 15
    s_lshl_b32 s63, s49, 11
    s_add_u32 s60, s60, s63
    s_add_u32 s60, s60, 7340032
    s_lshl_b32 s59, s59, 6
    s_lshl_b32 s63, s49, 2
    s_add_u32 s59, s59, s63
    s_add_u32 s59, s59, s66
    s_waitcnt vmcnt(0)
PP_7:
    v_cmp_ne_u32 vcc, s44, v13
    s_cbranch_vccnz PR_9
PC_8:
    buffer_load_dwordx4 v[128:131], v2, s[36:39], s58 offen offset:0 sc1
    buffer_load_dwordx4 v[132:135], v2, s[36:39], s58 offen offset:1024 sc1
    buffer_load_dwordx4 v[136:139], v2, s[36:39], s58 offen offset:2048 sc1
    buffer_load_dwordx4 v[140:143], v2, s[36:39], s58 offen offset:3072 sc1
    s_add_u32 s58, s58, 4096
    buffer_load_dwordx4 v[144:147], v2, s[36:39], s58 offen offset:0 sc1
    buffer_load_dwordx4 v[148:151], v2, s[36:39], s58 offen offset:1024 sc1
    buffer_load_dwordx4 v[152:155], v2, s[36:39], s58 offen offset:2048 sc1
    buffer_load_dwordx4 v[156:159], v2, s[36:39], s58 offen offset:3072 sc1
    s_add_u32 s58, s58, 4096
    buffer_load_dwordx4 v[160:163], v2, s[36:39], s58 offen offset:0 sc1
    buffer_load_dwordx4 v[164:167], v2, s[36:39], s58 offen offset:1024 sc1
    s_waitcnt lgkmcnt(0)
    s_barrier
    v_bfe_u32 v12, v1, 2, 2
    v_lshl_add_u32 v12, v8, 2, v12
    v_lshlrev_b32 v12, 5, v12
    v_bfe_u32 v13, v1, 1, 1
    v_and_b32 v14, 1, v9
    v_lshl_add_u32 v13, v14, 1, v13
    v_lshl_add_u32 v12, v13, 3, v12
    v_add_u32 v12, 160256, v12
    ds_read_b64_tr_b16 v[20:21], v12 offset:0
    ds_read_b64_tr_b16 v[22:23], v12 offset:256
    ds_read_b64_tr_b16 v[24:25], v12 offset:512
    ds_read_b64_tr_b16 v[26:27], v12 offset:768
    v_bfe_i32 v13, v1, 2, 1
    v_and_b32 v13, 0x80008000, v13
    v_add_u32 v14, 65536, v5
    v_add_u32 v18, 98304, v6
    s_waitcnt lgkmcnt(0)
    v_xor_b32 v20, v13, v20
    v_xor_b32 v21, v13, v21
    v_xor_b32 v22, v13, v22
    v_xor_b32 v23, v13, v23
    v_xor_b32 v24, v13, v24
    v_xor_b32 v25, v13, v25
    v_xor_b32 v26, v13, v26
    v_xor_b32 v27, v13, v27
    s_lshl_b32 s56, s47, 10
    s_add_u32 s56, s56, 32768
    v_lshl_add_u32 v15, v7, 5, s56
    v_lshl_add_u32 v15, v8, 12, v15
    ds_read_b64_tr_b16 v[32:33], v14 offset:0
    ds_read_b64_tr_b16 v[34:35], v14 offset:256
    ds_read_b64_tr_b16 v[36:37], v18 offset:0
    ds_read_b64_tr_b16 v[38:39], v18 offset:256
    ds_read_b64_tr_b16 v[40:41], v14 offset:1024
    ds_read_b64_tr_b16 v[42:43], v14 offset:1280
    ds_read_b64_tr_b16 v[44:45], v18 offset:1024
    ds_read_b64_tr_b16 v[46:47], v18 offset:1280
    ds_read_b64_tr_b16 v[48:49], v14 offset:2048
    ds_read_b64_tr_b16 v[50:51], v14 offset:2304
    s_waitcnt vmcnt(9) lgkmcnt(8)
    v_mfma_f32_32x32x16_bf16 v[64:79], v[32:35], v[128:131], 0
    buffer_load_dwordx4 v[168:171], v2, s[36:39], s58 offen offset:2048 sc1
    ds_read_b64_tr_b16 v[52:53], v18 offset:2048
    ds_read_b64_tr_b16 v[54:55], v18 offset:2304
    s_waitcnt lgkmcnt(8)
    v_mfma_f32_32x32x16_bf16 v[80:95], v[36:39], v[128:131], 0
    ds_read_b64_tr_b16 v[32:33], v14 offset:3072
    ds_read_b64_tr_b16 v[34:35], v14 offset:3328
    s_waitcnt vmcnt(9) lgkmcnt(8)
    v_mfma_f32_32x32x16_bf16 v[64:79], v[40:43], v[132:135], v[64:79]
    buffer_load_dwordx4 v[172:175], v2, s[36:39], s58 offen offset:3072 sc1
    s_add_u32 s58, s58, 4096
    ds_read_b64_tr_b16 v[36:37], v18 offset:3072
    ds_read_b64_tr_b16 v[38:39], v18 offset:3328
    s_waitcnt lgkmcnt(8)
    v_mfma_f32_32x32x16_bf16 v[80:95], v[44:47], v[132:135], v[80:95]
    ds_read_b64_tr_b16 v[40:41], v14 offset:4096
    ds_read_b64_tr_b16 v[42:43], v14 offset:4352
    s_waitcnt vmcnt(9) lgkmcnt(8)
    v_mfma_f32_32x32x16_bf16 v[64:79], v[48:51], v[136:139], v[64:79]
    buffer_load_dwordx4 v[176:179], v2, s[36:39], s58 offen offset:0 sc1
    ds_read_b64_tr_b16 v[44:45], v18 offset:4096
    ds_read_b64_tr_b16 v[46:47], v18 offset:4352
    s_waitcnt lgkmcnt(8)
    v_mfma_f32_32x32x16_bf16 v[80:95], v[52:55], v[136:139], v[80:95]
    ds_read_b64_tr_b16 v[48:49], v14 offset:5120
    ds_read_b64_tr_b16 v[50:51], v14 offset:5376
    s_waitcnt vmcnt(9) lgkmcnt(8)
    v_mfma_f32_32x32x16_bf16 v[64:79], v[32:35], v[140:143], v[64:79]
    buffer_load_dwordx4 v[180:183], v2, s[36:39], s58 offen offset:1024 sc1
    ds_read_b64_tr_b16 v[52:53], v18 offset:5120
    ds_read_b64_tr_b16 v[54:55], v18 offset:5376
    s_waitcnt lgkmcnt(8)
    v_mfma_f32_32x32x16_bf16 v[80:95], v[36:39], v[140:143], v[80:95]
    ds_read_b64_tr_b16 v[32:33], v14 offset:6144
    ds_read_b64_tr_b16 v[34:35], v14 offset:6400
    s_waitcnt vmcnt(9) lgkmcnt(8)
    v_mfma_f32_32x32x16_bf16 v[64:79], v[40:43], v[144:147], v[64:79]
    buffer_load_dwordx4 v[184:187], v2, s[36:39], s58 offen offset:2048 sc1
    ds_read_b64_tr_b16 v[36:37], v18 offset:6144
    ds_read_b64_tr_b16 v[38:39], v18 offset:6400
    s_waitcnt lgkmcnt(8)
    v_mfma_f32_32x32x16_bf16 v[80:95], v[44:47], v[144:147], v[80:95]
    ds_read_b64_tr_b16 v[40:41], v14 offset:7168
    ds_read_b64_tr_b16 v[42:43], v14 offset:7424
    s_waitcnt vmcnt(9) lgkmcnt(8)
    v_mfma_f32_32x32x16_bf16 v[64:79], v[48:51], v[148:151], v[64:79]
    buffer_load_dwordx4 v[188:191], v2, s[36:39], s58 offen offset:3072 sc1
    s_add_u32 s58, s58, 4096
    ds_read_b64_tr_b16 v[44:45], v18 offset:7168
    ds_read_b64_tr_b16 v[46:47], v18 offset:7424
    s_waitcnt lgkmcnt(8)
    v_mfma_f32_32x32x16_bf16 v[80:95], v[52:55], v[148:151], v[80:95]
    ds_read_b64_tr_b16 v[48:49], v14 offset:8192
    ds_read_b64_tr_b16 v[50:51], v14 offset:8448
    s_waitcnt vmcnt(9) lgkmcnt(8)
    v_mfma_f32_32x32x16_bf16 v[64:79], v[32:35], v[152:155], v[64:79]
    buffer_load_dwordx4 v[192:195], v2, s[36:39], s58 offen offset:0 sc1
    ds_read_b64_tr_b16 v[52:53], v18 offset:8192
    ds_read_b64_tr_b16 v[54:55], v18 offset:8448
    s_waitcnt lgkmcnt(8)
    v_mfma_f32_32x32x16_bf16 v[80:95], v[36:39], v[152:155], v[80:95]
    ds_read_b64_tr_b16 v[32:33], v14 offset:9216
    ds_read_b64_tr_b16 v[34:35], v14 offset:9472
    s_waitcnt vmcnt(9) lgkmcnt(8)
    v_mfma_f32_32x32x16_bf16 v[64:79], v[40:43], v[156:159], v[64:79]
    buffer_load_dwordx4 v[196:199], v2, s[36:39], s58 offen offset:1024 sc1
    ds_read_b64_tr_b16 v[36:37], v18 offset:9216
    ds_read_b64_tr_b16 v[38:39], v18 offset:9472
    s_waitcnt lgkmcnt(8)
    v_mfma_f32_32x32x16_bf16 v[80:95], v[44:47], v[156:159], v[80:95]
    ds_read_b64_tr_b16 v[40:41], v14 offset:10240
    ds_read_b64_tr_b16 v[42:43], v14 offset:10496
    s_waitcnt vmcnt(9) lgkmcnt(8)
    v_mfma_f32_32x32x16_bf16 v[64:79], v[48:51], v[160:163], v[64:79]
    buffer_load_dwordx4 v[200:203], v2, s[36:39], s58 offen offset:2048 sc1
    ds_read_b64_tr_b16 v[44:45], v18 offset:10240
    ds_read_b64_tr_b16 v[46:47], v18 offset:10496
    s_waitcnt lgkmcnt(8)
    v_mfma_f32_32x32x16_bf16 v[80:95], v[52:55], v[160:163], v[80:95]
    ds_read_b64_tr_b16 v[48:49], v14 offset:11264
    ds_read_b64_tr_b16 v[50:51], v14 offset:11520
    s_waitcnt vmcnt(9) lgkmcnt(8)
    v_mfma_f32_32x32x16_bf16 v[64:79], v[32:35], v[164:167], v[64:79]
    buffer_load_dwordx4 v[204:207], v2, s[36:39], s58 offen offset:3072 sc1
    s_add_u32 s58, s58, 4096
    ds_read_b64_tr_b16 v[52:53], v18 offset:11264
    ds_read_b64_tr_b16 v[54:55], v18 offset:11520
    s_waitcnt lgkmcnt(8)
    v_mfma_f32_32x32x16_bf16 v[80:95], v[36:39], v[164:167], v[80:95]
    ds_read_b64_tr_b16 v[32:33], v14 offset:12288
    ds_read_b64_tr_b16 v[34:35], v14 offset:12544
    s_waitcnt vmcnt(9) lgkmcnt(8)
    v_mfma_f32_32x32x16_bf16 v[64:79], v[40:43], v[168:171], v[64:79]
    buffer_load_dwordx4 v[208:211], v2, s[36:39], s58 offen offset:0 sc1
    ds_read_b64_tr_b16 v[36:37], v18 offset:12288
    ds_read_b64_tr_b16 v[38:39], v18 offset:12544
    s_waitcnt lgkmcnt(8)
    v_mfma_f32_32x32x16_bf16 v[80:95], v[44:47], v[168:171], v[80:95]
    ds_read_b64_tr_b16 v[40:41], v14 offset:13312
    ds_read_b64_tr_b16 v[42:43], v14 offset:13568
    s_waitcnt vmcnt(9) lgkmcnt(8)
    v_mfma_f32_32x32x16_bf16 v[64:79], v[48:51], v[172:175], v[64:79]
    buffer_load_dwordx4 v[212:215], v2, s[36:39], s58 offen offset:1024 sc1
    ds_read_b64_tr_b16 v[44:45], v18 offset:13312
    ds_read_b64_tr_b16 v[46:47], v18 offset:13568
    s_waitcnt lgkmcnt(8)
    v_mfma_f32_32x32x16_bf16 v[80:95], v[52:55], v[172:175], v[80:95]
    ds_read_b64_tr_b16 v[48:49], v14 offset:14336
    ds_read_b64_tr_b16 v[50:51], v14 offset:14592
    s_waitcnt vmcnt(9) lgkmcnt(8)
    v_mfma_f32_32x32x16_bf16 v[64:79], v[32:35], v[176:179], v[64:79]
    buffer_load_dwordx4 v[216:219], v2, s[36:39], s58 offen offset:2048 sc1
    ds_read_b64_tr_b16 v[52:53], v18 offset:14336
    ds_read_b64_tr_b16 v[54:55], v18 offset:14592
    s_waitcnt lgkmcnt(8)
    v_mfma_f32_32x32x16_bf16 v[80:95], v[36:39], v[176:179], v[80:95]
    ds_read_b64_tr_b16 v[32:33], v14 offset:15360
    ds_read_b64_tr_b16 v[34:35], v14 offset:15616
    s_waitcnt vmcnt(9) lgkmcnt(8)
    v_mfma_f32_32x32x16_bf16 v[64:79], v[40:43], v[180:183], v[64:79]
    buffer_load_dwordx4 v[220:223], v2, s[36:39], s58 offen offset:3072 sc1
    s_add_u32 s58, s58, 4096
    ds_read_b64_tr_b16 v[36:37], v18 offset:15360
    ds_read_b64_tr_b16 v[38:39], v18 offset:15616
    s_waitcnt lgkmcnt(8)
    v_mfma_f32_32x32x16_bf16 v[80:95], v[44:47], v[180:183], v[80:95]
    ds_read_b64_tr_b16 v[40:41], v14 offset:16384
    ds_read_b64_tr_b16 v[42:43], v14 offset:16640
    s_waitcnt vmcnt(9) lgkmcnt(8)
    v_mfma_f32_32x32x16_bf16 v[64:79], v[48:51], v[184:187], v[64:79]
    buffer_load_dwordx4 v[224:227], v2, s[36:39], s58 offen offset:0 sc1
    ds_read_b64_tr_b16 v[44:45], v18 offset:16384
    ds_read_b64_tr_b16 v[46:47], v18 offset:16640
    s_waitcnt lgkmcnt(8)
    v_mfma_f32_32x32x16_bf16 v[80:95], v[52:55], v[184:187], v[80:95]
    ds_read_b64_tr_b16 v[48:49], v14 offset:17408
    ds_read_b64_tr_b16 v[50:51], v14 offset:17664
    s_waitcnt vmcnt(9) lgkmcnt(8)
    v_mfma_f32_32x32x16_bf16 v[64:79], v[32:35], v[188:191], v[64:79]
    buffer_load_dwordx4 v[228:231], v2, s[36:39], s58 offen offset:1024 sc1
    ds_read_b64_tr_b16 v[52:53], v18 offset:17408
    ds_read_b64_tr_b16 v[54:55], v18 offset:17664
    s_waitcnt lgkmcnt(8)
    v_mfma_f32_32x32x16_bf16 v[80:95], v[36:39], v[188:191], v[80:95]
    ds_read_b64_tr_b16 v[32:33], v14 offset:18432
    ds_read_b64_tr_b16 v[34:35], v14 offset:18688
    s_waitcnt vmcnt(9) lgkmcnt(8)
    v_mfma_f32_32x32x16_bf16 v[64:79], v[40:43], v[192:195], v[64:79]
    buffer_load_dwordx4 v[232:235], v2, s[36:39], s58 offen offset:2048 sc1
    ds_read_b64_tr_b16 v[36:37], v18 offset:18432
    ds_read_b64_tr_b16 v[38:39], v18 offset:18688
    s_waitcnt lgkmcnt(8)
    v_mfma_f32_32x32x16_bf16 v[80:95], v[44:47], v[192:195], v[80:95]
    ds_read_b64_tr_b16 v[40:41], v14 offset:19456
    ds_read_b64_tr_b16 v[42:43], v14 offset:19712
    s_waitcnt vmcnt(9) lgkmcnt(8)
    v_mfma_f32_32x32x16_bf16 v[64:79], v[48:51], v[196:199], v[64:79]
    buffer_load_dwordx4 v[236:239], v2, s[36:39], s58 offen offset:3072 sc1
    s_add_u32 s58, s58, 4096
    ds_read_b64_tr_b16 v[44:45], v18 offset:19456
    ds_read_b64_tr_b16 v[46:47], v18 offset:19712
    s_waitcnt lgkmcnt(8)
    v_mfma_f32_32x32x16_bf16 v[80:95], v[52:55], v[196:199], v[80:95]
    ds_read_b64_tr_b16 v[48:49], v14 offset:20480
    ds_read_b64_tr_b16 v[50:51], v14 offset:20736
    s_waitcnt vmcnt(9) lgkmcnt(8)
    v_mfma_f32_32x32x16_bf16 v[64:79], v[32:35], v[200:203], v[64:79]
    buffer_load_dwordx4 v[240:243], v2, s[36:39], s58 offen offset:0 sc1
    ds_read_b64_tr_b16 v[52:53], v18 offset:20480
    ds_read_b64_tr_b16 v[54:55], v18 offset:20736
    s_waitcnt lgkmcnt(8)
    v_mfma_f32_32x32x16_bf16 v[80:95], v[36:39], v[200:203], v[80:95]
    ds_read_b64_tr_b16 v[32:33], v14 offset:21504
    ds_read_b64_tr_b16 v[34:35], v14 offset:21760
    s_waitcnt vmcnt(9) lgkmcnt(8)
    v_mfma_f32_32x32x16_bf16 v[64:79], v[40:43], v[204:207], v[64:79]
    buffer_load_dwordx4 v[244:247], v2, s[36:39], s58 offen offset:1024 sc1
    ds_read_b64_tr_b16 v[36:37], v18 offset:21504
    ds_read_b64_tr_b16 v[38:39], v18 offset:21760
    s_waitcnt lgkmcnt(8)
    v_mfma_f32_32x32x16_bf16 v[80:95], v[44:47], v[204:207], v[80:95]
    ds_read_b64_tr_b16 v[40:41], v14 offset:22528
    ds_read_b64_tr_b16 v[42:43], v14 offset:22784
    s_waitcnt vmcnt(9) lgkmcnt(8)
    v_mfma_f32_32x32x16_bf16 v[64:79], v[48:51], v[208:211], v[64:79]
    buffer_load_dwordx4 v[248:251], v2, s[36:39], s58 offen offset:2048 sc1
    ds_read_b64_tr_b16 v[44:45], v18 offset:22528
    ds_read_b64_tr_b16 v[46:47], v18 offset:22784
    s_waitcnt lgkmcnt(8)
    v_mfma_f32_32x32x16_bf16 v[80:95], v[52:55], v[208:211], v[80:95]
    ds_read_b64_tr_b16 v[48:49], v14 offset:23552
    ds_read_b64_tr_b16 v[50:51], v14 offset:23808
    s_waitcnt vmcnt(9) lgkmcnt(8)
    v_mfma_f32_32x32x16_bf16 v[64:79], v[32:35], v[212:215], v[64:79]
    buffer_load_dwordx4 v[252:255], v2, s[36:39], s58 offen offset:3072 sc1
    ds_read_b64_tr_b16 v[52:53], v18 offset:23552
    ds_read_b64_tr_b16 v[54:55], v18 offset:23808
    s_waitcnt lgkmcnt(8)
    v_mfma_f32_32x32x16_bf16 v[80:95], v[36:39], v[212:215], v[80:95]
    ds_read_b64_tr_b16 v[32:33], v14 offset:24576
    ds_read_b64_tr_b16 v[34:35], v14 offset:24832
    s_waitcnt vmcnt(9) lgkmcnt(8)
    v_mfma_f32_32x32x16_bf16 v[64:79], v[40:43], v[216:219], v[64:79]
    v_lshlrev_b32 v12, 7, v1
    s_lshr_b32 s7, s47, 1
    s_lshl1_add_u32 s7, s2, s7
    s_mul_i32 s6, s7, 2816
    s_mov_b64 exec, 0x3fffff
    buffer_load_dword v11, v12, s[52:55], s6 offen
    s_mov_b64 exec, -1
    ds_read_b64_tr_b16 v[36:37], v18 offset:24576
    ds_read_b64_tr_b16 v[38:39], v18 offset:24832
    s_waitcnt lgkmcnt(8)
    v_mfma_f32_32x32x16_bf16 v[80:95], v[44:47], v[216:219], v[80:95]
    ds_read_b64_tr_b16 v[40:41], v14 offset:25600
    ds_read_b64_tr_b16 v[42:43], v14 offset:25856
    s_waitcnt vmcnt(9) lgkmcnt(8)
    v_mfma_f32_32x32x16_bf16 v[64:79], v[48:51], v[220:223], v[64:79]
    s_add_u32 s81, s79, 244736
    buffer_load_dwordx4 v31, s[8:11], s81 offen offset:1024 lds
    ds_read_b64_tr_b16 v[44:45], v18 offset:25600
    ds_read_b64_tr_b16 v[46:47], v18 offset:25856
    s_waitcnt lgkmcnt(8)
    v_mfma_f32_32x32x16_bf16 v[80:95], v[52:55], v[220:223], v[80:95]
    ds_read_b64_tr_b16 v[48:49], v14 offset:26624
    ds_read_b64_tr_b16 v[50:51], v14 offset:26880
    s_waitcnt vmcnt(9) lgkmcnt(8)
    v_mfma_f32_32x32x16_bf16 v[64:79], v[32:35], v[224:227], v[64:79]
    s_add_u32 s81, s79, 292864
    buffer_load_dwordx4 v31, s[8:11], s81 offen offset:2048 lds
    ds_read_b64_tr_b16 v[52:53], v18 offset:26624
    ds_read_b64_tr_b16 v[54:55], v18 offset:26880
    s_waitcnt lgkmcnt(8)
    v_mfma_f32_32x32x16_bf16 v[80:95], v[36:39], v[224:227], v[80:95]
    ds_read_b64_tr_b16 v[32:33], v14 offset:27648
    ds_read_b64_tr_b16 v[34:35], v14 offset:27904
    s_waitcnt vmcnt(9) lgkmcnt(8)
    v_mfma_f32_32x32x16_bf16 v[64:79], v[40:43], v[228:231], v[64:79]
    s_add_u32 s81, s79, 340992
    buffer_load_dwordx4 v31, s[8:11], s81 offen offset:3072 lds
    ds_read_b64_tr_b16 v[36:37], v18 offset:27648
    ds_read_b64_tr_b16 v[38:39], v18 offset:27904
    s_waitcnt lgkmcnt(8)
    v_mfma_f32_32x32x16_bf16 v[80:95], v[44:47], v[228:231], v[80:95]
    ds_read_b64_tr_b16 v[40:41], v14 offset:28672
    ds_read_b64_tr_b16 v[42:43], v14 offset:28928
    s_waitcnt vmcnt(9) lgkmcnt(8)
    v_mfma_f32_32x32x16_bf16 v[64:79], v[48:51], v[232:235], v[64:79]
    ds_read_b64_tr_b16 v[44:45], v18 offset:28672
    ds_read_b64_tr_b16 v[46:47], v18 offset:28928
    s_waitcnt lgkmcnt(8)
    v_mfma_f32_32x32x16_bf16 v[80:95], v[52:55], v[232:235], v[80:95]
    ds_read_b64_tr_b16 v[48:49], v14 offset:29696
    ds_read_b64_tr_b16 v[50:51], v14 offset:29952
    s_waitcnt vmcnt(8) lgkmcnt(8)
    v_mfma_f32_32x32x16_bf16 v[64:79], v[32:35], v[236:239], v[64:79]
    ds_read_b64_tr_b16 v[52:53], v18 offset:29696
    ds_read_b64_tr_b16 v[54:55], v18 offset:29952
    s_waitcnt lgkmcnt(8)
    v_mfma_f32_32x32x16_bf16 v[80:95], v[36:39], v[236:239], v[80:95]
    ds_read_b64_tr_b16 v[32:33], v14 offset:30720
    ds_read_b64_tr_b16 v[34:35], v14 offset:30976
    s_waitcnt vmcnt(7) lgkmcnt(8)
    v_mfma_f32_32x32x16_bf16 v[64:79], v[40:43], v[240:243], v[64:79]
    ds_read_b64_tr_b16 v[36:37], v18 offset:30720
    ds_read_b64_tr_b16 v[38:39], v18 offset:30976
    s_waitcnt lgkmcnt(8)
    v_mfma_f32_32x32x16_bf16 v[80:95], v[44:47], v[240:243], v[80:95]
    ds_read_b64_tr_b16 v[40:41], v14 offset:31744
    ds_read_b64_tr_b16 v[42:43], v14 offset:32000
    s_waitcnt vmcnt(6) lgkmcnt(8)
    v_mfma_f32_32x32x16_bf16 v[64:79], v[48:51], v[244:247], v[64:79]
    ds_read_b64_tr_b16 v[44:45], v18 offset:31744
    ds_read_b64_tr_b16 v[46:47], v18 offset:32000
    s_waitcnt lgkmcnt(8)
    v_mfma_f32_32x32x16_bf16 v[80:95], v[52:55], v[244:247], v[80:95]
    s_waitcnt vmcnt(5) lgkmcnt(6)
    v_mfma_f32_32x32x16_bf16 v[64:79], v[32:35], v[248:251], v[64:79]
    s_waitcnt lgkmcnt(4)
    v_mfma_f32_32x32x16_bf16 v[80:95], v[36:39], v[248:251], v[80:95]
    s_waitcnt vmcnt(4) lgkmcnt(2)
    v_mfma_f32_32x32x16_bf16 v[64:79], v[40:43], v[252:255], v[64:79]
    s_waitcnt lgkmcnt(0)
    v_mfma_f32_32x32x16_bf16 v[80:95], v[44:47], v[252:255], v[80:95]
    s_lshl_b32 s56, s47, 13
    s_lshl_b32 s63, s49, 7
    s_add_u32 s56, s56, s63
    s_add_u32 s56, s56, 98304
    v_and_b32 v31, 3, v1
    v_lshl_add_u32 v31, v31, 11, s56
    s_mov_b32 s64, 30000
    buffer_load_dword v14, v31, s[36:39], 0 offen offset:0 sc1
    v_lshlrev_b32 v12, 7, v1
    s_lshl_b32 s6, s2, 11
    s_lshl_b32 s7, s47, 9
    s_add_u32 s6, s6, s7
    s_mov_b64 exec, 0xf
    buffer_load_dword v11, v12, s[12:15], s6 offen
    s_mov_b64 exec, -1
    s_lshr_b32 s57, s47, 1
    s_mul_i32 s79, s57, 44032
    s_mul_i32 s63, s49, 192
    s_add_u32 s79, s79, s63
    s_mul_i32 s80, s47, 3088
    v_cvt_pk_bf16_f32 v32, v64, v65
    v_cvt_pk_bf16_f32 v33, v66, v67
    v_cvt_pk_bf16_f32 v34, v68, v69
    v_cvt_pk_bf16_f32 v35, v70, v71
    v_cvt_pk_bf16_f32 v36, v72, v73
    v_cvt_pk_bf16_f32 v37, v74, v75
    v_cvt_pk_bf16_f32 v38, v76, v77
    v_cvt_pk_bf16_f32 v39, v78, v79
    v_mfma_f32_32x32x16_bf16 v[112:127], v[20:23], v[32:35], 0
    s_nop 0
    v_mfma_f32_32x32x16_bf16 v[96:111], v[24:27], v[36:39], 0
    v_cvt_pk_bf16_f32 v40, v80, v81
    v_cvt_pk_bf16_f32 v41, v82, v83
    v_cvt_pk_bf16_f32 v42, v84, v85
    v_cvt_pk_bf16_f32 v43, v86, v87
    v_cvt_pk_bf16_f32 v44, v88, v89
    v_cvt_pk_bf16_f32 v45, v90, v91
    v_cvt_pk_bf16_f32 v46, v92, v93
    v_cvt_pk_bf16_f32 v47, v94, v95
    ds_write_b128 v15, v[40:43] offset:16384
    ds_write_b128 v15, v[44:47] offset:16400
    v_max3_f32 v12, v112, v113, v114
    v_max3_f32 v13, v115, v116, v117
    v_max3_f32 v12, v12, v118, v119
    v_max3_f32 v13, v13, v120, v121
    v_max3_f32 v12, v12, v122, v123
    v_max3_f32 v13, v13, v124, v125
    v_max3_f32 v12, v12, v126, v127
    v_max_f32 v12, v12, v13
    v_pk_add_f32 v[112:113], v[112:113], v[12:13] op_sel_hi:[1,0] neg_lo:[0,1] neg_hi:[0,1]
    v_pk_add_f32 v[114:115], v[114:115], v[12:13] op_sel_hi:[1,0] neg_lo:[0,1] neg_hi:[0,1]
    v_pk_add_f32 v[116:117], v[116:117], v[12:13] op_sel_hi:[1,0] neg_lo:[0,1] neg_hi:[0,1]
    v_pk_add_f32 v[118:119], v[118:119], v[12:13] op_sel_hi:[1,0] neg_lo:[0,1] neg_hi:[0,1]
    v_pk_add_f32 v[120:121], v[120:121], v[12:13] op_sel_hi:[1,0] neg_lo:[0,1] neg_hi:[0,1]
    v_pk_add_f32 v[122:123], v[122:123], v[12:13] op_sel_hi:[1,0] neg_lo:[0,1] neg_hi:[0,1]
    v_pk_add_f32 v[124:125], v[124:125], v[12:13] op_sel_hi:[1,0] neg_lo:[0,1] neg_hi:[0,1]
    v_pk_add_f32 v[126:127], v[126:127], v[12:13] op_sel_hi:[1,0] neg_lo:[0,1] neg_hi:[0,1]
    v_pk_mul_f32 v[112:113], v[112:113], s[64:65] op_sel:[0,1]
    v_pk_mul_f32 v[114:115], v[114:115], s[64:65] op_sel:[0,1]
    v_pk_mul_f32 v[116:117], v[116:117], s[64:65] op_sel:[0,1]
    v_pk_mul_f32 v[118:119], v[118:119], s[64:65] op_sel:[0,1]
    v_pk_mul_f32 v[120:121], v[120:121], s[64:65] op_sel:[0,1]
    v_pk_mul_f32 v[122:123], v[122:123], s[64:65] op_sel:[0,1]
    v_pk_mul_f32 v[124:125], v[124:125], s[64:65] op_sel:[0,1]
    v_pk_mul_f32 v[126:127], v[126:127], s[64:65] op_sel:[0,1]
    v_exp_f32 v112, v112
    v_exp_f32 v113, v113
    v_exp_f32 v114, v114
    v_exp_f32 v115, v115
    v_exp_f32 v116, v116
    v_exp_f32 v117, v117
    v_exp_f32 v118, v118
    v_exp_f32 v119, v119
    v_exp_f32 v120, v120
    v_exp_f32 v121, v121
    v_exp_f32 v122, v122
    v_exp_f32 v123, v123
    v_exp_f32 v124, v124
    v_exp_f32 v125, v125
    v_exp_f32 v126, v126
    v_exp_f32 v127, v127
    v_pk_add_f32 v[12:13], v[112:113], v[114:115]
    v_pk_add_f32 v[16:17], v[116:117], v[118:119]
    v_pk_add_f32 v[12:13], v[12:13], v[120:121]
    v_pk_add_f32 v[16:17], v[16:17], v[122:123]
    v_pk_add_f32 v[12:13], v[12:13], v[124:125]
    v_pk_add_f32 v[16:17], v[16:17], v[126:127]
    v_pk_add_f32 v[12:13], v[12:13], v[16:17]
    v_add_f32 v12, v12, v13
    v_rcp_f32 v12, v12
    s_nop 0
    v_pk_mul_f32 v[112:113], v[112:113], v[12:13] op_sel_hi:[1,0]
    v_pk_mul_f32 v[114:115], v[114:115], v[12:13] op_sel_hi:[1,0]
    v_pk_mul_f32 v[116:117], v[116:117], v[12:13] op_sel_hi:[1,0]
    v_pk_mul_f32 v[118:119], v[118:119], v[12:13] op_sel_hi:[1,0]
    v_pk_mul_f32 v[120:121], v[120:121], v[12:13] op_sel_hi:[1,0]
    v_pk_mul_f32 v[122:123], v[122:123], v[12:13] op_sel_hi:[1,0]
    v_pk_mul_f32 v[124:125], v[124:125], v[12:13] op_sel_hi:[1,0]
    v_pk_mul_f32 v[126:127], v[126:127], v[12:13] op_sel_hi:[1,0]
    v_cvt_pk_bf16_f32 v32, v112, v113
    v_cvt_pk_bf16_f32 v33, v114, v115
    v_cvt_pk_bf16_f32 v34, v116, v117
    v_cvt_pk_bf16_f32 v35, v118, v119
    v_cvt_pk_bf16_f32 v36, v120, v121
    v_cvt_pk_bf16_f32 v37, v122, v123
    v_cvt_pk_bf16_f32 v38, v124, v125
    v_cvt_pk_bf16_f32 v39, v126, v127
    ds_write_b128 v15, v[32:35]
    ds_write_b128 v15, v[36:39] offset:16
    v_lshlrev_b32 v40, 7, v1
    s_lshl_b32 s6, s45, 18
    s_lshl_b32 s7, s46, 13
    s_add_u32 s6, s6, s7
    s_lshl_b32 s7, s47, 11
    s_add_u32 s6, s6, s7
    s_add_u32 s6, s6, 7340032
    s_mov_b64 exec, 0xffff
    buffer_load_dword v11, v40, s[36:39], s6 offen
    s_lshl_b32 s6, s45, 15
    s_lshl_b32 s7, s46, 10
    s_add_u32 s6, s6, s7
    s_lshl_b32 s7, s47, 8
    s_add_u32 s6, s6, s7
    s_add_u32 s6, s6, 524288
    s_mov_b64 exec, 0x3
    buffer_load_dword v11, v40, s[36:39], s6 offen
    s_mov_b64 exec, -1
    v_max3_f32 v12, v96, v97, v98
    v_max3_f32 v13, v99, v100, v101
    v_max3_f32 v12, v12, v102, v103
    v_max3_f32 v13, v13, v104, v105
    v_max3_f32 v12, v12, v106, v107
    v_max3_f32 v13, v13, v108, v109
    v_max3_f32 v12, v12, v110, v111
    v_max_f32 v12, v12, v13
    v_pk_add_f32 v[96:97], v[96:97], v[12:13] op_sel_hi:[1,0] neg_lo:[0,1] neg_hi:[0,1]
    v_pk_add_f32 v[98:99], v[98:99], v[12:13] op_sel_hi:[1,0] neg_lo:[0,1] neg_hi:[0,1]
    v_pk_add_f32 v[100:101], v[100:101], v[12:13] op_sel_hi:[1,0] neg_lo:[0,1] neg_hi:[0,1]
    v_pk_add_f32 v[102:103], v[102:103], v[12:13] op_sel_hi:[1,0] neg_lo:[0,1] neg_hi:[0,1]
    v_pk_add_f32 v[104:105], v[104:105], v[12:13] op_sel_hi:[1,0] neg_lo:[0,1] neg_hi:[0,1]
    v_pk_add_f32 v[106:107], v[106:107], v[12:13] op_sel_hi:[1,0] neg_lo:[0,1] neg_hi:[0,1]
    v_pk_add_f32 v[108:109], v[108:109], v[12:13] op_sel_hi:[1,0] neg_lo:[0,1] neg_hi:[0,1]
    v_pk_add_f32 v[110:111], v[110:111], v[12:13] op_sel_hi:[1,0] neg_lo:[0,1] neg_hi:[0,1]
    v_pk_mul_f32 v[96:97], v[96:97], s[64:65] op_sel:[0,1]
    v_pk_mul_f32 v[98:99], v[98:99], s[64:65] op_sel:[0,1]
    v_pk_mul_f32 v[100:101], v[100:101], s[64:65] op_sel:[0,1]
    v_pk_mul_f32 v[102:103], v[102:103], s[64:65] op_sel:[0,1]
    v_pk_mul_f32 v[104:105], v[104:105], s[64:65] op_sel:[0,1]
    v_pk_mul_f32 v[106:107], v[106:107], s[64:65] op_sel:[0,1]
    v_pk_mul_f32 v[108:109], v[108:109], s[64:65] op_sel:[0,1]
    v_pk_mul_f32 v[110:111], v[110:111], s[64:65] op_sel:[0,1]
    v_exp_f32 v96, v96
    v_exp_f32 v97, v97
    v_exp_f32 v98, v98
    v_exp_f32 v99, v99
    v_exp_f32 v100, v100
    v_exp_f32 v101, v101
    v_exp_f32 v102, v102
    v_exp_f32 v103, v103
    v_exp_f32 v104, v104
    v_exp_f32 v105, v105
    v_exp_f32 v106, v106
    v_exp_f32 v107, v107
    v_exp_f32 v108, v108
    v_exp_f32 v109, v109
    v_exp_f32 v110, v110
    v_exp_f32 v111, v111
    v_pk_add_f32 v[12:13], v[96:97], v[98:99]
    v_pk_add_f32 v[16:17], v[100:101], v[102:103]
    v_pk_add_f32 v[12:13], v[12:13], v[104:105]
    v_pk_add_f32 v[16:17], v[16:17], v[106:107]
    v_pk_add_f32 v[12:13], v[12:13], v[108:109]
    v_pk_add_f32 v[16:17], v[16:17], v[110:111]
    v_pk_add_f32 v[12:13], v[12:13], v[16:17]
    v_add_f32 v12, v12, v13
    v_rcp_f32 v12, v12
    s_nop 0
    v_pk_mul_f32 v[96:97], v[96:97], v[12:13] op_sel_hi:[1,0]
    v_pk_mul_f32 v[98:99], v[98:99], v[12:13] op_sel_hi:[1,0]
    v_pk_mul_f32 v[100:101], v[100:101], v[12:13] op_sel_hi:[1,0]
    v_pk_mul_f32 v[102:103], v[102:103], v[12:13] op_sel_hi:[1,0]
    v_pk_mul_f32 v[104:105], v[104:105], v[12:13] op_sel_hi:[1,0]
    v_pk_mul_f32 v[106:107], v[106:107], v[12:13] op_sel_hi:[1,0]
    v_pk_mul_f32 v[108:109], v[108:109], v[12:13] op_sel_hi:[1,0]
    v_pk_mul_f32 v[110:111], v[110:111], v[12:13] op_sel_hi:[1,0]
    v_cvt_pk_bf16_f32 v48, v96, v97
    v_cvt_pk_bf16_f32 v49, v98, v99
    v_cvt_pk_bf16_f32 v50, v100, v101
    v_cvt_pk_bf16_f32 v51, v102, v103
    v_cvt_pk_bf16_f32 v52, v104, v105
    v_cvt_pk_bf16_f32 v53, v106, v107
    v_cvt_pk_bf16_f32 v54, v108, v109
    v_cvt_pk_bf16_f32 v55, v110, v111
    ds_write_b128 v15, v[48:51] offset:8192
    ds_write_b128 v15, v[52:55] offset:8208
    s_lshl_b32 s56, s47, 12
    s_add_u32 s56, s56, 32768
    v_lshl_add_u32 v12, v1, 3, s56
    s_lshl_b32 s56, s57, 12
    s_add_u32 s56, s56, 49152
    v_lshl_add_u32 v13, v1, 3, s56
    v_mov_b32 v16, 0x3f803f80
    v_mov_b32 v17, 0x3f803f80
    v_mov_b32 v18, 0x3f803f80
    v_mov_b32 v19, 0x3f803f80
    s_waitcnt lgkmcnt(0)
    s_barrier
    ds_read_b64_tr_b16 v[64:65], v12 offset:0
    ds_read_b64_tr_b16 v[66:67], v12 offset:512
    ds_read_b64_tr_b16 v[68:69], v13 offset:0
    ds_read_b64_tr_b16 v[70:71], v13 offset:512
    ds_read_b64_tr_b16 v[72:73], v12 offset:1024
    ds_read_b64_tr_b16 v[74:75], v12 offset:1536
    ds_read_b64_tr_b16 v[76:77], v13 offset:1024
    ds_read_b64_tr_b16 v[78:79], v13 offset:1536
    ds_read_b64_tr_b16 v[80:81], v12 offset:2048
    ds_read_b64_tr_b16 v[82:83], v12 offset:2560
    ds_read_b64_tr_b16 v[84:85], v13 offset:2048
    ds_read_b64_tr_b16 v[86:87], v13 offset:2560
    ds_read_b64_tr_b16 v[88:89], v12 offset:3072
    ds_read_b64_tr_b16 v[90:91], v12 offset:3584
    ds_read_b64_tr_b16 v[92:93], v13 offset:3072
    ds_read_b64_tr_b16 v[94:95], v13 offset:3584
    s_lshl_b32 s82, s47, 16
    s_lshl_b32 s63, s51, 7
    s_add_u32 s82, s82, s63
    s_lshl_b32 s83, s47, 13
    s_waitcnt lgkmcnt(12)
    v_mfma_f32_16x16x32_bf16 v[112:115], v[64:67], v[68:71], 0
    v_mfma_f32_16x16x32_bf16 v[116:119], v[64:67], v[16:19], 0
    s_waitcnt lgkmcnt(8)
    v_mfma_f32_16x16x32_bf16 v[112:115], v[72:75], v[76:79], v[112:115]
    v_mfma_f32_16x16x32_bf16 v[116:119], v[72:75], v[16:19], v[116:119]
    s_waitcnt lgkmcnt(4)
    v_mfma_f32_16x16x32_bf16 v[112:115], v[80:83], v[84:87], v[112:115]
    v_mfma_f32_16x16x32_bf16 v[116:119], v[80:83], v[16:19], v[116:119]
    s_waitcnt lgkmcnt(0)
    v_mfma_f32_16x16x32_bf16 v[112:115], v[88:91], v[92:95], v[112:115]
    v_mfma_f32_16x16x32_bf16 v[116:119], v[88:91], v[16:19], v[116:119]
    s_nop 6
    v_cvt_pk_bf16_f32 v112, v112, v113
    v_cvt_pk_bf16_f32 v113, v114, v115
    v_cvt_pk_bf16_f32 v114, v116, v117
    v_cvt_pk_bf16_f32 v115, v118, v119
    s_nop 0
    v_permlane16_swap_b32 v112, v114
    v_permlane16_swap_b32 v113, v115
    s_mov_b32 exec_lo, 0x1ffff
    s_mov_b32 exec_hi, 0x1ffff
    buffer_store_dwordx4 v[112:115], v0, s[36:39], 0 offen sc1
    s_mov_b64 exec, -1
    s_cmp_eq_u32 s49, 15
    s_cselect_b32 s54, 0, s54
    s_add_u32 m0, s80, 131072
    s_add_u32 s81, s79, 0
    buffer_load_dwordx4 v28, s[52:55], s81 offen offset:0 lds
    s_waitcnt vmcnt(5)
PP_10:
    v_cmp_ne_u32 vcc, s44, v14
    s_cbranch_vccnz PR_12
PC_11:
    s_barrier
    ds_read_b64_tr_b16 v[32:33], v5 offset:0
    ds_read_b64_tr_b16 v[34:35], v5 offset:256
    ds_read_b64_tr_b16 v[36:37], v5 offset:1024
    ds_read_b64_tr_b16 v[38:39], v5 offset:1280
    ds_read_b64_tr_b16 v[40:41], v5 offset:2048
    ds_read_b64_tr_b16 v[42:43], v5 offset:2304
    ds_read_b64_tr_b16 v[44:45], v5 offset:3072
    ds_read_b64_tr_b16 v[46:47], v5 offset:3328
    ds_read_b64_tr_b16 v[48:49], v5 offset:4096
    ds_read_b64_tr_b16 v[50:51], v5 offset:4352
    s_waitcnt lgkmcnt(8)
    v_mfma_f32_32x32x16_bf16 v[96:111], v[32:35], v[128:131], 0
    buffer_load_dwordx4 v29, s[52:55], s81 offen offset:1024 lds
    ds_read_b64_tr_b16 v[52:53], v5 offset:5120
    ds_read_b64_tr_b16 v[54:55], v5 offset:5376
    s_waitcnt lgkmcnt(8)
    v_mfma_f32_32x32x16_bf16 v[96:111], v[36:39], v[132:135], v[96:111]
    ds_read_b64_tr_b16 v[32:33], v5 offset:6144
    ds_read_b64_tr_b16 v[34:35], v5 offset:6400
    s_waitcnt lgkmcnt(8)
    v_mfma_f32_32x32x16_bf16 v[96:111], v[40:43], v[136:139], v[96:111]
    ds_read_b64_tr_b16 v[36:37], v5 offset:7168
    ds_read_b64_tr_b16 v[38:39], v5 offset:7424
    s_waitcnt lgkmcnt(8)
    v_mfma_f32_32x32x16_bf16 v[96:111], v[44:47], v[140:143], v[96:111]
    buffer_load_dwordx4 v30, s[52:55], s81 offen offset:2048 lds
    ds_read_b64_tr_b16 v[40:41], v5 offset:8192
    ds_read_b64_tr_b16 v[42:43], v5 offset:8448
    s_waitcnt lgkmcnt(8)
    v_mfma_f32_32x32x16_bf16 v[96:111], v[48:51], v[144:147], v[96:111]
    ds_read_b64_tr_b16 v[44:45], v5 offset:9216
    ds_read_b64_tr_b16 v[46:47], v5 offset:9472
    s_waitcnt lgkmcnt(8)
    v_mfma_f32_32x32x16_bf16 v[96:111], v[52:55], v[148:151], v[96:111]
    ds_read_b64_tr_b16 v[48:49], v5 offset:10240
    ds_read_b64_tr_b16 v[50:51], v5 offset:10496
    s_waitcnt lgkmcnt(8)
    v_mfma_f32_32x32x16_bf16 v[96:111], v[32:35], v[152:155], v[96:111]
    s_add_u32 m0, s80, 143424
    s_add_u32 s81, s79, 88064
    buffer_load_dwordx4 v28, s[52:55], s81 offen offset:0 lds
    ds_read_b64_tr_b16 v[52:53], v5 offset:11264
    ds_read_b64_tr_b16 v[54:55], v5 offset:11520
    s_waitcnt lgkmcnt(8)
    v_mfma_f32_32x32x16_bf16 v[96:111], v[36:39], v[156:159], v[96:111]
    ds_read_b64_tr_b16 v[32:33], v5 offset:12288
    ds_read_b64_tr_b16 v[34:35], v5 offset:12544
    s_waitcnt lgkmcnt(8)
    v_mfma_f32_32x32x16_bf16 v[96:111], v[40:43], v[160:163], v[96:111]
    ds_read_b64_tr_b16 v[36:37], v5 offset:13312
    ds_read_b64_tr_b16 v[38:39], v5 offset:13568
    s_waitcnt lgkmcnt(8)
    v_mfma_f32_32x32x16_bf16 v[96:111], v[44:47], v[164:167], v[96:111]
    buffer_load_dwordx4 v29, s[52:55], s81 offen offset:1024 lds
    ds_read_b64_tr_b16 v[40:41], v5 offset:14336
    ds_read_b64_tr_b16 v[42:43], v5 offset:14592
    s_waitcnt lgkmcnt(8)
    v_mfma_f32_32x32x16_bf16 v[96:111], v[48:51], v[168:171], v[96:111]
    ds_read_b64_tr_b16 v[44:45], v5 offset:15360
    ds_read_b64_tr_b16 v[46:47], v5 offset:15616
    s_waitcnt lgkmcnt(8)
    v_mfma_f32_32x32x16_bf16 v[96:111], v[52:55], v[172:175], v[96:111]
    ds_read_b64_tr_b16 v[48:49], v5 offset:16384
    ds_read_b64_tr_b16 v[50:51], v5 offset:16640
    s_waitcnt lgkmcnt(8)
    v_mfma_f32_32x32x16_bf16 v[96:111], v[32:35], v[176:179], v[96:111]
    buffer_load_dwordx4 v30, s[52:55], s81 offen offset:2048 lds
    ds_read_b64_tr_b16 v[52:53], v5 offset:17408
    ds_read_b64_tr_b16 v[54:55], v5 offset:17664
    s_waitcnt lgkmcnt(8)
    v_mfma_f32_32x32x16_bf16 v[96:111], v[36:39], v[180:183], v[96:111]
    ds_read_b64_tr_b16 v[32:33], v5 offset:18432
    ds_read_b64_tr_b16 v[34:35], v5 offset:18688
    s_waitcnt lgkmcnt(8)
    v_mfma_f32_32x32x16_bf16 v[96:111], v[40:43], v[184:187], v[96:111]
    ds_read_b64_tr_b16 v[36:37], v5 offset:19456
    ds_read_b64_tr_b16 v[38:39], v5 offset:19712
    s_waitcnt lgkmcnt(8)
    v_mfma_f32_32x32x16_bf16 v[96:111], v[44:47], v[188:191], v[96:111]
    s_add_u32 m0, s80, 65536
    s_add_u32 s81, s79, 176128
    buffer_load_dwordx4 v28, s[52:55], s81 offen offset:0 lds
    ds_read_b64_tr_b16 v[40:41], v5 offset:20480
    ds_read_b64_tr_b16 v[42:43], v5 offset:20736
    s_waitcnt lgkmcnt(8)
    v_mfma_f32_32x32x16_bf16 v[96:111], v[48:51], v[192:195], v[96:111]
    ds_read_b64_tr_b16 v[44:45], v5 offset:21504
    ds_read_b64_tr_b16 v[46:47], v5 offset:21760
    s_waitcnt lgkmcnt(8)
    v_mfma_f32_32x32x16_bf16 v[96:111], v[52:55], v[196:199], v[96:111]
    ds_read_b64_tr_b16 v[48:49], v5 offset:22528
    ds_read_b64_tr_b16 v[50:51], v5 offset:22784
    s_waitcnt lgkmcnt(8)
    v_mfma_f32_32x32x16_bf16 v[96:111], v[32:35], v[200:203], v[96:111]
    buffer_load_dwordx4 v29, s[52:55], s81 offen offset:1024 lds
    ds_read_b64_tr_b16 v[52:53], v5 offset:23552
    ds_read_b64_tr_b16 v[54:55], v5 offset:23808
    s_waitcnt lgkmcnt(8)
    v_mfma_f32_32x32x16_bf16 v[96:111], v[36:39], v[204:207], v[96:111]
    ds_read_b64_tr_b16 v[32:33], v5 offset:24576
    ds_read_b64_tr_b16 v[34:35], v5 offset:24832
    s_waitcnt lgkmcnt(8)
    v_mfma_f32_32x32x16_bf16 v[96:111], v[40:43], v[208:211], v[96:111]
    ds_read_b64_tr_b16 v[36:37], v5 offset:25600
    ds_read_b64_tr_b16 v[38:39], v5 offset:25856
    s_waitcnt lgkmcnt(8)
    v_mfma_f32_32x32x16_bf16 v[96:111], v[44:47], v[212:215], v[96:111]
    buffer_load_dwordx4 v30, s[52:55], s81 offen offset:2048 lds
    ds_read_b64_tr_b16 v[40:41], v5 offset:26624
    ds_read_b64_tr_b16 v[42:43], v5 offset:26880
    s_waitcnt lgkmcnt(8)
    v_mfma_f32_32x32x16_bf16 v[96:111], v[48:51], v[216:219], v[96:111]
    ds_read_b64_tr_b16 v[44:45], v5 offset:27648
    ds_read_b64_tr_b16 v[46:47], v5 offset:27904
    s_waitcnt lgkmcnt(8)
    v_mfma_f32_32x32x16_bf16 v[96:111], v[52:55], v[220:223], v[96:111]
    ds_read_b64_tr_b16 v[48:49], v5 offset:28672
    ds_read_b64_tr_b16 v[50:51], v5 offset:28928
    s_waitcnt lgkmcnt(8)
    v_mfma_f32_32x32x16_bf16 v[96:111], v[32:35], v[224:227], v[96:111]
    s_add_u32 m0, s80, 77888
    s_add_u32 s81, s79, 264192
    buffer_load_dwordx4 v28, s[52:55], s81 offen offset:0 lds
    ds_read_b64_tr_b16 v[52:53], v5 offset:29696
    ds_read_b64_tr_b16 v[54:55], v5 offset:29952
    s_waitcnt lgkmcnt(8)
    v_mfma_f32_32x32x16_bf16 v[96:111], v[36:39], v[228:231], v[96:111]
    ds_read_b64_tr_b16 v[32:33], v5 offset:30720
    ds_read_b64_tr_b16 v[34:35], v5 offset:30976
    s_waitcnt lgkmcnt(8)
    v_mfma_f32_32x32x16_bf16 v[96:111], v[40:43], v[232:235], v[96:111]
    ds_read_b64_tr_b16 v[36:37], v5 offset:31744
    ds_read_b64_tr_b16 v[38:39], v5 offset:32000
    s_waitcnt lgkmcnt(8)
    v_mfma_f32_32x32x16_bf16 v[96:111], v[44:47], v[236:239], v[96:111]
    buffer_load_dwordx4 v29, s[52:55], s81 offen offset:1024 lds
    s_waitcnt lgkmcnt(6)
    v_mfma_f32_32x32x16_bf16 v[96:111], v[48:51], v[240:243], v[96:111]
    s_waitcnt lgkmcnt(4)
    v_mfma_f32_32x32x16_bf16 v[96:111], v[52:55], v[244:247], v[96:111]
    s_waitcnt lgkmcnt(2)
    v_mfma_f32_32x32x16_bf16 v[96:111], v[32:35], v[248:251], v[96:111]
    buffer_load_dwordx4 v30, s[52:55], s81 offen offset:2048 lds
    s_waitcnt lgkmcnt(0)
    v_mfma_f32_32x32x16_bf16 v[96:111], v[36:39], v[252:255], v[96:111]
    s_lshl_b32 s61, s49, 2
    s_add_u32 s61, s61, s47
    s_lshl_b32 s56, s61, 13
    s_add_u32 s56, s56, 1048576
    s_add_u32 s57, s56, 4096
    s_lshl_b32 s58, s49, 11
    s_lshl_b32 s63, s47, 5
    s_add_u32 s58, s58, s63
    s_add_u32 s58, s58, 262144
    v_lshrrev_b32 v14, 1, v10
    v_lshl_add_u32 v14, v8, 3, v14
    v_and_b32 v15, 1, v1
    v_lshlrev_b32 v15, 4, v15
    v_lshl_add_u32 v14, v14, 7, v15
    v_cvt_pk_bf16_f32 v32, v96, v97
    v_cvt_pk_bf16_f32 v33, v98, v99
    v_cvt_pk_bf16_f32 v34, v100, v101
    v_cvt_pk_bf16_f32 v35, v102, v103
    v_cvt_pk_bf16_f32 v36, v104, v105
    v_cvt_pk_bf16_f32 v37, v106, v107
    v_cvt_pk_bf16_f32 v38, v108, v109
    v_cvt_pk_bf16_f32 v39, v110, v111
    v_mfma_f32_32x32x16_bf16 v[112:127], v[20:23], v[32:35], 0
    s_nop 0
    v_mfma_f32_32x32x16_bf16 v[64:79], v[24:27], v[36:39], 0
    v_mov_b32 v160, 0
    v_mov_b32 v161, 0
    v_mov_b32 v162, 0
    v_mov_b32 v163, 0
    s_nop 5
    v_max3_f32 v12, v112, v113, v114
    v_max3_f32 v13, v115, v116, v117
    v_max3_f32 v12, v12, v118, v119
    v_max3_f32 v13, v13, v120, v121
    v_max3_f32 v12, v12, v122, v123
    v_max3_f32 v13, v13, v124, v125
    v_max3_f32 v12, v12, v126, v127
    v_max_f32 v12, v12, v13
    v_pk_add_f32 v[112:113], v[112:113], v[12:13] op_sel_hi:[1,0] neg_lo:[0,1] neg_hi:[0,1]
    v_pk_add_f32 v[114:115], v[114:115], v[12:13] op_sel_hi:[1,0] neg_lo:[0,1] neg_hi:[0,1]
    v_pk_add_f32 v[116:117], v[116:117], v[12:13] op_sel_hi:[1,0] neg_lo:[0,1] neg_hi:[0,1]
    v_pk_add_f32 v[118:119], v[118:119], v[12:13] op_sel_hi:[1,0] neg_lo:[0,1] neg_hi:[0,1]
    v_pk_add_f32 v[120:121], v[120:121], v[12:13] op_sel_hi:[1,0] neg_lo:[0,1] neg_hi:[0,1]
    v_pk_add_f32 v[122:123], v[122:123], v[12:13] op_sel_hi:[1,0] neg_lo:[0,1] neg_hi:[0,1]
    v_pk_add_f32 v[124:125], v[124:125], v[12:13] op_sel_hi:[1,0] neg_lo:[0,1] neg_hi:[0,1]
    v_pk_add_f32 v[126:127], v[126:127], v[12:13] op_sel_hi:[1,0] neg_lo:[0,1] neg_hi:[0,1]
    v_pk_mul_f32 v[112:113], v[112:113], s[64:65] op_sel:[0,1]
    v_pk_mul_f32 v[114:115], v[114:115], s[64:65] op_sel:[0,1]
    v_pk_mul_f32 v[116:117], v[116:117], s[64:65] op_sel:[0,1]
    v_pk_mul_f32 v[118:119], v[118:119], s[64:65] op_sel:[0,1]
    v_pk_mul_f32 v[120:121], v[120:121], s[64:65] op_sel:[0,1]
    v_pk_mul_f32 v[122:123], v[122:123], s[64:65] op_sel:[0,1]
    v_pk_mul_f32 v[124:125], v[124:125], s[64:65] op_sel:[0,1]
    v_pk_mul_f32 v[126:127], v[126:127], s[64:65] op_sel:[0,1]
    v_exp_f32 v112, v112
    v_exp_f32 v113, v113
    v_exp_f32 v114, v114
    v_exp_f32 v115, v115
    v_exp_f32 v116, v116
    v_exp_f32 v117, v117
    v_exp_f32 v118, v118
    v_exp_f32 v119, v119
    v_exp_f32 v120, v120
    v_exp_f32 v121, v121
    v_exp_f32 v122, v122
    v_exp_f32 v123, v123
    v_exp_f32 v124, v124
    v_exp_f32 v125, v125
    v_exp_f32 v126, v126
    v_exp_f32 v127, v127
    v_pk_add_f32 v[12:13], v[112:113], v[114:115]
    v_pk_add_f32 v[16:17], v[116:117], v[118:119]
    v_pk_add_f32 v[12:13], v[12:13], v[120:121]
    v_pk_add_f32 v[16:17], v[16:17], v[122:123]
    v_pk_add_f32 v[12:13], v[12:13], v[124:125]
    v_pk_add_f32 v[16:17], v[16:17], v[126:127]
    v_pk_add_f32 v[12:13], v[12:13], v[16:17]
    v_add_f32 v12, v12, v13
    v_rcp_f32 v12, v12
    s_nop 0
    v_pk_mul_f32 v[112:113], v[112:113], v[12:13] op_sel_hi:[1,0]
    v_pk_mul_f32 v[114:115], v[114:115], v[12:13] op_sel_hi:[1,0]
    v_pk_mul_f32 v[116:117], v[116:117], v[12:13] op_sel_hi:[1,0]
    v_pk_mul_f32 v[118:119], v[118:119], v[12:13] op_sel_hi:[1,0]
    v_pk_mul_f32 v[120:121], v[120:121], v[12:13] op_sel_hi:[1,0]
    v_pk_mul_f32 v[122:123], v[122:123], v[12:13] op_sel_hi:[1,0]
    v_pk_mul_f32 v[124:125], v[124:125], v[12:13] op_sel_hi:[1,0]
    v_pk_mul_f32 v[126:127], v[126:127], v[12:13] op_sel_hi:[1,0]
    v_cvt_pk_bf16_f32 v40, v112, v113
    v_cvt_pk_bf16_f32 v41, v114, v115
    v_cvt_pk_bf16_f32 v42, v116, v117
    v_cvt_pk_bf16_f32 v43, v118, v119
    v_cvt_pk_bf16_f32 v44, v120, v121
    v_cvt_pk_bf16_f32 v45, v122, v123
    v_cvt_pk_bf16_f32 v46, v124, v125
    v_cvt_pk_bf16_f32 v47, v126, v127
    v_max3_f32 v12, v64, v65, v66
    v_max3_f32 v13, v67, v68, v69
    v_max3_f32 v12, v12, v70, v71
    v_max3_f32 v13, v13, v72, v73
    v_max3_f32 v12, v12, v74, v75
    v_max3_f32 v13, v13, v76, v77
    v_max3_f32 v12, v12, v78, v79
    v_max_f32 v12, v12, v13
    v_pk_add_f32 v[64:65], v[64:65], v[12:13] op_sel_hi:[1,0] neg_lo:[0,1] neg_hi:[0,1]
    v_pk_add_f32 v[66:67], v[66:67], v[12:13] op_sel_hi:[1,0] neg_lo:[0,1] neg_hi:[0,1]
    v_pk_add_f32 v[68:69], v[68:69], v[12:13] op_sel_hi:[1,0] neg_lo:[0,1] neg_hi:[0,1]
    v_pk_add_f32 v[70:71], v[70:71], v[12:13] op_sel_hi:[1,0] neg_lo:[0,1] neg_hi:[0,1]
    v_pk_add_f32 v[72:73], v[72:73], v[12:13] op_sel_hi:[1,0] neg_lo:[0,1] neg_hi:[0,1]
    v_pk_add_f32 v[74:75], v[74:75], v[12:13] op_sel_hi:[1,0] neg_lo:[0,1] neg_hi:[0,1]
    v_pk_add_f32 v[76:77], v[76:77], v[12:13] op_sel_hi:[1,0] neg_lo:[0,1] neg_hi:[0,1]
    v_pk_add_f32 v[78:79], v[78:79], v[12:13] op_sel_hi:[1,0] neg_lo:[0,1] neg_hi:[0,1]
    v_pk_mul_f32 v[64:65], v[64:65], s[64:65] op_sel:[0,1]
    v_pk_mul_f32 v[66:67], v[66:67], s[64:65] op_sel:[0,1]
    v_pk_mul_f32 v[68:69], v[68:69], s[64:65] op_sel:[0,1]
    v_pk_mul_f32 v[70:71], v[70:71], s[64:65] op_sel:[0,1]
    v_pk_mul_f32 v[72:73], v[72:73], s[64:65] op_sel:[0,1]
    s_mov_b32 s64, 30000
    s_mov_b32 exec_lo, 0xffff
    s_mov_b32 exec_hi, 0xffff
    buffer_load_dwordx4 v[160:163], v14, s[36:39], s58 offen sc1
    s_mov_b64 exec, -1
    buffer_load_dwordx4 v[128:131], v2, s[36:39], s56 offen offset:0 sc1
    buffer_load_dwordx4 v[132:135], v2, s[36:39], s56 offen offset:1024 sc1
    buffer_load_dwordx4 v[136:139], v2, s[36:39], s56 offen offset:2048 sc1
    buffer_load_dwordx4 v[140:143], v2, s[36:39], s56 offen offset:3072 sc1
    buffer_load_dwordx4 v[144:147], v2, s[36:39], s57 offen offset:0 sc1
    buffer_load_dwordx4 v[148:151], v2, s[36:39], s57 offen offset:1024 sc1
    buffer_load_dwordx4 v[152:155], v2, s[36:39], s57 offen offset:2048 sc1
    buffer_load_dwordx4 v[156:159], v2, s[36:39], s57 offen offset:3072 sc1
    v_pk_mul_f32 v[74:75], v[74:75], s[64:65] op_sel:[0,1]
    v_pk_mul_f32 v[76:77], v[76:77], s[64:65] op_sel:[0,1]
    v_pk_mul_f32 v[78:79], v[78:79], s[64:65] op_sel:[0,1]
    v_exp_f32 v64, v64
    s_add_u32 m0, s80, 90240
    s_add_u32 s81, s79, 352256
    buffer_load_dwordx4 v28, s[52:55], s81 offen offset:0 lds
    v_exp_f32 v65, v65
    v_exp_f32 v66, v66
    v_exp_f32 v67, v67
    v_exp_f32 v68, v68
    v_exp_f32 v69, v69
    v_exp_f32 v70, v70
    v_exp_f32 v71, v71
    v_exp_f32 v72, v72
    v_exp_f32 v73, v73
    v_exp_f32 v74, v74
    v_exp_f32 v75, v75
    v_exp_f32 v76, v76
    buffer_load_dwordx4 v29, s[52:55], s81 offen offset:1024 lds
    v_exp_f32 v77, v77
    v_exp_f32 v78, v78
    v_exp_f32 v79, v79
    v_pk_add_f32 v[12:13], v[64:65], v[66:67]
    v_pk_add_f32 v[16:17], v[68:69], v[70:71]
    v_pk_add_f32 v[12:13], v[12:13], v[72:73]
    v_pk_add_f32 v[16:17], v[16:17], v[74:75]
    v_pk_add_f32 v[12:13], v[12:13], v[76:77]
    v_pk_add_f32 v[16:17], v[16:17], v[78:79]
    v_pk_add_f32 v[12:13], v[12:13], v[16:17]
    v_add_f32 v12, v12, v13
    v_rcp_f32 v12, v12
    buffer_load_dwordx4 v30, s[52:55], s81 offen offset:2048 lds
    v_pk_mul_f32 v[64:65], v[64:65], v[12:13] op_sel_hi:[1,0]
    v_pk_mul_f32 v[66:67], v[66:67], v[12:13] op_sel_hi:[1,0]
    v_pk_mul_f32 v[68:69], v[68:69], v[12:13] op_sel_hi:[1,0]
    v_pk_mul_f32 v[70:71], v[70:71], v[12:13] op_sel_hi:[1,0]
    v_pk_mul_f32 v[72:73], v[72:73], v[12:13] op_sel_hi:[1,0]
    v_pk_mul_f32 v[74:75], v[74:75], v[12:13] op_sel_hi:[1,0]
    v_pk_mul_f32 v[76:77], v[76:77], v[12:13] op_sel_hi:[1,0]
    v_pk_mul_f32 v[78:79], v[78:79], v[12:13] op_sel_hi:[1,0]
    v_cvt_pk_bf16_f32 v48, v64, v65
    v_cvt_pk_bf16_f32 v49, v66, v67
    v_cvt_pk_bf16_f32 v50, v68, v69
    v_cvt_pk_bf16_f32 v51, v70, v71
    s_add_u32 m0, s80, 102592
    s_add_u32 s81, s79, 440320
    buffer_load_dwordx4 v28, s[52:55], s81 offen offset:0 lds
    v_cvt_pk_bf16_f32 v52, v72, v73
    v_cvt_pk_bf16_f32 v53, v74, v75
    v_cvt_pk_bf16_f32 v54, v76, v77
    v_cvt_pk_bf16_f32 v55, v78, v79
    s_mul_i32 s62, s47, 576
    s_add_u32 s62, s62, 161280
    v_lshl_add_u32 v16, v9, 3, s62
    v_lshl_add_u32 v17, v10, 5, v16
    v_lshl_add_u32 v16, v8, 4, v16
    v_add_u32 v16, v16, v15
    v_bfe_u32 v12, v1, 2, 1
    v_bfe_u32 v13, v1, 3, 1
    buffer_load_dwordx4 v29, s[52:55], s81 offen offset:1024 lds
    v_and_b32 v18, 3, v1
    v_lshl_add_u32 v18, v12, 3, v18
    v_lshl_add_u32 v18, v13, 2, v18
    v_cmp_lt_u32 vcc, 15, v7
    s_nop 1
    v_cndmask_b32 v18, v18, 16, vcc
    v_lshlrev_b32 v18, 5, v18
    v_mul_u32_u24 v12, 576, v8
    v_add_u32 v12, 161280, v12
    v_add_u32 v18, v18, v12
    buffer_load_dwordx4 v30, s[52:55], s81 offen offset:2048 lds
    s_add_u32 m0, s80, 114944
    s_add_u32 s81, s79, 528384
    buffer_load_dwordx4 v28, s[52:55], s81 offen offset:0 lds
    buffer_load_dwordx4 v29, s[52:55], s81 offen offset:1024 lds
    buffer_load_dwordx4 v30, s[52:55], s81 offen offset:2048 lds
    s_waitcnt vmcnt(9)
PP_13:
    v_mfma_f32_16x16x32_bf16 v[116:119], v[56:59], v[160:163], 0
    v_mfma_f32_16x16x32_bf16 v[112:115], v[56:59], v[128:131], 0
    v_max3_u32 v12, v128, v132, v136
    v_mfma_f32_16x16x32_bf16 v[112:115], v[56:59], v[132:135], v[112:115]
    v_max3_u32 v12, v12, v140, v144
    v_mfma_f32_16x16x32_bf16 v[112:115], v[56:59], v[136:139], v[112:115]
    v_max3_u32 v12, v12, v148, v152
    v_mfma_f32_16x16x32_bf16 v[112:115], v[56:59], v[140:143], v[112:115]
    v_max3_u32 v12, v12, v156, v160
    v_add_f32_dpp v116, v116, v116 row_ror:2 row_mask:0xf bank_mask:0xf
    v_add_f32_dpp v117, v117, v117 row_ror:2 row_mask:0xf bank_mask:0xf
    v_add_f32_dpp v118, v118, v118 row_ror:2 row_mask:0xf bank_mask:0xf
    v_add_f32_dpp v119, v119, v119 row_ror:2 row_mask:0xf bank_mask:0xf
    v_mfma_f32_16x16x32_bf16 v[112:115], v[56:59], v[144:147], v[112:115]
    v_add_f32_dpp v116, v116, v116 row_ror:4 row_mask:0xf bank_mask:0xf
    v_add_f32_dpp v117, v117, v117 row_ror:4 row_mask:0xf bank_mask:0xf
    v_add_f32_dpp v118, v118, v118 row_ror:4 row_mask:0xf bank_mask:0xf
    v_add_f32_dpp v119, v119, v119 row_ror:4 row_mask:0xf bank_mask:0xf
    v_mfma_f32_16x16x32_bf16 v[112:115], v[56:59], v[148:151], v[112:115]
    v_add_f32_dpp v116, v116, v116 row_ror:8 row_mask:0xf bank_mask:0xf
    v_add_f32_dpp v117, v117, v117 row_ror:8 row_mask:0xf bank_mask:0xf
    v_add_f32_dpp v118, v118, v118 row_ror:8 row_mask:0xf bank_mask:0xf
    v_add_f32_dpp v119, v119, v119 row_ror:8 row_mask:0xf bank_mask:0xf
    v_mfma_f32_16x16x32_bf16 v[112:115], v[56:59], v[152:155], v[112:115]
    v_mfma_f32_16x16x32_bf16 v[112:115], v[56:59], v[156:159], v[112:115]
    v_cvt_pk_bf16_f32 v116, v116, v117
    v_cvt_pk_bf16_f32 v117, v118, v119
    v_cmp_eq_u32 vcc, -1, v12
    s_cbranch_vccnz PR_15
PC_14:
    ds_write_b64 v16, v[116:117] offset:512
    s_nop 2
    v_cvt_pk_bf16_f32 v112, v112, v113
    v_cvt_pk_bf16_f32 v113, v114, v115
    ds_write_b64 v17, v[112:113]
    s_waitcnt lgkmcnt(0)
    s_barrier
    ds_read_b128 v[64:67], v18 offset:0
    ds_read_b128 v[68:71], v18 offset:16
    ds_read_b128 v[72:75], v18 offset:1152
    ds_read_b128 v[76:79], v18 offset:1168
    s_waitcnt lgkmcnt(3)
    v_mfma_f32_32x32x16_bf16 v[96:111], v[64:67], v[40:43], 0
    s_waitcnt lgkmcnt(2)
    v_mfma_f32_32x32x16_bf16 v[96:111], v[68:71], v[44:47], v[96:111]
    s_waitcnt lgkmcnt(1)
    v_mfma_f32_32x32x16_bf16 v[112:127], v[72:75], v[48:51], 0
    s_waitcnt lgkmcnt(0)
    v_mfma_f32_32x32x16_bf16 v[112:127], v[76:79], v[52:55], v[112:127]
    s_nop 7
    v_add_f32 v104, 0x358637bd, v104
    v_rcp_f32 v104, v104
    s_nop 0
    v_pk_mul_f32 v[96:97], v[96:97], v[104:105] op_sel_hi:[1,0]
    v_pk_mul_f32 v[98:99], v[98:99], v[104:105] op_sel_hi:[1,0]
    v_pk_mul_f32 v[100:101], v[100:101], v[104:105] op_sel_hi:[1,0]
    v_pk_mul_f32 v[102:103], v[102:103], v[104:105] op_sel_hi:[1,0]
    v_cvt_pk_bf16_f32 v32, v96, v97
    v_cvt_pk_bf16_f32 v33, v98, v99
    v_cvt_pk_bf16_f32 v34, v100, v101
    v_cvt_pk_bf16_f32 v35, v102, v103
    buffer_store_dwordx4 v[32:35], v2, s[36:39], s60 offen offset:0
    v_add_f32 v120, 0x358637bd, v120
    v_rcp_f32 v120, v120
    s_nop 0
    v_pk_mul_f32 v[112:113], v[112:113], v[120:121] op_sel_hi:[1,0]
    v_pk_mul_f32 v[114:115], v[114:115], v[120:121] op_sel_hi:[1,0]
    v_pk_mul_f32 v[116:117], v[116:117], v[120:121] op_sel_hi:[1,0]
    v_pk_mul_f32 v[118:119], v[118:119], v[120:121] op_sel_hi:[1,0]
    v_cvt_pk_bf16_f32 v36, v112, v113
    v_cvt_pk_bf16_f32 v37, v114, v115
    v_cvt_pk_bf16_f32 v38, v116, v117
    v_cvt_pk_bf16_f32 v39, v118, v119
    buffer_store_dwordx4 v[36:39], v2, s[36:39], s60 offen offset:1024
    s_add_u32 m0, s83, 32768
    s_add_u32 s81, s82, 262144
    buffer_load_dwordx4 v62, s[12:15], s81 offen offset:0 lds
    v_and_b32 v12, 1, v1
    v_lshlrev_b32 v12, 10, v12
    v_sub_u32 v12, 158208, v12
    v_lshl_add_u32 v12, v9, 4, v12
    ds_read_b128 v[80:83], v12 offset:0
    ds_read_b128 v[84:87], v12 offset:64
    ds_read_b128 v[88:91], v12 offset:128
    ds_read_b128 v[92:95], v12 offset:192
    v_add_u32 v12, 131072, v60
    s_add_u32 s81, s82, 269312
    buffer_load_dwordx4 v62, s[12:15], s81 offen offset:1024 lds
    v_add_u32 v13, 131072, v61
    ds_read_b64_tr_b16 a[0:1], v12 offset:0
    ds_read_b64_tr_b16 a[2:3], v12 offset:768
    ds_read_b64_tr_b16 a[4:5], v12 offset:3088
    ds_read_b64_tr_b16 a[6:7], v12 offset:3856
    ds_read_b64_tr_b16 a[8:9], v13 offset:0
    ds_read_b64_tr_b16 a[10:11], v13 offset:768
    ds_read_b64_tr_b16 a[12:13], v12 offset:12352
    ds_read_b64_tr_b16 a[14:15], v12 offset:13120
    s_add_u32 s81, s82, 276480
    buffer_load_dwordx4 v62, s[12:15], s81 offen offset:2048 lds
    ds_read_b64_tr_b16 a[16:17], v12 offset:15440
    ds_read_b64_tr_b16 a[18:19], v12 offset:16208
    ds_read_b64_tr_b16 a[20:21], v13 offset:12352
    ds_read_b64_tr_b16 a[22:23], v13 offset:13120
    v_add_u32 v12, 65536, v60
    v_add_u32 v13, 65536, v61
    ds_read_b64_tr_b16 a[24:25], v12 offset:0
    ds_read_b64_tr_b16 a[26:27], v12 offset:768
    ds_read_b64_tr_b16 a[28:29], v12 offset:3088
    s_add_u32 s81, s82, 283648
    buffer_load_dwordx4 v62, s[12:15], s81 offen offset:3072 lds
    ds_read_b64_tr_b16 a[30:31], v12 offset:3856
    ds_read_b64_tr_b16 a[32:33], v13 offset:0
    ds_read_b64_tr_b16 a[34:35], v13 offset:768
    s_waitcnt lgkmcnt(12)
    v_mfma_f32_16x16x32_bf16 v[116:119], v[80:83], a[0:3], 0
    v_mfma_f32_16x16x32_bf16 v[120:123], v[80:83], a[4:7], 0
    v_mfma_f32_16x16x32_bf16 v[124:127], v[80:83], a[8:11], 0
    ds_read_b64_tr_b16 a[36:37], v12 offset:12352
    ds_read_b64_tr_b16 a[38:39], v12 offset:13120
    ds_read_b64_tr_b16 a[40:41], v12 offset:15440
    s_add_u32 m0, s83, 36864
    s_add_u32 s81, s82, 294912
    buffer_load_dwordx4 v62, s[12:15], s81 offen offset:0 lds
    ds_read_b64_tr_b16 a[42:43], v12 offset:16208
    ds_read_b64_tr_b16 a[44:45], v13 offset:12352
    ds_read_b64_tr_b16 a[46:47], v13 offset:13120
    s_waitcnt lgkmcnt(12)
    v_mfma_f32_16x16x32_bf16 v[116:119], v[84:87], a[12:15], v[116:119]
    v_mfma_f32_16x16x32_bf16 v[120:123], v[84:87], a[16:19], v[120:123]
    v_mfma_f32_16x16x32_bf16 v[124:127], v[84:87], a[20:23], v[124:127]
    s_waitcnt lgkmcnt(6)
    v_mfma_f32_16x16x32_bf16 v[116:119], v[88:91], a[24:27], v[116:119]
    v_mfma_f32_16x16x32_bf16 v[120:123], v[88:91], a[28:31], v[120:123]
    v_mfma_f32_16x16x32_bf16 v[124:127], v[88:91], a[32:35], v[124:127]
    s_add_u32 s81, s82, 302080
    buffer_load_dwordx4 v62, s[12:15], s81 offen offset:1024 lds
    s_waitcnt lgkmcnt(0)
    v_mfma_f32_16x16x32_bf16 v[116:119], v[92:95], a[36:39], v[116:119]
    v_mfma_f32_16x16x32_bf16 v[120:123], v[92:95], a[40:43], v[120:123]
    v_mfma_f32_16x16x32_bf16 v[124:127], v[92:95], a[44:47], v[124:127]
    s_waitcnt vmcnt(6)
    s_mov_b64 exec, 1
    buffer_store_dword v3, off, s[36:39], s59 offset:1024
    s_mov_b64 exec, -1
    s_add_u32 s81, s82, 309248
    buffer_load_dwordx4 v62, s[12:15], s81 offen offset:2048 lds
    s_add_u32 s81, s82, 316416
    buffer_load_dwordx4 v62, s[12:15], s81 offen offset:3072 lds
    s_add_u32 m0, s83, 0
    s_add_u32 s81, s82, 0
    buffer_load_dwordx4 v62, s[12:15], s81 offen offset:0 lds
    s_add_u32 s81, s82, 7168
    buffer_load_dwordx4 v62, s[12:15], s81 offen offset:1024 lds
    s_add_u32 s81, s82, 14336
    buffer_load_dwordx4 v62, s[12:15], s81 offen offset:2048 lds
    s_add_u32 s81, s82, 21504
    buffer_load_dwordx4 v62, s[12:15], s81 offen offset:3072 lds
    s_add_u32 m0, s83, 4096
    s_add_u32 s81, s82, 32768
    buffer_load_dwordx4 v62, s[12:15], s81 offen offset:0 lds
    s_add_u32 s81, s82, 39936
    buffer_load_dwordx4 v62, s[12:15], s81 offen offset:1024 lds
    s_add_u32 s81, s82, 47104
    buffer_load_dwordx4 v62, s[12:15], s81 offen offset:2048 lds
    s_add_u32 s81, s82, 54272
    buffer_load_dwordx4 v62, s[12:15], s81 offen offset:3072 lds
    s_waitcnt lgkmcnt(0)
    s_barrier
    s_lshl_b32 s59, s45, 2
    s_add_u32 s59, s59, s50
    s_lshl_b32 s56, s50, 7
    s_add_u32 s56, s56, s66
    v_lshlrev_b32 v5, 2, v7
    s_mov_b32 s64, 30000
    buffer_load_dword v17, v5, s[36:39], s56 offen offset:1024 sc1
    v_and_b32 v12, 1, v1
    v_lshlrev_b32 v12, 10, v12
    v_sub_u32 v12, 158208, v12
    v_lshl_add_u32 v12, v9, 4, v12
    ds_read_b128 v[80:83], v12 offset:256
    ds_read_b128 v[84:87], v12 offset:320
    ds_read_b128 v[88:91], v12 offset:384
    v_add_u32 v12, 90240, v60
    v_add_u32 v13, 90240, v61
    ds_read_b64_tr_b16 a[48:49], v12 offset:0
    ds_read_b64_tr_b16 a[50:51], v12 offset:768
    ds_read_b64_tr_b16 a[52:53], v12 offset:3088
    ds_read_b64_tr_b16 a[54:55], v12 offset:3856
    ds_read_b64_tr_b16 a[56:57], v13 offset:0
    ds_read_b64_tr_b16 a[58:59], v13 offset:768
    ds_read_b64_tr_b16 a[60:61], v12 offset:12352
    ds_read_b64_tr_b16 a[62:63], v12 offset:13120
    ds_read_b64_tr_b16 a[64:65], v12 offset:15440
    ds_read_b64_tr_b16 a[66:67], v12 offset:16208
    ds_read_b64_tr_b16 a[68:69], v13 offset:12352
    ds_read_b64_tr_b16 a[70:71], v13 offset:13120
    ds_read_b64_tr_b16 a[72:73], v12 offset:24704
    ds_read_b64_tr_b16 a[74:75], v12 offset:25472
    ds_read_b64_tr_b16 a[76:77], v12 offset:27792
    ds_read_b64_tr_b16 a[78:79], v12 offset:28560
    ds_read_b64_tr_b16 a[80:81], v13 offset:24704
    ds_read_b64_tr_b16 a[82:83], v13 offset:25472
    s_waitcnt lgkmcnt(12)
    v_mfma_f32_16x16x32_bf16 v[116:119], v[80:83], a[48:51], v[116:119]
    v_mfma_f32_16x16x32_bf16 v[120:123], v[80:83], a[52:55], v[120:123]
    v_mfma_f32_16x16x32_bf16 v[124:127], v[80:83], a[56:59], v[124:127]
    s_waitcnt lgkmcnt(6)
    v_mfma_f32_16x16x32_bf16 v[116:119], v[84:87], a[60:63], v[116:119]
    v_mfma_f32_16x16x32_bf16 v[120:123], v[84:87], a[64:67], v[120:123]
    v_mfma_f32_16x16x32_bf16 v[124:127], v[84:87], a[68:71], v[124:127]
    s_waitcnt lgkmcnt(0)
    v_mfma_f32_16x16x32_bf16 v[116:119], v[88:91], a[72:75], v[116:119]
    v_mfma_f32_16x16x32_bf16 v[120:123], v[88:91], a[76:79], v[120:123]
    v_mfma_f32_16x16x32_bf16 v[124:127], v[88:91], a[80:83], v[124:127]
    s_and_b32 s62, s47, 1
    s_lshl_b32 s63, s62, 9
    v_lshl_add_u32 v6, v8, 9, v6
    v_add_u32 v31, s63, v6
    s_lshr_b32 s61, s47, 1
    s_lshl_b32 s58, s61, 15
    s_lshl_b32 s63, s62, 12
    s_add_u32 s58, s58, s63
    s_lshl_b32 s57, s59, 16
    s_add_u32 s57, s57, s58
    s_add_u32 s57, s57, 7340032
    s_lshl_b32 s60, s61, 15
    s_add_u32 s60, s60, 65536
    v_add_u32 v14, s60, v2
    s_lshl_b32 s60, s51, 1
    s_add_u32 s60, s60, s62
    s_xor_b32 s62, s60, s78
    s_lshl_b32 s62, s62, 6
    s_add_u32 s62, s62, 156160
    v_lshl_add_u32 v16, v8, 5, s62
    s_waitcnt vmcnt(0)
PP_16:
    v_cmp_ne_u32 vcc, s44, v17
    s_cbranch_vccnz PR_18
PC_17:
    s_barrier
    s_add_u32 m0, s58, 65536
    s_nop 0
    buffer_load_dwordx4 v2, s[36:39], s57 offen offset:0 sc1 lds
    ds_read_b64_tr_b16 v[128:129], v31 offset:0
    ds_read_b64_tr_b16 v[130:131], v31 offset:256
    ds_read_b64_tr_b16 v[132:133], v31 offset:8192
    ds_read_b64_tr_b16 v[134:135], v31 offset:8448
    buffer_load_dwordx4 v2, s[36:39], s57 offen offset:1024 sc1 lds
    ds_read_b64_tr_b16 v[136:137], v31 offset:2048
    ds_read_b64_tr_b16 v[138:139], v31 offset:2304
    ds_read_b64_tr_b16 v[140:141], v31 offset:10240
    ds_read_b64_tr_b16 v[142:143], v31 offset:10496
    buffer_load_dwordx4 v2, s[36:39], s57 offen offset:2048 sc1 lds
    ds_read_b64_tr_b16 v[144:145], v31 offset:4096
    ds_read_b64_tr_b16 v[146:147], v31 offset:4352
    ds_read_b64_tr_b16 v[148:149], v31 offset:12288
    ds_read_b64_tr_b16 v[150:151], v31 offset:12544
    buffer_load_dwordx4 v2, s[36:39], s57 offen offset:3072 sc1 lds
    s_add_u32 s57, s57, 8192
    ds_read_b64_tr_b16 v[152:153], v31 offset:6144
    ds_read_b64_tr_b16 v[154:155], v31 offset:6400
    ds_read_b64_tr_b16 v[156:157], v31 offset:14336
    ds_read_b64_tr_b16 v[158:159], v31 offset:14592
    s_add_u32 m0, s58, 73728
    s_nop 0
    buffer_load_dwordx4 v2, s[36:39], s57 offen offset:0 sc1 lds
    ds_read_b64_tr_b16 v[160:161], v31 offset:16384
    ds_read_b64_tr_b16 v[162:163], v31 offset:16640
    ds_read_b64_tr_b16 v[164:165], v31 offset:24576
    ds_read_b64_tr_b16 v[166:167], v31 offset:24832
    buffer_load_dwordx4 v2, s[36:39], s57 offen offset:1024 sc1 lds
    ds_read_b64_tr_b16 v[168:169], v31 offset:18432
    ds_read_b64_tr_b16 v[170:171], v31 offset:18688
    ds_read_b64_tr_b16 v[172:173], v31 offset:26624
    ds_read_b64_tr_b16 v[174:175], v31 offset:26880
    buffer_load_dwordx4 v2, s[36:39], s57 offen offset:2048 sc1 lds
    ds_read_b64_tr_b16 v[176:177], v31 offset:20480
    ds_read_b64_tr_b16 v[178:179], v31 offset:20736
    ds_read_b64_tr_b16 v[180:181], v31 offset:28672
    ds_read_b64_tr_b16 v[182:183], v31 offset:28928
    buffer_load_dwordx4 v2, s[36:39], s57 offen offset:3072 sc1 lds
    s_add_u32 s57, s57, 8192
    ds_read_b64_tr_b16 v[184:185], v31 offset:22528
    ds_read_b64_tr_b16 v[186:187], v31 offset:22784
    ds_read_b64_tr_b16 v[188:189], v31 offset:30720
    ds_read_b64_tr_b16 v[190:191], v31 offset:30976
    s_add_u32 m0, s58, 81920
    s_nop 0
    buffer_load_dwordx4 v2, s[36:39], s57 offen offset:0 sc1 lds
    ds_read_b64_tr_b16 v[192:193], v31 offset:32768
    ds_read_b64_tr_b16 v[194:195], v31 offset:33024
    ds_read_b64_tr_b16 v[196:197], v31 offset:40960
    ds_read_b64_tr_b16 v[198:199], v31 offset:41216
    buffer_load_dwordx4 v2, s[36:39], s57 offen offset:1024 sc1 lds
    ds_read_b64_tr_b16 v[200:201], v31 offset:34816
    ds_read_b64_tr_b16 v[202:203], v31 offset:35072
    ds_read_b64_tr_b16 v[204:205], v31 offset:43008
    ds_read_b64_tr_b16 v[206:207], v31 offset:43264
    buffer_load_dwordx4 v2, s[36:39], s57 offen offset:2048 sc1 lds
    ds_read_b64_tr_b16 v[208:209], v31 offset:36864
    ds_read_b64_tr_b16 v[210:211], v31 offset:37120
    ds_read_b64_tr_b16 v[212:213], v31 offset:45056
    ds_read_b64_tr_b16 v[214:215], v31 offset:45312
    buffer_load_dwordx4 v2, s[36:39], s57 offen offset:3072 sc1 lds
    s_add_u32 s57, s57, 8192
    ds_read_b64_tr_b16 v[216:217], v31 offset:38912
    ds_read_b64_tr_b16 v[218:219], v31 offset:39168
    ds_read_b64_tr_b16 v[220:221], v31 offset:47104
    ds_read_b64_tr_b16 v[222:223], v31 offset:47360
    s_add_u32 m0, s58, 90112
    s_nop 0
    buffer_load_dwordx4 v2, s[36:39], s57 offen offset:0 sc1 lds
    ds_read_b64_tr_b16 v[224:225], v31 offset:49152
    ds_read_b64_tr_b16 v[226:227], v31 offset:49408
    ds_read_b64_tr_b16 v[228:229], v31 offset:57344
    ds_read_b64_tr_b16 v[230:231], v31 offset:57600
    buffer_load_dwordx4 v2, s[36:39], s57 offen offset:1024 sc1 lds
    ds_read_b64_tr_b16 v[232:233], v31 offset:51200
    ds_read_b64_tr_b16 v[234:235], v31 offset:51456
    ds_read_b64_tr_b16 v[236:237], v31 offset:59392
    ds_read_b64_tr_b16 v[238:239], v31 offset:59648
    buffer_load_dwordx4 v2, s[36:39], s57 offen offset:2048 sc1 lds
    ds_read_b64_tr_b16 v[240:241], v31 offset:53248
    ds_read_b64_tr_b16 v[242:243], v31 offset:53504
    ds_read_b64_tr_b16 v[244:245], v31 offset:61440
    ds_read_b64_tr_b16 v[246:247], v31 offset:61696
    buffer_load_dwordx4 v2, s[36:39], s57 offen offset:3072 sc1 lds
    ds_read_b64_tr_b16 v[248:249], v31 offset:55296
    ds_read_b64_tr_b16 v[250:251], v31 offset:55552
    ds_read_b64_tr_b16 v[252:253], v31 offset:63488
    ds_read_b64_tr_b16 v[254:255], v31 offset:63744
    ds_read_b128 v[80:83], v16 offset:0
    ds_read_b128 v[84:87], v16 offset:16
    ds_read_b128 v[88:91], v16 offset:2048
    ds_read_b128 v[92:95], v16 offset:2064
    v_lshlrev_b32 v12, 7, v1
    s_mul_i32 s6, s2, 5632
    s_mul_i32 s7, s47, 1408
    s_add_u32 s6, s6, s7
    s_mov_b64 exec, 0x7ff
    buffer_load_dword v11, v12, s[24:27], s6 offen
    s_mov_b64 exec, -1
    s_cmp_eq_u32 s2, 0
    s_cselect_b32 s56, 0, 0x7fff0000
    s_mov_b64 exec, 1
    buffer_store_dword v3, off, s[36:39], s56 sc1
    s_mov_b64 exec, -1
    v_accvgpr_read_b32 v20, a192
    v_accvgpr_read_b32 v21, a193
    v_accvgpr_read_b32 v22, a194
    v_accvgpr_read_b32 v23, a195
    v_accvgpr_read_b32 v24, a196
    v_accvgpr_read_b32 v25, a197
    v_accvgpr_read_b32 v26, a198
    v_accvgpr_read_b32 v27, a199
    s_lshl_b32 s63, s59, 1
    s_add_u32 s61, s61, s63
    s_lshl_b32 s56, s61, 15
    s_lshl_b32 s63, s60, 10
    s_add_u32 s56, s56, s63
    s_add_u32 s56, s56, 2097152
    s_lshl_b32 s57, s61, 12
    s_lshl_b32 s63, s60, 8
    s_add_u32 s57, s57, s63
    s_add_u32 s57, s57, 524288
    s_and_b32 s61, s61, 7
    s_lshl_b32 s58, s61, 6
    s_lshl_b32 s63, s60, 2
    s_add_u32 s58, s58, s63
    s_add_u32 s58, s58, s66
    v_and_b32 v12, 1, v9
    v_lshlrev_b32 v12, 14, v12
    v_lshl_add_u32 v12, v8, 9, v12
    v_lshl_add_u32 v15, v10, 4, v12
    s_waitcnt vmcnt(14) lgkmcnt(0)
    s_barrier
    ds_read_b128 v[32:35], v14 offset:0
    s_waitcnt lgkmcnt(0)
    ds_read_b128 v[36:39], v14 offset:4096
    ds_read_b128 v[40:43], v14 offset:1024
    v_mfma_f32_32x32x16_bf16 v[64:79], v[128:131], v[32:35], 0
    s_add_u32 m0, s80, 131072
    s_add_u32 s81, s79, 616448
    s_waitcnt lgkmcnt(1)
    ds_read_b128 v[44:47], v14 offset:5120
    ds_read_b128 v[48:51], v14 offset:2048
    v_mfma_f32_32x32x16_bf16 v[64:79], v[132:135], v[36:39], v[64:79]
    s_waitcnt lgkmcnt(2)
    buffer_load_dwordx4 v28, s[52:55], s81 offen offset:0 lds
    ds_read_b128 v[52:55], v14 offset:6144
    v_lshlrev_b32 v128, 16, v20
    v_and_b32 v129, 0xffff0000, v20
    v_lshlrev_b32 v130, 16, v21
    v_and_b32 v131, 0xffff0000, v21
    v_mfma_f32_32x32x16_bf16 v[64:79], v[136:139], v[40:43], v[64:79]
    s_waitcnt lgkmcnt(1)
    buffer_load_dwordx4 v29, s[52:55], s81 offen offset:1024 lds
    ds_read_b128 v[32:35], v14 offset:3072
    v_lshlrev_b32 v132, 16, v22
    v_and_b32 v133, 0xffff0000, v22
    v_lshlrev_b32 v134, 16, v23
    v_and_b32 v135, 0xffff0000, v23
    v_mfma_f32_32x32x16_bf16 v[64:79], v[140:143], v[44:47], v[64:79]
    s_waitcnt lgkmcnt(1)
    ds_read_b128 v[36:39], v14 offset:7168
    v_lshlrev_b32 v136, 16, v24
    v_and_b32 v137, 0xffff0000, v24
    v_lshlrev_b32 v138, 16, v25
    v_and_b32 v139, 0xffff0000, v25
    v_mfma_f32_32x32x16_bf16 v[64:79], v[144:147], v[48:51], v[64:79]
    s_waitcnt vmcnt(12) lgkmcnt(1)
    s_barrier
    buffer_load_dwordx4 v30, s[52:55], s81 offen offset:2048 lds
    ds_read_b128 v[40:43], v14 offset:8192
    v_lshlrev_b32 v140, 16, v26
    v_and_b32 v141, 0xffff0000, v26
    v_lshlrev_b32 v142, 16, v27
    v_mfma_f32_32x32x16_bf16 v[64:79], v[148:151], v[52:55], v[64:79]
    s_add_u32 m0, s80, 143424
    s_add_u32 s81, s79, 704512
    s_waitcnt lgkmcnt(1)
    ds_read_b128 v[44:47], v14 offset:12288
    ds_read_b128 v[48:51], v14 offset:9216
    v_and_b32 v143, 0xffff0000, v27
    v_lshlrev_b32 v144, 16, v80
    v_mfma_f32_32x32x16_bf16 v[64:79], v[152:155], v[32:35], v[64:79]
    s_waitcnt lgkmcnt(2)
    buffer_load_dwordx4 v28, s[52:55], s81 offen offset:0 lds
    ds_read_b128 v[52:55], v14 offset:13312
    v_and_b32 v145, 0xffff0000, v80
    v_lshlrev_b32 v146, 16, v81
    v_and_b32 v147, 0xffff0000, v81
    v_lshlrev_b32 v148, 16, v82
    v_mfma_f32_32x32x16_bf16 v[64:79], v[156:159], v[36:39], v[64:79]
    s_waitcnt lgkmcnt(2)
    ds_read_b128 v[32:35], v14 offset:10240
    ds_read_b128 v[36:39], v14 offset:14336
    v_and_b32 v149, 0xffff0000, v82
    v_lshlrev_b32 v150, 16, v83
    v_and_b32 v151, 0xffff0000, v83
    v_lshlrev_b32 v152, 16, v84
    v_mfma_f32_32x32x16_bf16 v[64:79], v[160:163], v[40:43], v[64:79]
    s_waitcnt lgkmcnt(3)
    buffer_load_dwordx4 v29, s[52:55], s81 offen offset:1024 lds
    ds_read_b128 v[40:43], v14 offset:11264
    v_and_b32 v153, 0xffff0000, v84
    v_lshlrev_b32 v154, 16, v85
    v_and_b32 v155, 0xffff0000, v85
    v_lshlrev_b32 v156, 16, v86
    v_mfma_f32_32x32x16_bf16 v[64:79], v[164:167], v[44:47], v[64:79]
    s_waitcnt lgkmcnt(3)
    ds_read_b128 v[44:47], v14 offset:15360
    v_and_b32 v157, 0xffff0000, v86
    v_lshlrev_b32 v158, 16, v87
    v_and_b32 v159, 0xffff0000, v87
    v_lshlrev_b32 v160, 16, v88
    v_and_b32 v161, 0xffff0000, v88
    v_mfma_f32_32x32x16_bf16 v[64:79], v[168:171], v[48:51], v[64:79]
    s_waitcnt lgkmcnt(3)
    buffer_load_dwordx4 v30, s[52:55], s81 offen offset:2048 lds
    v_lshlrev_b32 v162, 16, v89
    v_and_b32 v163, 0xffff0000, v89
    v_lshlrev_b32 v164, 16, v90
    v_and_b32 v165, 0xffff0000, v90
    v_lshlrev_b32 v166, 16, v91
    v_mfma_f32_32x32x16_bf16 v[64:79], v[172:175], v[52:55], v[64:79]
    s_add_u32 m0, s80, 0
    s_add_u32 s81, s79, 792576
    s_waitcnt lgkmcnt(2)
    v_and_b32 v167, 0xffff0000, v91
    v_lshlrev_b32 v168, 16, v92
    v_and_b32 v169, 0xffff0000, v92
    v_lshlrev_b32 v170, 16, v93
    v_mfma_f32_32x32x16_bf16 v[64:79], v[176:179], v[32:35], v[64:79]
    s_waitcnt vmcnt(12) lgkmcnt(1)
    s_barrier
    buffer_load_dwordx4 v28, s[52:55], s81 offen offset:0 lds
    ds_read_b128 v[48:51], v14 offset:16384
    v_and_b32 v171, 0xffff0000, v93
    v_lshlrev_b32 v172, 16, v94
    v_and_b32 v173, 0xffff0000, v94
    v_mfma_f32_32x32x16_bf16 v[64:79], v[180:183], v[36:39], v[64:79]
    s_waitcnt lgkmcnt(1)
    ds_read_b128 v[52:55], v14 offset:20480
    ds_read_b128 v[32:35], v14 offset:17408
    v_lshlrev_b32 v174, 16, v95
    v_and_b32 v175, 0xffff0000, v95
    v_mfma_f32_32x32x16_bf16 v[64:79], v[184:187], v[40:43], v[64:79]
    s_waitcnt lgkmcnt(2)
    buffer_load_dwordx4 v29, s[52:55], s81 offen offset:1024 lds
    ds_read_b128 v[36:39], v14 offset:21504
    v_mfma_f32_32x32x16_bf16 v[64:79], v[188:191], v[44:47], v[64:79]
    s_waitcnt lgkmcnt(2)
    ds_read_b128 v[40:43], v14 offset:18432
    ds_read_b128 v[44:47], v14 offset:22528
    v_mfma_f32_32x32x16_bf16 v[64:79], v[192:195], v[48:51], v[64:79]
    s_waitcnt lgkmcnt(3)
    buffer_load_dwordx4 v30, s[52:55], s81 offen offset:2048 lds
    ds_read_b128 v[48:51], v14 offset:19456
    v_mfma_f32_32x32x16_bf16 v[64:79], v[196:199], v[52:55], v[64:79]
    s_add_u32 m0, s80, 12352
    s_add_u32 s81, s79, 880640
    s_waitcnt lgkmcnt(3)
    ds_read_b128 v[52:55], v14 offset:23552
    v_mfma_f32_32x32x16_bf16 v[64:79], v[200:203], v[32:35], v[64:79]
    s_waitcnt lgkmcnt(3)
    buffer_load_dwordx4 v28, s[52:55], s81 offen offset:0 lds
    v_mfma_f32_32x32x16_bf16 v[64:79], v[204:207], v[36:39], v[64:79]
    s_waitcnt lgkmcnt(2)
    v_mfma_f32_32x32x16_bf16 v[64:79], v[208:211], v[40:43], v[64:79]
    s_waitcnt vmcnt(12) lgkmcnt(1)
    s_barrier
    buffer_load_dwordx4 v29, s[52:55], s81 offen offset:1024 lds
    ds_read_b128 v[32:35], v14 offset:24576
    v_mfma_f32_32x32x16_bf16 v[64:79], v[212:215], v[44:47], v[64:79]
    s_waitcnt lgkmcnt(1)
    ds_read_b128 v[36:39], v14 offset:28672
    ds_read_b128 v[40:43], v14 offset:25600
    v_mfma_f32_32x32x16_bf16 v[64:79], v[216:219], v[48:51], v[64:79]
    s_waitcnt lgkmcnt(2)
    buffer_load_dwordx4 v30, s[52:55], s81 offen offset:2048 lds
    ds_read_b128 v[44:47], v14 offset:29696
    v_mfma_f32_32x32x16_bf16 v[64:79], v[220:223], v[52:55], v[64:79]
    s_waitcnt lgkmcnt(2)
    ds_read_b128 v[48:51], v14 offset:26624
    ds_read_b128 v[52:55], v14 offset:30720
    v_mfma_f32_32x32x16_bf16 v[64:79], v[224:227], v[32:35], v[64:79]
    s_waitcnt lgkmcnt(3)
    ds_read_b128 v[32:35], v14 offset:27648
    v_mfma_f32_32x32x16_bf16 v[64:79], v[228:231], v[36:39], v[64:79]
    s_waitcnt lgkmcnt(3)
    ds_read_b128 v[36:39], v14 offset:31744
    v_mfma_f32_32x32x16_bf16 v[64:79], v[232:235], v[40:43], v[64:79]
    s_waitcnt lgkmcnt(3)
    v_mfma_f32_32x32x16_bf16 v[64:79], v[236:239], v[44:47], v[64:79]
    s_waitcnt lgkmcnt(2)
    v_mfma_f32_32x32x16_bf16 v[64:79], v[240:243], v[48:51], v[64:79]
    s_waitcnt lgkmcnt(1)
    v_mfma_f32_32x32x16_bf16 v[64:79], v[244:247], v[52:55], v[64:79]
    s_waitcnt lgkmcnt(0)
    s_barrier
    v_mfma_f32_32x32x16_bf16 v[64:79], v[248:251], v[32:35], v[64:79]
    v_mfma_f32_32x32x16_bf16 v[64:79], v[252:255], v[36:39], v[64:79]
    s_nop 11
    v_pk_fma_f32 v[64:65], v[64:65], v[144:145], v[128:129]
    v_pk_fma_f32 v[66:67], v[66:67], v[146:147], v[130:131]
    v_pk_fma_f32 v[68:69], v[68:69], v[148:149], v[132:133]
    v_pk_fma_f32 v[70:71], v[70:71], v[150:151], v[134:135]
    v_pk_fma_f32 v[72:73], v[72:73], v[152:153], v[136:137]
    v_pk_fma_f32 v[74:75], v[74:75], v[154:155], v[138:139]
    v_pk_fma_f32 v[76:77], v[76:77], v[156:157], v[140:141]
    v_pk_fma_f32 v[78:79], v[78:79], v[158:159], v[142:143]
    v_pk_mul_f32 v[160:161], v[64:65], v[160:161]
    v_pk_mul_f32 v[162:163], v[66:67], v[162:163]
    v_pk_mul_f32 v[164:165], v[68:69], v[164:165]
    v_pk_mul_f32 v[166:167], v[70:71], v[166:167]
    v_cvt_pk_bf16_f32 v32, v160, v161
    v_cvt_pk_bf16_f32 v33, v162, v163
    v_cvt_pk_bf16_f32 v34, v164, v165
    v_cvt_pk_bf16_f32 v35, v166, v167
    buffer_store_dwordx4 v[32:35], v15, s[36:39], s56 offen offset:0
    v_pk_mul_f32 v[168:169], v[72:73], v[168:169]
    v_pk_mul_f32 v[170:171], v[74:75], v[170:171]
    v_pk_mul_f32 v[172:173], v[76:77], v[172:173]
    v_pk_mul_f32 v[174:175], v[78:79], v[174:175]
    v_cvt_pk_bf16_f32 v36, v168, v169
    v_cvt_pk_bf16_f32 v37, v170, v171
    v_cvt_pk_bf16_f32 v38, v172, v173
    v_cvt_pk_bf16_f32 v39, v174, v175
    buffer_store_dwordx4 v[36:39], v15, s[36:39], s56 offen offset:256
    v_pk_add_f32 v[16:17], v[64:65], v[66:67]
    v_pk_mul_f32 v[18:19], v[64:65], v[64:65]
    v_pk_fma_f32 v[18:19], v[66:67], v[66:67], v[18:19]
    v_pk_add_f32 v[16:17], v[16:17], v[68:69]
    v_pk_fma_f32 v[18:19], v[68:69], v[68:69], v[18:19]
    v_pk_add_f32 v[16:17], v[16:17], v[70:71]
    v_pk_fma_f32 v[18:19], v[70:71], v[70:71], v[18:19]
    v_pk_add_f32 v[16:17], v[16:17], v[72:73]
    v_pk_fma_f32 v[18:19], v[72:73], v[72:73], v[18:19]
    v_pk_add_f32 v[16:17], v[16:17], v[74:75]
    v_pk_fma_f32 v[18:19], v[74:75], v[74:75], v[18:19]
    v_pk_add_f32 v[16:17], v[16:17], v[76:77]
    v_pk_fma_f32 v[18:19], v[76:77], v[76:77], v[18:19]
    v_pk_add_f32 v[16:17], v[16:17], v[78:79]
    v_pk_fma_f32 v[18:19], v[78:79], v[78:79], v[18:19]
    v_add_f32 v16, v16, v17
    v_add_f32 v18, v18, v19
    s_nop 1
    v_permlane32_swap_b32 v16, v18
    v_add_f32 v16, v16, v18
    buffer_store_dword v16, v4, s[36:39], s57 offen
    s_add_u32 m0, s80, 24704
    s_add_u32 s81, s79, 968704
    buffer_load_dwordx4 v28, s[52:55], s81 offen offset:0 lds
    buffer_load_dwordx4 v29, s[52:55], s81 offen offset:1024 lds
    buffer_load_dwordx4 v30, s[52:55], s81 offen offset:2048 lds
    s_add_u32 m0, s80, 37056
    s_add_u32 s81, s79, 1056768
    buffer_load_dwordx4 v28, s[52:55], s81 offen offset:0 lds
    buffer_load_dwordx4 v29, s[52:55], s81 offen offset:1024 lds
    buffer_load_dwordx4 v30, s[52:55], s81 offen offset:2048 lds
    s_waitcnt vmcnt(6)
    s_mov_b64 exec, 1
    buffer_store_dword v3, off, s[36:39], s58 offset:1536
    s_mov_b64 exec, -1
    s_barrier
    s_add_u32 m0, s80, 49408
    s_add_u32 s81, s79, 1144832
    buffer_load_dwordx4 v28, s[52:55], s81 offen offset:0 lds
    v_and_b32 v12, 1, v1
    v_lshlrev_b32 v12, 10, v12
    v_sub_u32 v12, 158208, v12
    v_lshl_add_u32 v12, v9, 4, v12
    ds_read_b128 v[80:83], v12 offset:448
    ds_read_b128 v[84:87], v12 offset:512
    buffer_load_dwordx4 v29, s[52:55], s81 offen offset:1024 lds
    ds_read_b128 v[88:91], v12 offset:576
    ds_read_b128 v[92:95], v12 offset:640
    v_add_u32 v12, 131072, v60
    v_add_u32 v13, 131072, v61
    ds_read_b64_tr_b16 a[84:85], v12 offset:0
    ds_read_b64_tr_b16 a[86:87], v12 offset:768
    buffer_load_dwordx4 v30, s[52:55], s81 offen offset:2048 lds
    ds_read_b64_tr_b16 a[88:89], v12 offset:3088
    ds_read_b64_tr_b16 a[90:91], v12 offset:3856
    ds_read_b64_tr_b16 a[92:93], v13 offset:0
    ds_read_b64_tr_b16 a[94:95], v13 offset:768
    ds_read_b64_tr_b16 a[96:97], v12 offset:12352
    ds_read_b64_tr_b16 a[98:99], v12 offset:13120
    s_add_u32 m0, s80, 98304
    s_add_u32 s81, s79, 1232896
    buffer_load_dwordx4 v28, s[52:55], s81 offen offset:0 lds
    ds_read_b64_tr_b16 a[100:101], v12 offset:15440
    ds_read_b64_tr_b16 a[102:103], v12 offset:16208
    ds_read_b64_tr_b16 a[104:105], v13 offset:12352
    ds_read_b64_tr_b16 a[106:107], v13 offset:13120
    v_add_u32 v12, 0, v60
    v_add_u32 v13, 0, v61
    buffer_load_dwordx4 v29, s[52:55], s81 offen offset:1024 lds
    ds_read_b64_tr_b16 a[108:109], v12 offset:0
    ds_read_b64_tr_b16 a[110:111], v12 offset:768
    ds_read_b64_tr_b16 a[112:113], v12 offset:3088
    ds_read_b64_tr_b16 a[114:115], v12 offset:3856
    ds_read_b64_tr_b16 a[116:117], v13 offset:0
    ds_read_b64_tr_b16 a[118:119], v13 offset:768
    buffer_load_dwordx4 v30, s[52:55], s81 offen offset:2048 lds
    s_waitcnt lgkmcnt(12)
    v_mfma_f32_16x16x32_bf16 v[116:119], v[80:83], a[84:87], v[116:119]
    v_mfma_f32_16x16x32_bf16 v[120:123], v[80:83], a[88:91], v[120:123]
    v_mfma_f32_16x16x32_bf16 v[124:127], v[80:83], a[92:95], v[124:127]
    ds_read_b64_tr_b16 a[120:121], v12 offset:12352
    ds_read_b64_tr_b16 a[122:123], v12 offset:13120
    ds_read_b64_tr_b16 a[124:125], v12 offset:15440
    s_add_u32 m0, s80, 110656
    s_add_u32 s81, s79, 1320960
    buffer_load_dwordx4 v28, s[52:55], s81 offen offset:0 lds
    ds_read_b64_tr_b16 a[126:127], v12 offset:16208
    ds_read_b64_tr_b16 a[128:129], v13 offset:12352
    ds_read_b64_tr_b16 a[130:131], v13 offset:13120
    s_waitcnt lgkmcnt(12)
    v_mfma_f32_16x16x32_bf16 v[116:119], v[84:87], a[96:99], v[116:119]
    v_mfma_f32_16x16x32_bf16 v[120:123], v[84:87], a[100:103], v[120:123]
    v_mfma_f32_16x16x32_bf16 v[124:127], v[84:87], a[104:107], v[124:127]
    buffer_load_dwordx4 v29, s[52:55], s81 offen offset:1024 lds
    s_waitcnt lgkmcnt(6)
    v_mfma_f32_16x16x32_bf16 v[116:119], v[88:91], a[108:111], v[116:119]
    v_mfma_f32_16x16x32_bf16 v[120:123], v[88:91], a[112:115], v[120:123]
    v_mfma_f32_16x16x32_bf16 v[124:127], v[88:91], a[116:119], v[124:127]
    s_waitcnt lgkmcnt(0)
    v_mfma_f32_16x16x32_bf16 v[116:119], v[92:95], a[120:123], v[116:119]
    v_mfma_f32_16x16x32_bf16 v[120:123], v[92:95], a[124:127], v[120:123]
    v_mfma_f32_16x16x32_bf16 v[124:127], v[92:95], a[128:131], v[124:127]
    buffer_load_dwordx4 v30, s[52:55], s81 offen offset:2048 lds
    s_lshl_b32 s56, s48, 8
    s_add_u32 s56, s56, s66
    s_lshl_b32 s60, s45, 1
    s_add_u32 s60, s60, s48
    s_and_b32 s61, s49, 1
    s_lshl_b32 s57, s61, 1
    s_xor_b32 s57, s57, s47
    s_lshl_b32 s57, s57, 12
    s_lshl_b32 s63, s60, 14
    s_add_u32 s57, s57, s63
    s_add_u32 s57, s57, 524288
    s_lshl_b32 s82, s60, 17
    s_lshl_b32 s63, s61, 16
    s_add_u32 s82, s82, s63
    s_add_u32 s82, s82, s83
    s_add_u32 s82, s82, 2097152
    s_lshl_b32 s63, s78, 10
    s_xor_b32 s82, s82, s63
    s_getpc_b64 s[4:5]
    s_lshl_b32 s6, s46, 2
    s_add_u32 s6, s6, s47
    v_mov_b32 v12, s6
    v_lshlrev_b32 v12, 1, v12
    v_mad_u64_u32 v[12:13], vcc, v12, 64, s[4:5]
    global_load_dword v11, v[12:13], off
    s_mov_b32 s64, 30000
    buffer_load_dword v17, v4, s[36:39], s56 offen offset:1536 sc1
    v_add_u32 v18, 65536, v2
    v_add_u32 v25, 4096, v2
    v_add_u32 v26, 8192, v2
    v_lshlrev_b32 v14, 4, v10
    v_add_u32 v19, 160256, v14
    v_lshlrev_b32 v20, 3, v10
    v_add_u32 v20, 162304, v20
    v_lshl_add_u32 v21, v8, 7, v20
    v_lshl_add_u32 v14, v8, 8, v14
    v_and_b32 v15, 1, v9
    s_lshr_b32 s4, s49, 1
    s_lshr_b32 s5, s47, 1
    s_and_b32 s6, s47, 1
    s_lshl_b32 s7, s4, 4
    s_lshl_b32 s63, s47, 2
    s_add_u32 s7, s7, s63
    v_min_u32 v16, 1, v1
    v_lshl_add_u32 v24, v16, 30, s7
    s_mul_i32 s4, s4, 6
    s_mul_i32 s63, s5, 3
    s_add_u32 s4, s4, s63
    s_lshl1_add_u32 s5, s6, s4
    s_and_b32 s7, s5, 3
    s_lshr_b32 s5, s5, 2
    s_lshl_b32 s5, s5, 10
    s_mul_i32 s63, s7, 12288
    s_add_u32 s5, s5, s63
    v_lshl_add_u32 v16, v15, 9, v14
    v_add_u32 v22, s5, v16
    s_add_u32 s5, s4, 1
    s_and_b32 s7, s5, 3
    s_lshr_b32 s5, s5, 2
    s_lshl_b32 s5, s5, 10
    s_mul_i32 s63, s7, 12288
    s_add_u32 s5, s5, s63
    s_lshl_b32 s63, s6, 9
    s_add_u32 s5, s5, s63
    v_lshl_add_u32 v16, v15, 30, v14
    v_add_u32 v23, s5, v16
    s_lshl_b32 s4, s60, 1
    s_add_u32 s4, s4, s61
    s_xor_b32 s5, s4, 1
    s_mul_i32 s16, s4, 98304
    s_add_u32 s16, s16, 4194304
    s_add_u32 s17, s16, 49152
    s_lshl_b32 s18, s5, 16
    s_add_u32 s18, s18, 7340032
    s_add_u32 s19, s18, 4289724416
    s_and_b32 s4, s4, 3
    s_lshl_b32 s20, s4, 9
    s_add_u32 s20, s20, s66
    s_xor_b32 s21, s20, 512
    s_lshl_b32 s22, s50, 9
    s_add_u32 s22, s22, s66
    s_mul_i32 s4, s47, 12288
    s_mul_i32 s8, s59, 98304
    s_add_u32 s8, s8, s4
    s_add_u32 s8, s8, 4194304
    s_add_u32 s9, s8, 49152
    s_lshl_b32 s10, s59, 16
    s_add_u32 s10, s10, s4
    s_add_u32 s10, s10, 7340032
    s_add_u32 s11, s10, 4289724416
    s_andn2_b32 s13, s22, 512
    v_lshl_add_u32 v58, v8, 9, v5
    s_mul_i32 s12, s47, 14336
    s_add_u32 s12, s12, 98304
    v_add_u32 v56, s12, v6
    s_lshl_b32 s4, s51, 7
    v_add_u32 v62, s4, v62
    v_add_u32 v0, 7168, v62
    s_and_b32 s4, s50, 1
    s_mul_i32 s4, s4, 98304
    s_lshr_b32 s5, s47, 1
    s_lshl_b32 s68, s47, 14
    s_add_u32 s68, s68, s4
    s_mul_i32 s69, s5, 98304
    s_add_u32 s69, s69, s68
    s_lshl_b32 s4, s4, 1
    s_sub_u32 s4, 98304, s4
    s_add_u32 s70, s68, s4
    s_add_u32 s71, s69, s4
    s_waitcnt vmcnt(0)
PP_19:
    v_cmp_ne_u32 vcc, s44, v17
    s_cbranch_vccnz PR_21
PC_20:
    s_barrier
    buffer_load_dwordx4 v[96:99], v2, s[36:39], s57 offen offset:0 sc1
    buffer_load_dwordx4 v[100:103], v2, s[36:39], s57 offen offset:1024 sc1
    buffer_load_dwordx4 v[104:107], v2, s[36:39], s57 offen offset:2048 sc1
    buffer_load_dwordx4 v[108:111], v2, s[36:39], s57 offen offset:3072 sc1
    s_add_u32 m0, s83, 65536
    s_xor_b32 s23, s82, 0
    buffer_load_dwordx4 v2, s[36:39], s23 offen offset:0 sc1 lds
    v_and_b32 v12, 1, v1
    v_lshlrev_b32 v12, 10, v12
    v_sub_u32 v12, 158208, v12
    v_lshl_add_u32 v12, v9, 4, v12
    ds_read_b128 v[128:131], v12 offset:704
    ds_read_b128 v[132:135], v12 offset:768
    ds_read_b128 v[136:139], v12 offset:832
    buffer_load_dwordx4 v2, s[36:39], s23 offen offset:1024 sc1 lds
    ds_read_b128 v[140:143], v12 offset:896
    ds_read_b128 v[144:147], v12 offset:960
    v_add_u32 v12, 24704, v60
    v_add_u32 v13, 24704, v61
    ds_read_b64_tr_b16 a[132:133], v12 offset:0
    ds_read_b64_tr_b16 a[134:135], v12 offset:768
    ds_read_b64_tr_b16 a[136:137], v12 offset:3088
    buffer_load_dwordx4 v2, s[36:39], s23 offen offset:2048 sc1 lds
    ds_read_b64_tr_b16 a[138:139], v12 offset:3856
    ds_read_b64_tr_b16 a[140:141], v13 offset:0
    ds_read_b64_tr_b16 a[142:143], v13 offset:768
    ds_read_b64_tr_b16 a[144:145], v12 offset:12352
    ds_read_b64_tr_b16 a[146:147], v12 offset:13120
    ds_read_b64_tr_b16 a[148:149], v12 offset:15440
    ds_read_b64_tr_b16 a[150:151], v12 offset:16208
    buffer_load_dwordx4 v2, s[36:39], s23 offen offset:3072 sc1 lds
    ds_read_b64_tr_b16 a[152:153], v13 offset:12352
    ds_read_b64_tr_b16 a[154:155], v13 offset:13120
    ds_read_b64_tr_b16 a[156:157], v12 offset:24704
    ds_read_b64_tr_b16 a[158:159], v12 offset:25472
    ds_read_b64_tr_b16 a[160:161], v12 offset:27792
    ds_read_b64_tr_b16 a[162:163], v12 offset:28560
    ds_read_b64_tr_b16 a[164:165], v13 offset:24704
    s_add_u32 m0, s83, 69632
    s_xor_b32 s23, s82, 4096
    buffer_load_dwordx4 v2, s[36:39], s23 offen offset:0 sc1 lds
    ds_read_b64_tr_b16 a[166:167], v13 offset:25472
    s_waitcnt lgkmcnt(12)
    v_mfma_f32_16x16x32_bf16 v[116:119], v[128:131], a[132:135], v[116:119]
    v_mfma_f32_16x16x32_bf16 v[120:123], v[128:131], a[136:139], v[120:123]
    v_mfma_f32_16x16x32_bf16 v[124:127], v[128:131], a[140:143], v[124:127]
    v_add_u32 v12, 98304, v60
    v_add_u32 v13, 98304, v61
    ds_read_b64_tr_b16 a[168:169], v12 offset:0
    buffer_load_dwordx4 v2, s[36:39], s23 offen offset:1024 sc1 lds
    ds_read_b64_tr_b16 a[170:171], v12 offset:768
    ds_read_b64_tr_b16 a[172:173], v12 offset:3088
    ds_read_b64_tr_b16 a[174:175], v12 offset:3856
    ds_read_b64_tr_b16 a[176:177], v13 offset:0
    ds_read_b64_tr_b16 a[178:179], v13 offset:768
    s_waitcnt lgkmcnt(12)
    v_mfma_f32_16x16x32_bf16 v[116:119], v[132:135], a[144:147], v[116:119]
    v_mfma_f32_16x16x32_bf16 v[120:123], v[132:135], a[148:151], v[120:123]
    buffer_load_dwordx4 v2, s[36:39], s23 offen offset:2048 sc1 lds
    v_mfma_f32_16x16x32_bf16 v[124:127], v[132:135], a[152:155], v[124:127]
    ds_read_b64_tr_b16 a[180:181], v12 offset:12352
    ds_read_b64_tr_b16 a[182:183], v12 offset:13120
    ds_read_b64_tr_b16 a[184:185], v12 offset:15440
    ds_read_b64_tr_b16 a[186:187], v12 offset:16208
    ds_read_b64_tr_b16 a[188:189], v13 offset:12352
    ds_read_b64_tr_b16 a[190:191], v13 offset:13120
    buffer_load_dwordx4 v2, s[36:39], s23 offen offset:3072 sc1 lds
    s_waitcnt lgkmcnt(12)
    v_mfma_f32_16x16x32_bf16 v[116:119], v[136:139], a[156:159], v[116:119]
    v_mfma_f32_16x16x32_bf16 v[120:123], v[136:139], a[160:163], v[120:123]
    v_mfma_f32_16x16x32_bf16 v[124:127], v[136:139], a[164:167], v[124:127]
    s_waitcnt lgkmcnt(6)
    v_mfma_f32_16x16x32_bf16 v[116:119], v[140:143], a[168:171], v[116:119]
    v_mfma_f32_16x16x32_bf16 v[120:123], v[140:143], a[172:175], v[120:123]
    v_mfma_f32_16x16x32_bf16 v[124:127], v[140:143], a[176:179], v[124:127]
    s_waitcnt lgkmcnt(0)
    v_mfma_f32_16x16x32_bf16 v[116:119], v[144:147], a[180:183], v[116:119]
    v_mfma_f32_16x16x32_bf16 v[120:123], v[144:147], a[184:187], v[120:123]
    v_mfma_f32_16x16x32_bf16 v[124:127], v[144:147], a[188:191], v[124:127]
    s_waitcnt vmcnt(8)
    s_barrier
    s_add_u32 m0, s83, 0
    s_xor_b32 s23, s82, 32768
    buffer_load_dwordx4 v2, s[36:39], s23 offen offset:0 sc1 lds
    v_pk_add_f32 v[96:97], v[96:97], v[100:101]
    v_pk_add_f32 v[98:99], v[98:99], v[102:103]
    v_pk_add_f32 v[104:105], v[104:105], v[108:109]
    v_pk_add_f32 v[106:107], v[106:107], v[110:111]
    v_pk_add_f32 v[96:97], v[96:97], v[104:105]
    v_pk_add_f32 v[98:99], v[98:99], v[106:107]
    buffer_load_dwordx4 v2, s[36:39], s23 offen offset:1024 sc1 lds
    s_nop 0
    v_permlane32_swap_b32 v96, v98
    v_permlane32_swap_b32 v97, v99
    v_add_f32 v96, v96, v98
    v_add_f32 v97, v97, v99
    s_nop 1
    v_permlane16_swap_b32 v96, v97
    v_add_f32 v96, v96, v97
    buffer_load_dwordx4 v2, s[36:39], s23 offen offset:2048 sc1 lds
    v_mul_f32 v96, 0x3b000000, v96
    s_nop 1
    v_mov_b32_dpp v97, v96 row_ror:8 row_mask:0xf bank_mask:0xf
    v_fma_f32 v97, -v96, v96, v97
    v_max_f32 v97, 0, v97
    v_add_f32 v97, 0x3727c5ac, v97
    v_rsq_f32 v98, v97
    buffer_load_dwordx4 v2, s[36:39], s23 offen offset:3072 sc1 lds
    v_sub_f32 v96, 0, v96
    v_mul_f32 v97, v97, v98
    v_cvt_pk_bf16_f32 v100, v96, v96
    v_cvt_pk_bf16_f32 v104, v97, v97
    v_and_b32 v105, 0xffff0000, v100
    v_and_b32 v104, 0xffff0000, v104
    s_add_u32 m0, s83, 4096
    s_xor_b32 s23, s82, 36864
    buffer_load_dwordx4 v2, s[36:39], s23 offen offset:0 sc1 lds
    v_sub_f32 v96, v96, v105
    v_sub_f32 v97, v97, v104
    v_cvt_pk_bf16_f32 v101, v96, v104
    v_cvt_pk_bf16_f32 v102, v104, v97
    v_mov_b32 v103, 0
    v_mul_f32 v99, v98, v98
    buffer_load_dwordx4 v2, s[36:39], s23 offen offset:1024 sc1 lds
    v_mul_f32 v104, 0xc0135761, v98
    v_mul_f32 v105, 0xbdd2d3e8, v98
    v_mul_f32 v105, v105, v99
    v_and_b32 v14, 7, v1
    v_lshl_add_u32 v14, v14, 2, v9
    s_lshl_b32 s56, s47, 5
    buffer_load_dwordx4 v2, s[36:39], s23 offen offset:2048 sc1 lds
    v_add_u32 v14, s56, v14
    v_lshlrev_b32 v15, 4, v14
    v_add_u32 v15, 160256, v15
    v_lshlrev_b32 v16, 3, v14
    v_add_u32 v16, 162304, v16
    v_lshlrev_b32 v17, 2, v14
    buffer_load_dwordx4 v2, s[36:39], s23 offen offset:3072 sc1 lds
    v_add_u32 v17, 163328, v17
    s_mov_b32 exec_lo, 0x00ff00ff
    s_mov_b32 exec_hi, 0x00ff00ff
    ds_write_b128 v15, v[100:103]
    ds_write_b64 v16, v[104:105]
    ds_write_b32 v17, v99
    s_mov_b64 exec, -1
    s_mov_b32 s64, 30000
    v_cmp_gt_u32 vcc, 16, v1
    s_waitcnt vmcnt(8) lgkmcnt(0)
    s_barrier
    ds_read_b128 v[92:95], v18 offset:0
    s_waitcnt lgkmcnt(0)
    ds_read_b128 v[96:99], v18 offset:1024
    ds_read_b128 v[100:103], v18 offset:2048
    ds_read_b128 v[104:107], v18 offset:3072
    v_mfma_f32_16x16x32_bf16 v[80:83], a[0:3], v[92:95], 0
    ds_read_b128 v[108:111], v18 offset:4096
    ds_read_b128 v[112:115], v18 offset:5120
    v_mfma_f32_16x16x32_bf16 v[84:87], a[4:7], v[92:95], 0
    v_cndmask_b32 v116, 0, v116, vcc
    v_cndmask_b32 v117, 0, v117, vcc
    v_mfma_f32_16x16x32_bf16 v[88:91], a[8:11], v[92:95], 0
    s_waitcnt lgkmcnt(4)
    ds_read_b128 v[92:95], v18 offset:6144
    v_cvt_pk_bf16_f32 v45, v116, v117
    v_mfma_f32_16x16x32_bf16 v[80:83], a[12:15], v[96:99], v[80:83]
    v_lshlrev_b32 v118, 16, v45
    v_and_b32 v119, 0xffff0000, v45
    v_mfma_f32_16x16x32_bf16 v[84:87], a[16:19], v[96:99], v[84:87]
    v_sub_f32 v116, v116, v118
    v_sub_f32 v117, v117, v119
    v_mfma_f32_16x16x32_bf16 v[88:91], a[20:23], v[96:99], v[88:91]
    s_add_u32 m0, s12, 0
    s_waitcnt lgkmcnt(4)
    ds_read_b128 v[96:99], v18 offset:7168
    v_cvt_pk_bf16_f32 v44, v118, v116
    v_mfma_f32_16x16x32_bf16 v[80:83], a[24:27], v[100:103], v[80:83]
    s_add_u32 s14, s68, 0
    v_cvt_pk_bf16_f32 v46, v117, v119
    v_mov_b32 v47, 0
    v_mfma_f32_16x16x32_bf16 v[84:87], a[28:31], v[100:103], v[84:87]
    v_cndmask_b32 v120, 0, v120, vcc
    v_cndmask_b32 v121, 0, v121, vcc
    v_mfma_f32_16x16x32_bf16 v[88:91], a[32:35], v[100:103], v[88:91]
    s_waitcnt lgkmcnt(4)
    buffer_load_dwordx4 v62, s[24:27], s14 offen offset:0 lds
    ds_read_b128 v[100:103], v18 offset:8192
    v_mfma_f32_16x16x32_bf16 v[80:83], a[36:39], v[104:107], v[80:83]
    v_cvt_pk_bf16_f32 v49, v120, v121
    v_lshlrev_b32 v122, 16, v49
    v_mfma_f32_16x16x32_bf16 v[84:87], a[40:43], v[104:107], v[84:87]
    s_waitcnt lgkmcnt(4)
    v_and_b32 v123, 0xffff0000, v49
    v_sub_f32 v120, v120, v122
    v_mfma_f32_16x16x32_bf16 v[88:91], a[44:47], v[104:107], v[88:91]
    ds_read_b128 v[104:107], v18 offset:9216
    v_sub_f32 v121, v121, v123
    v_mfma_f32_16x16x32_bf16 v[80:83], a[48:51], v[108:111], v[80:83]
    v_cvt_pk_bf16_f32 v48, v122, v120
    v_cvt_pk_bf16_f32 v50, v121, v123
    v_mfma_f32_16x16x32_bf16 v[84:87], a[52:55], v[108:111], v[84:87]
    s_waitcnt lgkmcnt(4)
    v_mov_b32 v51, 0
    v_cndmask_b32 v124, 0, v124, vcc
    v_mfma_f32_16x16x32_bf16 v[88:91], a[56:59], v[108:111], v[88:91]
    buffer_load_dwordx4 v0, s[24:27], s14 offen offset:1024 lds
    ds_read_b128 v[108:111], v18 offset:10240
    v_mfma_f32_16x16x32_bf16 v[80:83], a[60:63], v[112:115], v[80:83]
    v_cndmask_b32 v125, 0, v125, vcc
    v_cvt_pk_bf16_f32 v53, v124, v125
    v_mfma_f32_16x16x32_bf16 v[84:87], a[64:67], v[112:115], v[84:87]
    s_waitcnt lgkmcnt(4)
    v_lshlrev_b32 v126, 16, v53
    v_and_b32 v127, 0xffff0000, v53
    v_mfma_f32_16x16x32_bf16 v[88:91], a[68:71], v[112:115], v[88:91]
    s_add_u32 m0, s12, 2048
    ds_read_b128 v[112:115], v18 offset:11264
    v_sub_f32 v124, v124, v126
    v_mfma_f32_16x16x32_bf16 v[80:83], a[72:75], v[92:95], v[80:83]
    s_add_u32 s14, s69, 65536
    v_sub_f32 v125, v125, v127
    v_cvt_pk_bf16_f32 v52, v126, v124
    v_mfma_f32_16x16x32_bf16 v[84:87], a[76:79], v[92:95], v[84:87]
    s_waitcnt lgkmcnt(4)
    buffer_load_dwordx4 v62, s[24:27], s14 offen offset:0 lds
    v_cvt_pk_bf16_f32 v54, v125, v127
    v_mfma_f32_16x16x32_bf16 v[88:91], a[80:83], v[92:95], v[88:91]
    ds_read_b128 v[92:95], v18 offset:12288
    v_mov_b32 v55, 0
    v_mfma_f32_16x16x32_bf16 v[80:83], a[84:87], v[96:99], v[80:83]
    v_mfma_f32_16x16x32_bf16 v[84:87], a[88:91], v[96:99], v[84:87]
    s_waitcnt lgkmcnt(4)
    v_mfma_f32_16x16x32_bf16 v[88:91], a[92:95], v[96:99], v[88:91]
    ds_read_b128 v[96:99], v18 offset:13312
    v_mfma_f32_16x16x32_bf16 v[80:83], a[96:99], v[100:103], v[80:83]
    v_mfma_f32_16x16x32_bf16 v[84:87], a[100:103], v[100:103], v[84:87]
    s_waitcnt lgkmcnt(4)
    buffer_load_dwordx4 v0, s[24:27], s14 offen offset:1024 lds
    v_mfma_f32_16x16x32_bf16 v[88:91], a[104:107], v[100:103], v[88:91]
    ds_read_b128 v[100:103], v18 offset:14336
    v_mfma_f32_16x16x32_bf16 v[80:83], a[108:111], v[104:107], v[80:83]
    v_mfma_f32_16x16x32_bf16 v[84:87], a[112:115], v[104:107], v[84:87]
    s_waitcnt lgkmcnt(4)
    v_mfma_f32_16x16x32_bf16 v[88:91], a[116:119], v[104:107], v[88:91]
    s_add_u32 m0, s12, 4096
    ds_read_b128 v[104:107], v18 offset:15360
    v_mfma_f32_16x16x32_bf16 v[80:83], a[120:123], v[108:111], v[80:83]
    s_add_u32 s14, s68, 229376
    v_mfma_f32_16x16x32_bf16 v[84:87], a[124:127], v[108:111], v[84:87]
    s_waitcnt lgkmcnt(4)
    buffer_load_dwordx4 v62, s[24:27], s14 offen offset:0 lds
    v_mfma_f32_16x16x32_bf16 v[88:91], a[128:131], v[108:111], v[88:91]
    ds_read_b128 v[108:111], v19 offset:0
    v_mfma_f32_16x16x32_bf16 v[80:83], a[132:135], v[112:115], v[80:83]
    v_mfma_f32_16x16x32_bf16 v[84:87], a[136:139], v[112:115], v[84:87]
    s_waitcnt lgkmcnt(4)
    v_mfma_f32_16x16x32_bf16 v[88:91], a[140:143], v[112:115], v[88:91]
    ds_read_b128 v[112:115], v18 offset:16384
    v_mfma_f32_16x16x32_bf16 v[80:83], a[144:147], v[92:95], v[80:83]
    v_mfma_f32_16x16x32_bf16 v[84:87], a[148:151], v[92:95], v[84:87]
    s_waitcnt lgkmcnt(4)
    buffer_load_dwordx4 v0, s[24:27], s14 offen offset:1024 lds
    v_mfma_f32_16x16x32_bf16 v[88:91], a[152:155], v[92:95], v[88:91]
    ds_read_b128 v[92:95], v18 offset:17408
    v_mfma_f32_16x16x32_bf16 v[80:83], a[156:159], v[96:99], v[80:83]
    ds_read_b64 v[12:13], v20 offset:0
    v_mfma_f32_16x16x32_bf16 v[84:87], a[160:163], v[96:99], v[84:87]
    s_waitcnt lgkmcnt(5)
    v_mfma_f32_16x16x32_bf16 v[88:91], a[164:167], v[96:99], v[88:91]
    s_add_u32 m0, s12, 6144
    ds_read_b128 v[96:99], v18 offset:18432
    v_mfma_f32_16x16x32_bf16 v[80:83], a[168:171], v[100:103], v[80:83]
    s_add_u32 s14, s68, 393216
    v_mfma_f32_16x16x32_bf16 v[84:87], a[172:175], v[100:103], v[84:87]
    s_waitcnt lgkmcnt(5)
    buffer_load_dwordx4 v62, s[24:27], s14 offen offset:0 lds
    v_mfma_f32_16x16x32_bf16 v[88:91], a[176:179], v[100:103], v[88:91]
    ds_read_b128 v[100:103], v18 offset:19456
    v_mfma_f32_16x16x32_bf16 v[80:83], a[180:183], v[104:107], v[80:83]
    v_mfma_f32_16x16x32_bf16 v[84:87], a[184:187], v[104:107], v[84:87]
    s_waitcnt lgkmcnt(5)
    v_mfma_f32_16x16x32_bf16 v[88:91], a[188:191], v[104:107], v[88:91]
    ds_read_b128 v[104:107], v18 offset:20480
    v_mfma_f32_16x16x32_bf16 v[80:83], v[44:47], v[108:111], v[80:83]
    v_mfma_f32_16x16x32_bf16 v[84:87], v[48:51], v[108:111], v[84:87]
    s_waitcnt lgkmcnt(5)
    buffer_load_dwordx4 v0, s[24:27], s14 offen offset:1024 lds
    v_mfma_f32_16x16x32_bf16 v[88:91], v[52:55], v[108:111], v[88:91]
    ds_read_b128 v[108:111], v18 offset:21504
    v_mfma_f32_16x16x32_bf16 v[32:35], a[0:3], v[112:115], 0
    s_nop 1
    v_mul_f32 v128, v80, v80
    v_mul_f32 v129, v81, v81
    v_mfma_f32_16x16x32_bf16 v[36:39], a[4:7], v[112:115], 0
    s_add_u32 m0, s83, 32768
    s_waitcnt lgkmcnt(4)
    v_mfma_f32_16x16x32_bf16 v[116:119], a[8:11], v[112:115], 0
    s_xor_b32 s23, s82, 65536
    ds_read_b128 v[112:115], v18 offset:22528
    v_mul_f32 v130, v82, v82
    v_mfma_f32_16x16x32_bf16 v[32:35], a[12:15], v[92:95], v[32:35]
    v_mul_f32 v131, v83, v83
    v_fma_f32 v128, v128, v13, v12
    v_mfma_f32_16x16x32_bf16 v[36:39], a[16:19], v[92:95], v[36:39]
    s_waitcnt lgkmcnt(4)
    buffer_load_dwordx4 v2, s[36:39], s23 offen offset:0 sc1 lds
    v_fma_f32 v129, v129, v13, v12
    v_mfma_f32_16x16x32_bf16 v[116:119], a[20:23], v[92:95], v[116:119]
    ds_read_b128 v[92:95], v18 offset:23552
    v_fma_f32 v130, v130, v13, v12
    v_mfma_f32_16x16x32_bf16 v[32:35], a[24:27], v[96:99], v[32:35]
    v_fma_f32 v131, v131, v13, v12
    v_mul_f32 v128, v128, v80
    v_mfma_f32_16x16x32_bf16 v[36:39], a[28:31], v[96:99], v[36:39]
    s_waitcnt lgkmcnt(4)
    v_mul_f32 v129, v129, v81
    v_mul_f32 v130, v130, v82
    v_mfma_f32_16x16x32_bf16 v[116:119], a[32:35], v[96:99], v[116:119]
    buffer_load_dwordx4 v2, s[36:39], s23 offen offset:1024 sc1 lds
    ds_read_b128 v[96:99], v18 offset:24576
    v_mfma_f32_16x16x32_bf16 v[32:35], a[36:39], v[100:103], v[32:35]
    v_mul_f32 v131, v131, v83
    v_mul_f32 v84, v80, v84
    v_mfma_f32_16x16x32_bf16 v[36:39], a[40:43], v[100:103], v[36:39]
    s_waitcnt lgkmcnt(4)
    v_exp_f32 v128, v128
    v_mfma_f32_16x16x32_bf16 v[116:119], a[44:47], v[100:103], v[116:119]
    ds_read_b128 v[100:103], v18 offset:25600
    v_add_f32 v128, 1.0, v128
    v_mfma_f32_16x16x32_bf16 v[32:35], a[48:51], v[104:107], v[32:35]
    s_waitcnt vmcnt(8)
    buffer_load_dwordx4 v2, s[36:39], s23 offen offset:2048 sc1 lds
    ds_read_b64_tr_b16 a[192:193], v56 offset:0
    v_mfma_f32_16x16x32_bf16 v[36:39], a[52:55], v[104:107], v[36:39]
    s_waitcnt lgkmcnt(5)
    ds_read_b64_tr_b16 a[194:195], v56 offset:256
    v_mul_f32 v85, v81, v85
    v_mfma_f32_16x16x32_bf16 v[116:119], a[56:59], v[104:107], v[116:119]
    ds_read_b64_tr_b16 a[196:197], v56 offset:512
    ds_read_b128 v[104:107], v18 offset:26624
    v_mfma_f32_16x16x32_bf16 v[32:35], a[60:63], v[108:111], v[32:35]
    ds_read_b64_tr_b16 a[198:199], v56 offset:768
    v_mul_f32 v86, v82, v86
    v_mfma_f32_16x16x32_bf16 v[36:39], a[64:67], v[108:111], v[36:39]
    s_waitcnt lgkmcnt(8)
    v_exp_f32 v129, v129
    v_mfma_f32_16x16x32_bf16 v[116:119], a[68:71], v[108:111], v[116:119]
    buffer_load_dwordx4 v2, s[36:39], s23 offen offset:3072 sc1 lds
    ds_read_b128 v[108:111], v18 offset:27648
    v_mfma_f32_16x16x32_bf16 v[32:35], a[72:75], v[112:115], v[32:35]
    v_exp_f32 v130, v130
    v_mfma_f32_16x16x32_bf16 v[36:39], a[76:79], v[112:115], v[36:39]
    s_add_u32 m0, s12, 8192
    s_waitcnt lgkmcnt(8)
    v_add_f32 v129, 1.0, v129
    v_mfma_f32_16x16x32_bf16 v[116:119], a[80:83], v[112:115], v[116:119]
    s_add_u32 s14, s69, 458752
    ds_read_b128 v[112:115], v18 offset:28672
    v_add_f32 v130, 1.0, v130
    v_mfma_f32_16x16x32_bf16 v[32:35], a[84:87], v[92:95], v[32:35]
    buffer_load_dwordx4 v62, s[24:27], s14 offen offset:0 lds
    v_mul_f32 v87, v83, v87
    v_mfma_f32_16x16x32_bf16 v[36:39], a[88:91], v[92:95], v[36:39]
    s_waitcnt lgkmcnt(8)
    v_exp_f32 v131, v131
    v_mfma_f32_16x16x32_bf16 v[116:119], a[92:95], v[92:95], v[116:119]
    ds_read_b128 v[92:95], v18 offset:29696
    v_add_f32 v131, 1.0, v131
    v_mfma_f32_16x16x32_bf16 v[32:35], a[96:99], v[96:99], v[32:35]
    s_waitcnt vmcnt(9)
    v_rcp_f32 v128, v128
    v_mfma_f32_16x16x32_bf16 v[36:39], a[100:103], v[96:99], v[36:39]
    s_waitcnt lgkmcnt(8)
    ds_read_b64_tr_b16 a[200:201], v56 offset:2048
    ds_read_b64_tr_b16 a[202:203], v56 offset:2304
    v_mfma_f32_16x16x32_bf16 v[116:119], a[104:107], v[96:99], v[116:119]
    ds_read_b64_tr_b16 a[204:205], v56 offset:2560
    ds_read_b128 v[96:99], v18 offset:30720
    v_mfma_f32_16x16x32_bf16 v[32:35], a[108:111], v[100:103], v[32:35]
    s_waitcnt lgkmcnt(7)
    buffer_load_dwordx4 v0, s[24:27], s14 offen offset:1024 lds
    ds_read_b64_tr_b16 a[206:207], v56 offset:2816
    v_mfma_f32_16x16x32_bf16 v[36:39], a[112:115], v[100:103], v[36:39]
    v_rcp_f32 v129, v129
    v_mfma_f32_16x16x32_bf16 v[116:119], a[116:119], v[100:103], v[116:119]
    ds_read_b128 v[100:103], v18 offset:31744
    v_mul_f32 v84, v84, v128
    v_mfma_f32_16x16x32_bf16 v[32:35], a[120:123], v[104:107], v[32:35]
    v_rcp_f32 v130, v130
    v_mfma_f32_16x16x32_bf16 v[36:39], a[124:127], v[104:107], v[36:39]
    s_add_u32 m0, s12, 10240
    s_waitcnt lgkmcnt(8)
    v_mul_f32 v85, v85, v129
    v_mfma_f32_16x16x32_bf16 v[116:119], a[128:131], v[104:107], v[116:119]
    s_add_u32 s14, s68, 622592
    ds_read_b128 v[104:107], v19 offset:256
    v_mul_f32 v86, v86, v130
    v_mfma_f32_16x16x32_bf16 v[32:35], a[132:135], v[108:111], v[32:35]
    buffer_load_dwordx4 v62, s[24:27], s14 offen offset:0 lds
    v_cvt_pk_bf16_f32 v40, v84, v85
    v_mfma_f32_16x16x32_bf16 v[36:39], a[136:139], v[108:111], v[36:39]
    s_waitcnt lgkmcnt(8)
    v_rcp_f32 v131, v131
    v_mfma_f32_16x16x32_bf16 v[116:119], a[140:143], v[108:111], v[116:119]
    v_mul_f32 v87, v87, v131
    v_cvt_pk_bf16_f32 v41, v86, v87
    v_mfma_f32_16x16x32_bf16 v[32:35], a[144:147], v[112:115], v[32:35]
    s_waitcnt vmcnt(9)
    ds_read_b64_tr_b16 a[208:209], v56 offset:4096
    v_mfma_f32_16x16x32_bf16 v[36:39], a[148:151], v[112:115], v[36:39]
    s_waitcnt lgkmcnt(8)
    ds_read_b64_tr_b16 a[210:211], v56 offset:4352
    v_mfma_f32_16x16x32_bf16 v[116:119], a[152:155], v[112:115], v[116:119]
    ds_read_b64_tr_b16 a[212:213], v56 offset:4608
    v_mfma_f32_16x16x32_bf16 v[32:35], a[156:159], v[92:95], v[32:35]
    s_waitcnt lgkmcnt(5)
    buffer_load_dwordx4 v0, s[24:27], s14 offen offset:1024 lds
    ds_read_b64_tr_b16 a[214:215], v56 offset:4864
    v_mfma_f32_16x16x32_bf16 v[36:39], a[160:163], v[92:95], v[36:39]
    s_barrier
    ds_read_b128 v[108:111], v2 offset:0
    v_mfma_f32_16x16x32_bf16 v[116:119], a[164:167], v[92:95], v[116:119]
    ds_read_b128 v[112:115], v2 offset:1024
    ds_read_b64 v[14:15], v20 offset:128
    v_mfma_f32_16x16x32_bf16 v[32:35], a[168:171], v[96:99], v[32:35]
    s_add_u32 m0, s83, 36864
    ds_read_b64 v[16:17], v21 offset:0
    ds_read_b128 v[92:95], v2 offset:2048
    v_mfma_f32_16x16x32_bf16 v[36:39], a[172:175], v[96:99], v[36:39]
    s_xor_b32 s23, s82, 69632
    s_waitcnt lgkmcnt(10)
    v_mfma_f32_16x16x32_bf16 v[116:119], a[176:179], v[96:99], v[116:119]
    ds_read_b128 v[96:99], v2 offset:3072
    v_mfma_f32_16x16x32_bf16 v[32:35], a[180:183], v[100:103], v[32:35]
    buffer_load_dwordx4 v2, s[36:39], s23 offen offset:0 sc1 lds
    v_mfma_f32_16x16x32_bf16 v[36:39], a[184:187], v[100:103], v[36:39]
    s_waitcnt lgkmcnt(10)
    v_mfma_f32_16x16x32_bf16 v[116:119], a[188:191], v[100:103], v[116:119]
    ds_read_b128 v[100:103], v2 offset:4096
    v_mfma_f32_16x16x32_bf16 v[32:35], v[44:47], v[104:107], v[32:35]
    s_waitcnt vmcnt(9)
    ds_read_b64_tr_b16 a[216:217], v56 offset:6144
    v_mfma_f32_16x16x32_bf16 v[36:39], v[48:51], v[104:107], v[36:39]
    buffer_load_dwordx4 v2, s[36:39], s23 offen offset:1024 sc1 lds
    ds_read_b64_tr_b16 a[218:219], v56 offset:6400
    v_mfma_f32_16x16x32_bf16 v[116:119], v[52:55], v[104:107], v[116:119]
    s_waitcnt lgkmcnt(8)
    ds_read_b64_tr_b16 a[220:221], v56 offset:6656
    ds_read_b128 v[104:107], v2 offset:5120
    v_mfma_f32_16x16x32_bf16 v[80:83], a[0:3], v[108:111], 0
    ds_read_b64_tr_b16 a[222:223], v56 offset:6912
    v_mul_f32 v132, v32, v32
    v_mfma_f32_16x16x32_bf16 v[84:87], a[4:7], v[108:111], 0
    s_waitcnt lgkmcnt(8)
    v_mul_f32 v133, v33, v33
    v_mul_f32 v134, v34, v34
    v_mfma_f32_16x16x32_bf16 v[120:123], a[8:11], v[108:111], 0
    buffer_load_dwordx4 v2, s[36:39], s23 offen offset:2048 sc1 lds
    ds_read_b128 v[108:111], v2 offset:6144
    v_mfma_f32_16x16x32_bf16 v[80:83], a[12:15], v[112:115], v[80:83]
    v_mul_f32 v135, v35, v35
    v_fma_f32 v132, v132, v15, v14
    v_mfma_f32_16x16x32_bf16 v[84:87], a[16:19], v[112:115], v[84:87]
    s_waitcnt lgkmcnt(8)
    v_fma_f32 v133, v133, v15, v14
    v_fma_f32 v134, v134, v15, v14
    v_mfma_f32_16x16x32_bf16 v[120:123], a[20:23], v[112:115], v[120:123]
    ds_read_b128 v[112:115], v2 offset:7168
    v_fma_f32 v135, v135, v15, v14
    v_mfma_f32_16x16x32_bf16 v[80:83], a[24:27], v[92:95], v[80:83]
    v_mul_f32 v132, v132, v32
    v_mul_f32 v133, v133, v33
    v_mfma_f32_16x16x32_bf16 v[84:87], a[28:31], v[92:95], v[84:87]
    s_waitcnt lgkmcnt(8)
    buffer_load_dwordx4 v2, s[36:39], s23 offen offset:3072 sc1 lds
    v_mul_f32 v134, v134, v34
    v_mfma_f32_16x16x32_bf16 v[120:123], a[32:35], v[92:95], v[120:123]
    ds_read_b128 v[92:95], v2 offset:8192
    v_mul_f32 v135, v135, v35
    v_mfma_f32_16x16x32_bf16 v[80:83], a[36:39], v[96:99], v[80:83]
    s_add_u32 m0, s12, 12288
    v_exp_f32 v132, v132
    v_mfma_f32_16x16x32_bf16 v[84:87], a[40:43], v[96:99], v[84:87]
    s_add_u32 s14, s68, 786432
    s_waitcnt lgkmcnt(8)
    v_add_f32 v132, 1.0, v132
    v_mfma_f32_16x16x32_bf16 v[120:123], a[44:47], v[96:99], v[120:123]
    buffer_load_dwordx4 v62, s[24:27], s14 offen offset:0 lds
    ds_read_b128 v[96:99], v2 offset:9216
    v_mfma_f32_16x16x32_bf16 v[80:83], a[48:51], v[100:103], v[80:83]
    s_waitcnt lgkmcnt(4)
    v_exp_f32 v133, v133
    v_mfma_f32_16x16x32_bf16 v[84:87], a[52:55], v[100:103], v[84:87]
    v_exp_f32 v134, v134
    v_mfma_f32_16x16x32_bf16 v[120:123], a[56:59], v[100:103], v[120:123]
    ds_read_b128 v[100:103], v2 offset:10240
    v_add_f32 v133, 1.0, v133
    v_mfma_f32_16x16x32_bf16 v[80:83], a[60:63], v[104:107], v[80:83]
    v_exp_f32 v135, v135
    v_mfma_f32_16x16x32_bf16 v[84:87], a[64:67], v[104:107], v[84:87]
    s_waitcnt lgkmcnt(4)
    v_add_f32 v134, 1.0, v134
    v_add_f32 v135, 1.0, v135
    v_mfma_f32_16x16x32_bf16 v[120:123], a[68:71], v[104:107], v[120:123]
    buffer_load_dwordx4 v0, s[24:27], s14 offen offset:1024 lds
    ds_read_b128 v[104:107], v2 offset:11264
    v_mfma_f32_16x16x32_bf16 v[80:83], a[72:75], v[108:111], v[80:83]
    v_rcp_f32 v132, v132
    v_mfma_f32_16x16x32_bf16 v[84:87], a[76:79], v[108:111], v[84:87]
    s_waitcnt lgkmcnt(4)
    v_rcp_f32 v133, v133
    v_mfma_f32_16x16x32_bf16 v[120:123], a[80:83], v[108:111], v[120:123]
    s_add_u32 m0, s12, 0
    ds_read_b128 v[108:111], v2 offset:12288
    v_mul_f32 v36, v32, v36
    v_mfma_f32_16x16x32_bf16 v[80:83], a[84:87], v[112:115], v[80:83]
    s_add_u32 s14, s69, 851968
    v_rcp_f32 v134, v134
    v_mfma_f32_16x16x32_bf16 v[84:87], a[88:91], v[112:115], v[84:87]
    s_waitcnt lgkmcnt(4)
    v_rcp_f32 v135, v135
    v_mfma_f32_16x16x32_bf16 v[120:123], a[92:95], v[112:115], v[120:123]
    buffer_load_dwordx4 v62, s[24:27], s14 offen offset:0 lds
    ds_read_b128 v[112:115], v2 offset:13312
    v_mfma_f32_16x16x32_bf16 v[80:83], a[96:99], v[92:95], v[80:83]
    v_mul_f32 v37, v33, v37
    v_mul_f32 v38, v34, v38
    v_mfma_f32_16x16x32_bf16 v[84:87], a[100:103], v[92:95], v[84:87]
    s_waitcnt lgkmcnt(4)
    v_mul_f32 v39, v35, v39
    v_mul_f32 v36, v36, v132
    v_mfma_f32_16x16x32_bf16 v[120:123], a[104:107], v[92:95], v[120:123]
    s_waitcnt vmcnt(9)
    ds_read_b64_tr_b16 a[224:225], v56 offset:8192
    ds_read_b128 v[92:95], v2 offset:14336
    v_mfma_f32_16x16x32_bf16 v[80:83], a[108:111], v[96:99], v[80:83]
    ds_read_b64_tr_b16 a[226:227], v56 offset:8448
    v_mul_f32 v37, v37, v133
    v_mfma_f32_16x16x32_bf16 v[84:87], a[112:115], v[96:99], v[84:87]
    s_waitcnt lgkmcnt(6)
    ds_read_b64_tr_b16 a[228:229], v56 offset:8704
    v_mul_f32 v38, v38, v134
    v_mfma_f32_16x16x32_bf16 v[120:123], a[116:119], v[96:99], v[120:123]
    buffer_load_dwordx4 v0, s[24:27], s14 offen offset:1024 lds
    ds_read_b64_tr_b16 a[230:231], v56 offset:8960
    v_mfma_f32_16x16x32_bf16 v[80:83], a[120:123], v[100:103], v[80:83]
    v_mul_f32 v39, v39, v135
    v_cvt_pk_bf16_f32 v42, v36, v37
    v_mfma_f32_16x16x32_bf16 v[84:87], a[124:127], v[100:103], v[84:87]
    s_waitcnt lgkmcnt(7)
    ds_read_b128 v[96:99], v2 offset:15360
    v_cvt_pk_bf16_f32 v43, v38, v39
    v_mfma_f32_16x16x32_bf16 v[120:123], a[128:131], v[100:103], v[120:123]
    s_add_u32 m0, s12, 2048
    v_permlane32_swap_b32 v40, v42
    v_mfma_f32_16x16x32_bf16 v[80:83], a[132:135], v[104:107], v[80:83]
    s_add_u32 s14, s68, 1015808
    v_permlane32_swap_b32 v41, v43
    v_mfma_f32_16x16x32_bf16 v[84:87], a[136:139], v[104:107], v[84:87]
    s_waitcnt lgkmcnt(7)
    buffer_store_dwordx4 v[40:43], v22, s[36:39], s16 offen sc1
    ds_read_b128 v[100:103], v19 offset:512
    v_mfma_f32_16x16x32_bf16 v[120:123], a[140:143], v[104:107], v[120:123]
    v_permlane32_swap_b32 v88, v116
    v_mfma_f32_16x16x32_bf16 v[80:83], a[144:147], v[108:111], v[80:83]
    ds_read_b128 v[104:107], v2 offset:16384
    v_mul_f32 v136, v88, v88
    v_mfma_f32_16x16x32_bf16 v[84:87], a[148:151], v[108:111], v[84:87]
    s_waitcnt lgkmcnt(8)
    v_permlane32_swap_b32 v89, v117
    v_mfma_f32_16x16x32_bf16 v[120:123], a[152:155], v[108:111], v[120:123]
    s_waitcnt vmcnt(9)
    ds_read_b64_tr_b16 a[232:233], v56 offset:10240
    ds_read_b128 v[108:111], v2 offset:17408
    v_mfma_f32_16x16x32_bf16 v[80:83], a[156:159], v[112:115], v[80:83]
    buffer_load_dwordx4 v62, s[24:27], s14 offen offset:0 lds
    ds_read_b64_tr_b16 a[234:235], v56 offset:10496
    v_mfma_f32_16x16x32_bf16 v[84:87], a[160:163], v[112:115], v[84:87]
    s_waitcnt lgkmcnt(9)
    ds_read_b64_tr_b16 a[236:237], v56 offset:10752
    ds_read_b64 v[12:13], v20 offset:256
    v_mfma_f32_16x16x32_bf16 v[120:123], a[164:167], v[112:115], v[120:123]
    s_waitcnt lgkmcnt(8)
    ds_read_b64_tr_b16 a[238:239], v56 offset:11008
    ds_read_b128 v[112:115], v2 offset:18432
    v_mfma_f32_16x16x32_bf16 v[80:83], a[168:171], v[92:95], v[80:83]
    v_permlane32_swap_b32 v90, v118
    v_mfma_f32_16x16x32_bf16 v[84:87], a[172:175], v[92:95], v[84:87]
    s_waitcnt lgkmcnt(9)
    v_permlane32_swap_b32 v91, v119
    v_mfma_f32_16x16x32_bf16 v[120:123], a[176:179], v[92:95], v[120:123]
    ds_read_b128 v[92:95], v2 offset:19456
    v_mul_f32 v137, v89, v89
    v_mfma_f32_16x16x32_bf16 v[80:83], a[180:183], v[96:99], v[80:83]
    buffer_load_dwordx4 v0, s[24:27], s14 offen offset:1024 lds
    v_mul_f32 v138, v90, v90
    v_mfma_f32_16x16x32_bf16 v[84:87], a[184:187], v[96:99], v[84:87]
    s_add_u32 m0, s12, 4096
    s_waitcnt lgkmcnt(9)
    v_mul_f32 v139, v91, v91
    v_mfma_f32_16x16x32_bf16 v[120:123], a[188:191], v[96:99], v[120:123]
    s_add_u32 s14, s68, 1179648
    v_fma_f32 v136, v136, v17, v16
    v_fma_f32 v137, v137, v17, v16
    v_mfma_f32_16x16x32_bf16 v[80:83], v[44:47], v[100:103], v[80:83]
    v_fma_f32 v138, v138, v17, v16
    v_fma_f32 v139, v139, v17, v16
    v_mfma_f32_16x16x32_bf16 v[84:87], v[48:51], v[100:103], v[84:87]
    s_waitcnt lgkmcnt(8)
    v_mul_f32 v136, v136, v88
    v_mul_f32 v137, v137, v89
    v_mfma_f32_16x16x32_bf16 v[120:123], v[52:55], v[100:103], v[120:123]
    v_mul_f32 v138, v138, v90
    v_mul_f32 v139, v139, v91
    v_mfma_f32_16x16x32_bf16 v[32:35], a[0:3], v[104:107], 0
    buffer_load_dwordx4 v62, s[24:27], s14 offen offset:0 lds
    ds_read_b128 v[96:99], v2 offset:20480
    v_mfma_f32_16x16x32_bf16 v[36:39], a[4:7], v[104:107], 0
    s_waitcnt lgkmcnt(4)
    v_exp_f32 v136, v136
    v_mfma_f32_16x16x32_bf16 v[124:127], a[8:11], v[104:107], 0
    s_waitcnt lgkmcnt(3)
    v_exp_f32 v137, v137
    v_mfma_f32_16x16x32_bf16 v[32:35], a[12:15], v[108:111], v[32:35]
    v_exp_f32 v138, v138
    v_mfma_f32_16x16x32_bf16 v[36:39], a[16:19], v[108:111], v[36:39]
    s_waitcnt lgkmcnt(2)
    ds_read_b128 v[100:103], v2 offset:21504
    v_exp_f32 v139, v139
    v_mfma_f32_16x16x32_bf16 v[124:127], a[20:23], v[108:111], v[124:127]
    v_add_f32 v136, 1.0, v136
    v_add_f32 v137, 1.0, v137
    v_mfma_f32_16x16x32_bf16 v[32:35], a[24:27], v[112:115], v[32:35]
    buffer_load_dwordx4 v0, s[24:27], s14 offen offset:1024 lds
    v_add_f32 v138, 1.0, v138
    v_mfma_f32_16x16x32_bf16 v[36:39], a[28:31], v[112:115], v[36:39]
    s_add_u32 m0, s12, 6144
    ds_read_b128 v[104:107], v2 offset:22528
    v_add_f32 v139, 1.0, v139
    v_mul_f32 v116, v88, v116
    v_mfma_f32_16x16x32_bf16 v[124:127], a[32:35], v[112:115], v[124:127]
    s_add_u32 s14, s69, 1245184
    s_waitcnt lgkmcnt(3)
    v_rcp_f32 v136, v136
    v_mfma_f32_16x16x32_bf16 v[32:35], a[36:39], v[92:95], v[32:35]
    v_rcp_f32 v137, v137
    v_mfma_f32_16x16x32_bf16 v[36:39], a[40:43], v[92:95], v[36:39]
    s_waitcnt lgkmcnt(2)
    ds_read_b128 v[108:111], v2 offset:23552
    v_rcp_f32 v138, v138
    v_mfma_f32_16x16x32_bf16 v[124:127], a[44:47], v[92:95], v[124:127]
    v_rcp_f32 v139, v139
    v_mfma_f32_16x16x32_bf16 v[32:35], a[48:51], v[96:99], v[32:35]
    buffer_load_dwordx4 v62, s[24:27], s14 offen offset:0 lds
    v_mul_f32 v117, v89, v117
    v_mfma_f32_16x16x32_bf16 v[36:39], a[52:55], v[96:99], v[36:39]
    ds_read_b128 v[112:115], v2 offset:24576
    v_mul_f32 v118, v90, v118
    v_mul_f32 v119, v91, v119
    v_mfma_f32_16x16x32_bf16 v[124:127], a[56:59], v[96:99], v[124:127]
    s_waitcnt lgkmcnt(3)
    v_mul_f32 v116, v116, v136
    v_mul_f32 v117, v117, v137
    v_mfma_f32_16x16x32_bf16 v[32:35], a[60:63], v[100:103], v[32:35]
    v_mul_f32 v118, v118, v138
    v_mul_f32 v119, v119, v139
    v_mfma_f32_16x16x32_bf16 v[36:39], a[64:67], v[100:103], v[36:39]
    s_waitcnt vmcnt(8)
    ds_read_b64_tr_b16 a[240:241], v56 offset:12288
    ds_read_b128 v[92:95], v2 offset:25600
    v_cvt_pk_bf16_f32 v28, v116, v117
    v_mfma_f32_16x16x32_bf16 v[124:127], a[68:71], v[100:103], v[124:127]
    s_waitcnt lgkmcnt(4)
    buffer_load_dwordx4 v0, s[24:27], s14 offen offset:1024 lds
    ds_read_b64_tr_b16 a[242:243], v56 offset:12544
    v_mfma_f32_16x16x32_bf16 v[32:35], a[72:75], v[104:107], v[32:35]
    s_add_u32 m0, s12, 8192
    ds_read_b64_tr_b16 a[244:245], v56 offset:12800
    v_cvt_pk_bf16_f32 v29, v118, v119
    v_mfma_f32_16x16x32_bf16 v[36:39], a[76:79], v[104:107], v[36:39]
    s_add_u32 s14, s70, 0
    ds_read_b64_tr_b16 a[246:247], v56 offset:13056
    ds_read_b128 v[96:99], v2 offset:26624
    v_cvt_pk_bf16_f32 v30, v116, v117
    v_mfma_f32_16x16x32_bf16 v[124:127], a[80:83], v[104:107], v[124:127]
    s_waitcnt lgkmcnt(7)
    ds_read_b128 v[100:103], v2 offset:27648
    v_cvt_pk_bf16_f32 v31, v118, v119
    v_mfma_f32_16x16x32_bf16 v[32:35], a[84:87], v[108:111], v[32:35]
    v_permlane16_swap_b32 v28, v30
    v_mfma_f32_16x16x32_bf16 v[36:39], a[88:91], v[108:111], v[36:39]
    v_permlane16_swap_b32 v29, v31
    v_mfma_f32_16x16x32_bf16 v[124:127], a[92:95], v[108:111], v[124:127]
    s_waitcnt lgkmcnt(7)
    buffer_store_dwordx4 v[28:31], v23, s[36:39], s16 offen sc1
    ds_read_b128 v[104:107], v2 offset:28672
    v_mfma_f32_16x16x32_bf16 v[32:35], a[96:99], v[112:115], v[32:35]
    ds_read_b128 v[108:111], v2 offset:29696
    v_mul_f32 v128, v80, v80
    v_mfma_f32_16x16x32_bf16 v[36:39], a[100:103], v[112:115], v[36:39]
    buffer_load_dwordx4 v62, s[24:27], s14 offen offset:0 lds
    v_mul_f32 v129, v81, v81
    v_mfma_f32_16x16x32_bf16 v[124:127], a[104:107], v[112:115], v[124:127]
    s_waitcnt lgkmcnt(7)
    ds_read_b128 v[112:115], v2 offset:30720
    v_mul_f32 v130, v82, v82
    v_mfma_f32_16x16x32_bf16 v[32:35], a[108:111], v[92:95], v[32:35]
    s_waitcnt vmcnt(9)
    ds_read_b64_tr_b16 a[248:249], v56 offset:0
    v_mul_f32 v131, v83, v83
    v_mfma_f32_16x16x32_bf16 v[36:39], a[112:115], v[92:95], v[36:39]
    ds_read_b64_tr_b16 a[250:251], v56 offset:256
    v_fma_f32 v128, v128, v13, v12
    v_mfma_f32_16x16x32_bf16 v[124:127], a[116:119], v[92:95], v[124:127]
    s_waitcnt lgkmcnt(6)
    ds_read_b64_tr_b16 a[252:253], v56 offset:512
    ds_read_b128 v[92:95], v2 offset:31744
    v_mfma_f32_16x16x32_bf16 v[32:35], a[120:123], v[96:99], v[32:35]
    ds_read_b64_tr_b16 a[254:255], v56 offset:768
    v_fma_f32 v129, v129, v13, v12
    v_mfma_f32_16x16x32_bf16 v[36:39], a[124:127], v[96:99], v[36:39]
    s_waitcnt lgkmcnt(8)
    buffer_load_dwordx4 v0, s[24:27], s14 offen offset:1024 lds
    v_fma_f32 v130, v130, v13, v12
    v_mfma_f32_16x16x32_bf16 v[124:127], a[128:131], v[96:99], v[124:127]
    s_add_u32 m0, s12, 10240
    s_add_u32 s14, s71, 65536
    ds_read_b128 v[96:99], v19 offset:768
    v_mfma_f32_16x16x32_bf16 v[32:35], a[132:135], v[100:103], v[32:35]
    v_fma_f32 v131, v131, v13, v12
    v_mul_f32 v128, v128, v80
    v_mfma_f32_16x16x32_bf16 v[36:39], a[136:139], v[100:103], v[36:39]
    s_waitcnt lgkmcnt(8)
    v_mul_f32 v129, v129, v81
    v_mul_f32 v130, v130, v82
    v_mfma_f32_16x16x32_bf16 v[124:127], a[140:143], v[100:103], v[124:127]
    v_mul_f32 v131, v131, v83
    v_mul_f32 v84, v80, v84
    v_mfma_f32_16x16x32_bf16 v[32:35], a[144:147], v[104:107], v[32:35]
    v_exp_f32 v128, v128
    v_mfma_f32_16x16x32_bf16 v[36:39], a[148:151], v[104:107], v[36:39]
    s_waitcnt lgkmcnt(7)
    buffer_load_dwordx4 v62, s[24:27], s14 offen offset:0 lds
    v_add_f32 v128, 1.0, v128
    v_mfma_f32_16x16x32_bf16 v[124:127], a[152:155], v[104:107], v[124:127]
    v_exp_f32 v129, v129
    v_mfma_f32_16x16x32_bf16 v[32:35], a[156:159], v[108:111], v[32:35]
    v_exp_f32 v130, v130
    v_mfma_f32_16x16x32_bf16 v[36:39], a[160:163], v[108:111], v[36:39]
    s_xor_b32 s23, s82, 98304
    s_barrier
    ds_read_b128 v[100:103], v2 offset:32768
    v_mfma_f32_16x16x32_bf16 v[124:127], a[164:167], v[108:111], v[124:127]
    s_waitcnt lgkmcnt(7)
    ds_read_b128 v[104:107], v2 offset:33792
    v_add_f32 v129, 1.0, v129
    v_mfma_f32_16x16x32_bf16 v[32:35], a[168:171], v[112:115], v[32:35]
    s_waitcnt vmcnt(8) lgkmcnt(3)
    ds_read_b64_tr_b16 v[144:145], v56 offset:2048
    v_add_f32 v130, 1.0, v130
    v_mfma_f32_16x16x32_bf16 v[36:39], a[172:175], v[112:115], v[36:39]
    buffer_load_dwordx4 v0, s[24:27], s14 offen offset:1024 lds
    ds_read_b64_tr_b16 v[146:147], v56 offset:2304
    v_mfma_f32_16x16x32_bf16 v[124:127], a[176:179], v[112:115], v[124:127]
    s_add_u32 m0, s83, 65536
    ds_read_b64_tr_b16 v[148:149], v56 offset:2560
    ds_read_b64 v[14:15], v20 offset:384
    v_mfma_f32_16x16x32_bf16 v[32:35], a[180:183], v[92:95], v[32:35]
    ds_read_b64_tr_b16 v[150:151], v56 offset:2816
    ds_read_b64 v[16:17], v21 offset:256
    v_mfma_f32_16x16x32_bf16 v[36:39], a[184:187], v[92:95], v[36:39]
    s_waitcnt lgkmcnt(8)
    ds_read_b128 v[108:111], v2 offset:34816
    v_exp_f32 v131, v131
    v_mfma_f32_16x16x32_bf16 v[124:127], a[188:191], v[92:95], v[124:127]
    v_add_f32 v131, 1.0, v131
    v_mul_f32 v85, v81, v85
    v_mfma_f32_16x16x32_bf16 v[32:35], v[44:47], v[96:99], v[32:35]
    v_rcp_f32 v128, v128
    v_mfma_f32_16x16x32_bf16 v[36:39], v[48:51], v[96:99], v[36:39]
    buffer_load_dwordx4 v2, s[36:39], s23 offen offset:0 sc1 lds
    ds_read_b128 v[112:115], v2 offset:35840
    v_mul_f32 v86, v82, v86
    v_rcp_f32 v129, v129
    v_rcp_f32 v130, v130
    v_rcp_f32 v131, v131
    v_mfma_f32_16x16x32_bf16 v[124:127], v[52:55], v[96:99], v[124:127]
    s_waitcnt lgkmcnt(9)
    v_mul_f32 v87, v83, v87
    v_mul_f32 v84, v84, v128
    v_mul_f32 v85, v85, v129
    v_mul_f32 v86, v86, v130
    v_mul_f32 v87, v87, v131
    v_mfma_f32_16x16x32_bf16 v[80:83], a[0:3], v[100:103], 0
    v_cvt_pk_bf16_f32 v40, v84, v85
    v_cvt_pk_bf16_f32 v41, v86, v87
    v_mfma_f32_16x16x32_bf16 v[84:87], a[4:7], v[100:103], 0
    s_waitcnt lgkmcnt(2)
    ds_read_b128 v[92:95], v2 offset:36864
    ds_read_b128 v[96:99], v2 offset:37888
    v_mfma_f32_16x16x32_bf16 v[88:91], a[8:11], v[100:103], 0
    buffer_load_dwordx4 v2, s[36:39], s23 offen offset:1024 sc1 lds
    ds_read_b128 v[100:103], v2 offset:38912
    v_mfma_f32_16x16x32_bf16 v[80:83], a[12:15], v[104:107], v[80:83]
    s_waitcnt vmcnt(9)
    ds_read_b64_tr_b16 v[152:153], v56 offset:4096
    v_mul_f32 v132, v32, v32
    v_mfma_f32_16x16x32_bf16 v[84:87], a[16:19], v[104:107], v[84:87]
    ds_read_b64_tr_b16 v[154:155], v56 offset:4352
    v_mul_f32 v133, v33, v33
    v_mfma_f32_16x16x32_bf16 v[88:91], a[20:23], v[104:107], v[88:91]
    s_waitcnt lgkmcnt(6)
    ds_read_b64_tr_b16 v[156:157], v56 offset:4608
    ds_read_b128 v[104:107], v2 offset:39936
    v_mfma_f32_16x16x32_bf16 v[80:83], a[24:27], v[108:111], v[80:83]
    s_add_u32 s14, s70, 229376
    ds_read_b64_tr_b16 v[158:159], v56 offset:4864
    v_mul_f32 v134, v34, v34
    v_mfma_f32_16x16x32_bf16 v[84:87], a[28:31], v[108:111], v[84:87]
    buffer_load_dwordx4 v2, s[36:39], s23 offen offset:2048 sc1 lds
    v_mul_f32 v135, v35, v35
    v_mfma_f32_16x16x32_bf16 v[88:91], a[32:35], v[108:111], v[88:91]
    s_waitcnt lgkmcnt(8)
    ds_read_b128 v[108:111], v2 offset:40960
    v_fma_f32 v132, v132, v15, v14
    v_mfma_f32_16x16x32_bf16 v[80:83], a[36:39], v[112:115], v[80:83]
    v_fma_f32 v133, v133, v15, v14
    v_fma_f32 v134, v134, v15, v14
    v_mfma_f32_16x16x32_bf16 v[84:87], a[40:43], v[112:115], v[84:87]
    v_fma_f32 v135, v135, v15, v14
    v_mul_f32 v132, v132, v32
    v_mfma_f32_16x16x32_bf16 v[88:91], a[44:47], v[112:115], v[88:91]
    s_waitcnt lgkmcnt(8)
    buffer_load_dwordx4 v2, s[36:39], s23 offen offset:3072 sc1 lds
    ds_read_b128 v[112:115], v2 offset:41984
    v_mfma_f32_16x16x32_bf16 v[80:83], a[48:51], v[92:95], v[80:83]
    s_add_u32 m0, s12, 12288
    v_mul_f32 v133, v133, v33
    v_mul_f32 v134, v134, v34
    v_mfma_f32_16x16x32_bf16 v[84:87], a[52:55], v[92:95], v[84:87]
    s_waitcnt lgkmcnt(8)
    v_mul_f32 v135, v135, v35
    v_mul_f32 v36, v32, v36
    v_mfma_f32_16x16x32_bf16 v[88:91], a[56:59], v[92:95], v[88:91]
    s_waitcnt vmcnt(9)
    ds_read_b64_tr_b16 v[160:161], v56 offset:6144
    ds_read_b128 v[92:95], v2 offset:43008
    v_mfma_f32_16x16x32_bf16 v[80:83], a[60:63], v[96:99], v[80:83]
    buffer_load_dwordx4 v62, s[24:27], s14 offen offset:0 lds
    ds_read_b64_tr_b16 v[162:163], v56 offset:6400
    v_mfma_f32_16x16x32_bf16 v[84:87], a[64:67], v[96:99], v[84:87]
    s_waitcnt lgkmcnt(10)
    ds_read_b64_tr_b16 v[164:165], v56 offset:6656
    v_mul_f32 v37, v33, v37
    v_mfma_f32_16x16x32_bf16 v[88:91], a[68:71], v[96:99], v[88:91]
    ds_read_b64_tr_b16 v[166:167], v56 offset:6912
    ds_read_b128 v[96:99], v2 offset:44032
    v_mfma_f32_16x16x32_bf16 v[80:83], a[72:75], v[100:103], v[80:83]
    s_waitcnt lgkmcnt(8)
    s_xor_b32 s23, s82, 102400
    v_exp_f32 v132, v132
    v_mfma_f32_16x16x32_bf16 v[84:87], a[76:79], v[100:103], v[84:87]
    v_exp_f32 v133, v133
    v_mfma_f32_16x16x32_bf16 v[88:91], a[80:83], v[100:103], v[88:91]
    ds_read_b128 v[100:103], v2 offset:45056
    v_add_f32 v132, 1.0, v132
    v_mfma_f32_16x16x32_bf16 v[80:83], a[84:87], v[104:107], v[80:83]
    buffer_load_dwordx4 v0, s[24:27], s14 offen offset:1024 lds
    v_add_f32 v133, 1.0, v133
    v_mfma_f32_16x16x32_bf16 v[84:87], a[88:91], v[104:107], v[84:87]
    s_add_u32 m0, s83, 69632
    s_waitcnt lgkmcnt(8)
    v_mul_f32 v38, v34, v38
    v_mfma_f32_16x16x32_bf16 v[88:91], a[92:95], v[104:107], v[88:91]
    ds_read_b128 v[104:107], v2 offset:46080
    v_mul_f32 v39, v35, v39
    v_mfma_f32_16x16x32_bf16 v[80:83], a[96:99], v[108:111], v[80:83]
    v_exp_f32 v134, v134
    v_mfma_f32_16x16x32_bf16 v[84:87], a[100:103], v[108:111], v[84:87]
    s_waitcnt vmcnt(10) lgkmcnt(8)
    buffer_store_dword v3, v24, s[36:39], s20 offen offset:2048
    v_add_f32 v134, 1.0, v134
    v_mfma_f32_16x16x32_bf16 v[88:91], a[104:107], v[108:111], v[88:91]
    v_exp_f32 v135, v135
    v_mfma_f32_16x16x32_bf16 v[80:83], a[108:111], v[112:115], v[80:83]
    ds_read_b128 v[108:111], v2 offset:47104
    v_add_f32 v135, 1.0, v135
    v_mfma_f32_16x16x32_bf16 v[84:87], a[112:115], v[112:115], v[84:87]
    s_waitcnt vmcnt(9) lgkmcnt(7)
    buffer_load_dwordx4 v2, s[36:39], s23 offen offset:0 sc1 lds
    ds_read_b64_tr_b16 v[168:169], v56 offset:8192
    v_mfma_f32_16x16x32_bf16 v[88:91], a[116:119], v[112:115], v[88:91]
    s_waitcnt lgkmcnt(5)
    ds_read_b64_tr_b16 v[170:171], v56 offset:8448
    ds_read_b128 v[112:115], v2 offset:48128
    v_mfma_f32_16x16x32_bf16 v[80:83], a[120:123], v[92:95], v[80:83]
    v_rcp_f32 v132, v132
    v_mfma_f32_16x16x32_bf16 v[84:87], a[124:127], v[92:95], v[84:87]
    s_waitcnt lgkmcnt(6)
    ds_read_b64_tr_b16 v[172:173], v56 offset:8704
    ds_read_b64_tr_b16 v[174:175], v56 offset:8960
    v_mfma_f32_16x16x32_bf16 v[88:91], a[128:131], v[92:95], v[88:91]
    buffer_load_dwordx4 v2, s[36:39], s23 offen offset:1024 sc1 lds
    v_mul_f32 v36, v36, v132
    v_mfma_f32_16x16x32_bf16 v[80:83], a[132:135], v[96:99], v[80:83]
    v_rcp_f32 v133, v133
    v_mfma_f32_16x16x32_bf16 v[84:87], a[136:139], v[96:99], v[84:87]
    s_waitcnt lgkmcnt(7)
    v_rcp_f32 v134, v134
    v_mfma_f32_16x16x32_bf16 v[88:91], a[140:143], v[96:99], v[88:91]
    v_rcp_f32 v135, v135
    v_mfma_f32_16x16x32_bf16 v[80:83], a[144:147], v[100:103], v[80:83]
    s_add_u32 s14, s70, 393216
    v_mul_f32 v37, v37, v133
    v_mul_f32 v38, v38, v134
    v_mfma_f32_16x16x32_bf16 v[84:87], a[148:151], v[100:103], v[84:87]
    s_waitcnt lgkmcnt(6)
    buffer_load_dwordx4 v2, s[36:39], s23 offen offset:2048 sc1 lds
    ds_read_b128 v[92:95], v19 offset:1024
    v_mul_f32 v39, v39, v135
    v_mfma_f32_16x16x32_bf16 v[88:91], a[152:155], v[100:103], v[88:91]
    v_cvt_pk_bf16_f32 v42, v36, v37
    v_cvt_pk_bf16_f32 v43, v38, v39
    v_mfma_f32_16x16x32_bf16 v[80:83], a[156:159], v[104:107], v[80:83]
    v_permlane32_swap_b32 v40, v42
    v_mfma_f32_16x16x32_bf16 v[84:87], a[160:163], v[104:107], v[84:87]
    s_waitcnt vmcnt(10) lgkmcnt(6)
    ds_read_b64_tr_b16 v[176:177], v56 offset:10240
    ds_read_b128 v[96:99], v2 offset:49152
    v_mfma_f32_16x16x32_bf16 v[88:91], a[164:167], v[104:107], v[88:91]
    buffer_load_dwordx4 v2, s[36:39], s23 offen offset:3072 sc1 lds
    ds_read_b64_tr_b16 v[178:179], v56 offset:10496
    v_mfma_f32_16x16x32_bf16 v[80:83], a[168:171], v[108:111], v[80:83]
    s_add_u32 m0, s12, 0
    ds_read_b64_tr_b16 v[180:181], v56 offset:10752
    ds_read_b128 v[100:103], v2 offset:50176
    v_mfma_f32_16x16x32_bf16 v[84:87], a[172:175], v[108:111], v[84:87]
    s_waitcnt lgkmcnt(6)
    ds_read_b64_tr_b16 v[182:183], v56 offset:11008
    ds_read_b64 v[12:13], v20 offset:512
    v_mfma_f32_16x16x32_bf16 v[88:91], a[176:179], v[108:111], v[88:91]
    v_permlane32_swap_b32 v41, v43
    v_mfma_f32_16x16x32_bf16 v[80:83], a[180:183], v[112:115], v[80:83]
    buffer_store_dwordx4 v[40:43], v22, s[36:39], s17 offen sc1
    ds_read_b128 v[104:107], v2 offset:51200
    v_mfma_f32_16x16x32_bf16 v[84:87], a[184:187], v[112:115], v[84:87]
    v_permlane32_swap_b32 v120, v124
    v_mfma_f32_16x16x32_bf16 v[88:91], a[188:191], v[112:115], v[88:91]
    s_waitcnt lgkmcnt(8)
    ds_read_b128 v[108:111], v2 offset:52224
    v_mul_f32 v136, v120, v120
    v_mfma_f32_16x16x32_bf16 v[80:83], v[44:47], v[92:95], v[80:83]
    v_permlane32_swap_b32 v121, v125
    v_mfma_f32_16x16x32_bf16 v[84:87], v[48:51], v[92:95], v[84:87]
    v_permlane32_swap_b32 v122, v126
    v_mfma_f32_16x16x32_bf16 v[88:91], v[52:55], v[92:95], v[88:91]
    s_waitcnt lgkmcnt(7)
    buffer_load_dwordx4 v62, s[24:27], s14 offen offset:0 lds
    v_mul_f32 v137, v121, v121
    v_mfma_f32_16x16x32_bf16 v[32:35], a[0:3], v[96:99], 0
    v_permlane32_swap_b32 v123, v127
    v_mfma_f32_16x16x32_bf16 v[36:39], a[4:7], v[96:99], 0
    s_waitcnt lgkmcnt(2)
    ds_read_b128 v[112:115], v2 offset:53248
    v_mul_f32 v138, v122, v122
    v_mul_f32 v139, v123, v123
    v_mfma_f32_16x16x32_bf16 v[116:119], a[8:11], v[96:99], 0
    v_fma_f32 v136, v136, v17, v16
    v_fma_f32 v137, v137, v17, v16
    v_mfma_f32_16x16x32_bf16 v[32:35], a[12:15], v[100:103], v[32:35]
    v_fma_f32 v138, v138, v17, v16
    v_fma_f32 v139, v139, v17, v16
    v_mfma_f32_16x16x32_bf16 v[36:39], a[16:19], v[100:103], v[36:39]
    s_waitcnt lgkmcnt(2)
    ds_read_b128 v[92:95], v2 offset:54272
    v_mul_f32 v136, v136, v120
    v_mul_f32 v137, v137, v121
    v_mfma_f32_16x16x32_bf16 v[116:119], a[20:23], v[100:103], v[116:119]
    buffer_load_dwordx4 v0, s[24:27], s14 offen offset:1024 lds
    v_mul_f32 v138, v138, v122
    v_mfma_f32_16x16x32_bf16 v[32:35], a[24:27], v[104:107], v[32:35]
    s_add_u32 m0, s12, 2048
    s_add_u32 s14, s71, 458752
    v_mul_f32 v139, v139, v123
    v_mfma_f32_16x16x32_bf16 v[36:39], a[28:31], v[104:107], v[36:39]
    s_waitcnt lgkmcnt(2)
    ds_read_b128 v[96:99], v2 offset:55296
    v_exp_f32 v136, v136
    v_mfma_f32_16x16x32_bf16 v[116:119], a[32:35], v[104:107], v[116:119]
    v_exp_f32 v137, v137
    v_mfma_f32_16x16x32_bf16 v[32:35], a[36:39], v[108:111], v[32:35]
    v_exp_f32 v138, v138
    v_mfma_f32_16x16x32_bf16 v[36:39], a[40:43], v[108:111], v[36:39]
    ds_read_b128 v[100:103], v2 offset:56320
    v_exp_f32 v139, v139
    v_mfma_f32_16x16x32_bf16 v[116:119], a[44:47], v[108:111], v[116:119]
    s_waitcnt lgkmcnt(3)
    buffer_load_dwordx4 v62, s[24:27], s14 offen offset:0 lds
    v_add_f32 v136, 1.0, v136
    v_mfma_f32_16x16x32_bf16 v[32:35], a[48:51], v[112:115], v[32:35]
    v_add_f32 v137, 1.0, v137
    v_add_f32 v138, 1.0, v138
    v_mfma_f32_16x16x32_bf16 v[36:39], a[52:55], v[112:115], v[36:39]
    ds_read_b128 v[104:107], v2 offset:57344
    v_add_f32 v139, 1.0, v139
    v_mul_f32 v124, v120, v124
    v_mfma_f32_16x16x32_bf16 v[116:119], a[56:59], v[112:115], v[116:119]
    s_waitcnt lgkmcnt(3)
    v_rcp_f32 v136, v136
    v_mfma_f32_16x16x32_bf16 v[32:35], a[60:63], v[92:95], v[32:35]
    v_rcp_f32 v137, v137
    v_mfma_f32_16x16x32_bf16 v[36:39], a[64:67], v[92:95], v[36:39]
    ds_read_b128 v[108:111], v2 offset:58368
    v_rcp_f32 v138, v138
    v_mfma_f32_16x16x32_bf16 v[116:119], a[68:71], v[92:95], v[116:119]
    s_waitcnt lgkmcnt(3)
    buffer_load_dwordx4 v0, s[24:27], s14 offen offset:1024 lds
    v_mul_f32 v125, v121, v125
    v_mfma_f32_16x16x32_bf16 v[32:35], a[72:75], v[96:99], v[32:35]
    s_add_u32 m0, s12, 4096
    s_add_u32 s14, s70, 622592
    s_waitcnt vmcnt(10)
    v_mfma_f32_16x16x32_bf16 v[36:39], a[76:79], v[96:99], v[36:39]
    ds_read_b64_tr_b16 v[184:185], v56 offset:12288
    ds_read_b64_tr_b16 v[186:187], v56 offset:12544
    ds_read_b128 v[112:115], v2 offset:59392
    v_mfma_f32_16x16x32_bf16 v[116:119], a[80:83], v[96:99], v[116:119]
    s_waitcnt lgkmcnt(5)
    ds_read_b64_tr_b16 v[188:189], v56 offset:12800
    v_mul_f32 v126, v122, v126
    v_mfma_f32_16x16x32_bf16 v[32:35], a[84:87], v[100:103], v[32:35]
    ds_read_b64_tr_b16 v[190:191], v56 offset:13056
    v_mul_f32 v127, v123, v127
    v_mfma_f32_16x16x32_bf16 v[36:39], a[88:91], v[100:103], v[36:39]
    buffer_load_dwordx4 v62, s[24:27], s14 offen offset:0 lds
    ds_read_b128 v[92:95], v2 offset:60416
    v_mul_f32 v124, v124, v136
    v_mfma_f32_16x16x32_bf16 v[116:119], a[92:95], v[100:103], v[116:119]
    s_waitcnt lgkmcnt(7)
    v_rcp_f32 v139, v139
    v_mfma_f32_16x16x32_bf16 v[32:35], a[96:99], v[104:107], v[32:35]
    v_mul_f32 v125, v125, v137
    v_mul_f32 v126, v126, v138
    v_mfma_f32_16x16x32_bf16 v[36:39], a[100:103], v[104:107], v[36:39]
    buffer_load_dword v27, v5, s[36:39], s22 offen offset:2048 sc1
    ds_read_b128 v[96:99], v2 offset:61440
    v_mul_f32 v127, v127, v139
    v_mfma_f32_16x16x32_bf16 v[116:119], a[104:107], v[104:107], v[116:119]
    s_waitcnt lgkmcnt(7)
    v_cvt_pk_bf16_f32 v28, v124, v125
    v_cvt_pk_bf16_f32 v29, v126, v127
    v_mfma_f32_16x16x32_bf16 v[32:35], a[108:111], v[108:111], v[32:35]
    v_cvt_pk_bf16_f32 v30, v124, v125
    v_cvt_pk_bf16_f32 v31, v126, v127
    v_mfma_f32_16x16x32_bf16 v[36:39], a[112:115], v[108:111], v[36:39]
    ds_read_b128 v[100:103], v2 offset:62464
    v_permlane16_swap_b32 v28, v30
    v_mfma_f32_16x16x32_bf16 v[116:119], a[116:119], v[108:111], v[116:119]
    s_waitcnt lgkmcnt(5)
    buffer_load_dwordx4 v0, s[24:27], s14 offen offset:1024 lds
    ds_read_b128 v[104:107], v2 offset:63488
    v_mfma_f32_16x16x32_bf16 v[32:35], a[120:123], v[112:115], v[32:35]
    s_add_u32 m0, s12, 6144
    s_add_u32 s14, s70, 786432
    ds_read_b128 v[108:111], v2 offset:64512
    v_mfma_f32_16x16x32_bf16 v[36:39], a[124:127], v[112:115], v[36:39]
    v_permlane16_swap_b32 v29, v31
    v_mfma_f32_16x16x32_bf16 v[116:119], a[128:131], v[112:115], v[116:119]
    s_waitcnt lgkmcnt(4)
    buffer_store_dwordx4 v[28:31], v23, s[36:39], s17 offen sc1
    ds_read_b128 v[112:115], v19 offset:1280
    v_mfma_f32_16x16x32_bf16 v[32:35], a[132:135], v[92:95], v[32:35]
    v_mul_f32 v128, v80, v80
    v_mul_f32 v129, v81, v81
    v_mfma_f32_16x16x32_bf16 v[36:39], a[136:139], v[92:95], v[36:39]
    v_mul_f32 v130, v82, v82
    v_mul_f32 v131, v83, v83
    v_mfma_f32_16x16x32_bf16 v[116:119], a[140:143], v[92:95], v[116:119]
    s_waitcnt lgkmcnt(4)
    v_fma_f32 v128, v128, v13, v12
    v_fma_f32 v129, v129, v13, v12
    v_mfma_f32_16x16x32_bf16 v[32:35], a[144:147], v[96:99], v[32:35]
    v_fma_f32 v130, v130, v13, v12
    v_fma_f32 v131, v131, v13, v12
    v_mfma_f32_16x16x32_bf16 v[36:39], a[148:151], v[96:99], v[36:39]
    buffer_load_dwordx4 v62, s[24:27], s14 offen offset:0 lds
    v_mul_f32 v128, v128, v80
    v_mfma_f32_16x16x32_bf16 v[116:119], a[152:155], v[96:99], v[116:119]
    s_waitcnt lgkmcnt(3)
    v_mul_f32 v129, v129, v81
    v_mul_f32 v130, v130, v82
    v_mfma_f32_16x16x32_bf16 v[32:35], a[156:159], v[100:103], v[32:35]
    ds_read_b64 v[14:15], v20 offset:640
    v_mul_f32 v131, v131, v83
    v_mfma_f32_16x16x32_bf16 v[36:39], a[160:163], v[100:103], v[36:39]
    s_waitcnt vmcnt(10)
    s_barrier
    ds_read_b128 v[92:95], v18 offset:0
    v_mfma_f32_16x16x32_bf16 v[116:119], a[164:167], v[100:103], v[116:119]
    s_waitcnt lgkmcnt(4)
    ds_read_b128 v[96:99], v18 offset:1024
    ds_read_b64 v[16:17], v21 offset:512
    v_mfma_f32_16x16x32_bf16 v[32:35], a[168:171], v[104:107], v[32:35]
    v_exp_f32 v128, v128
    v_mfma_f32_16x16x32_bf16 v[36:39], a[172:175], v[104:107], v[36:39]
    s_waitcnt lgkmcnt(5)
    buffer_load_dwordx4 v0, s[24:27], s14 offen offset:1024 lds
    v_add_f32 v128, 1.0, v128
    v_mfma_f32_16x16x32_bf16 v[116:119], a[176:179], v[104:107], v[116:119]
    s_add_u32 m0, s12, 8192
    s_add_u32 s14, s71, 851968
    v_mul_f32 v84, v80, v84
    v_mfma_f32_16x16x32_bf16 v[32:35], a[180:183], v[108:111], v[32:35]
    v_exp_f32 v129, v129
    v_mfma_f32_16x16x32_bf16 v[36:39], a[184:187], v[108:111], v[36:39]
    s_waitcnt lgkmcnt(4)
    ds_read_b128 v[100:103], v18 offset:2048
    v_exp_f32 v130, v130
    v_mfma_f32_16x16x32_bf16 v[116:119], a[188:191], v[108:111], v[116:119]
    v_exp_f32 v131, v131
    v_mfma_f32_16x16x32_bf16 v[32:35], v[44:47], v[112:115], v[32:35]
    v_add_f32 v129, 1.0, v129
    v_add_f32 v130, 1.0, v130
    v_mfma_f32_16x16x32_bf16 v[36:39], v[48:51], v[112:115], v[36:39]
    buffer_load_dwordx4 v62, s[24:27], s14 offen offset:0 lds
    ds_read_b128 v[104:107], v18 offset:3072
    v_add_f32 v131, 1.0, v131
    v_rcp_f32 v128, v128
    v_rcp_f32 v129, v129
    v_rcp_f32 v130, v130
    v_rcp_f32 v131, v131
    v_mfma_f32_16x16x32_bf16 v[116:119], v[52:55], v[112:115], v[116:119]
    s_waitcnt lgkmcnt(4)
    v_mul_f32 v85, v81, v85
    v_mul_f32 v86, v82, v86
    v_mul_f32 v87, v83, v87
    v_mul_f32 v84, v84, v128
    v_mul_f32 v85, v85, v129
    v_mul_f32 v86, v86, v130
    v_mul_f32 v87, v87, v131
    v_mfma_f32_16x16x32_bf16 v[80:83], a[0:3], v[92:95], 0
    v_cvt_pk_bf16_f32 v40, v84, v85
    v_cvt_pk_bf16_f32 v41, v86, v87
    v_mfma_f32_16x16x32_bf16 v[84:87], a[4:7], v[92:95], 0
    s_waitcnt lgkmcnt(2)
    ds_read_b128 v[108:111], v18 offset:4096
    ds_read_b128 v[112:115], v18 offset:5120
    v_mfma_f32_16x16x32_bf16 v[120:123], a[8:11], v[92:95], 0
    s_waitcnt vmcnt(9)
    ds_read_b64_tr_b16 v[192:193], v56 offset:0
    ds_read_b128 v[92:95], v18 offset:6144
    v_mfma_f32_16x16x32_bf16 v[80:83], a[12:15], v[96:99], v[80:83]
    ds_read_b64_tr_b16 v[194:195], v56 offset:256
    v_mul_f32 v132, v32, v32
    v_mfma_f32_16x16x32_bf16 v[84:87], a[16:19], v[96:99], v[84:87]
    buffer_load_dwordx4 v0, s[24:27], s14 offen offset:1024 lds
    ds_read_b64_tr_b16 v[196:197], v56 offset:512
    v_mfma_f32_16x16x32_bf16 v[120:123], a[20:23], v[96:99], v[120:123]
    s_add_u32 m0, s12, 10240
    s_add_u32 s14, s70, 1015808
    s_waitcnt lgkmcnt(7)
    ds_read_b64_tr_b16 v[198:199], v56 offset:768
    v_mfma_f32_16x16x32_bf16 v[80:83], a[24:27], v[100:103], v[80:83]
    ds_read_b128 v[96:99], v18 offset:7168
    v_mul_f32 v133, v33, v33
    v_mfma_f32_16x16x32_bf16 v[84:87], a[28:31], v[100:103], v[84:87]
    v_mul_f32 v134, v34, v34
    v_mul_f32 v135, v35, v35
    v_mfma_f32_16x16x32_bf16 v[120:123], a[32:35], v[100:103], v[120:123]
    s_waitcnt lgkmcnt(8)
    ds_read_b128 v[100:103], v18 offset:8192
    v_fma_f32 v132, v132, v15, v14
    v_mfma_f32_16x16x32_bf16 v[80:83], a[36:39], v[104:107], v[80:83]
    s_waitcnt vmcnt(6)
PP_22:
    v_cmp_ne_u32 vcc, s44, v27
    s_cbranch_vccnz PR_24
PC_23:
    v_mfma_f32_16x16x32_bf16 v[84:87], a[40:43], v[104:107], v[84:87]
    buffer_load_dwordx4 v62, s[24:27], s14 offen offset:0 lds
    v_fma_f32 v133, v133, v15, v14
    v_mfma_f32_16x16x32_bf16 v[120:123], a[44:47], v[104:107], v[120:123]
    s_waitcnt lgkmcnt(8)
    ds_read_b128 v[104:107], v18 offset:9216
    v_fma_f32 v134, v134, v15, v14
    v_mfma_f32_16x16x32_bf16 v[80:83], a[48:51], v[108:111], v[80:83]
    v_fma_f32 v135, v135, v15, v14
    v_mul_f32 v132, v132, v32
    v_mfma_f32_16x16x32_bf16 v[84:87], a[52:55], v[108:111], v[84:87]
    s_waitcnt lgkmcnt(8)
    v_mul_f32 v133, v133, v33
    v_mul_f32 v134, v134, v34
    v_mfma_f32_16x16x32_bf16 v[120:123], a[56:59], v[108:111], v[120:123]
    ds_read_b128 v[108:111], v18 offset:10240
    v_mul_f32 v135, v135, v35
    v_mfma_f32_16x16x32_bf16 v[80:83], a[60:63], v[112:115], v[80:83]
    v_exp_f32 v132, v132
    v_mfma_f32_16x16x32_bf16 v[84:87], a[64:67], v[112:115], v[84:87]
    s_waitcnt lgkmcnt(7)
    buffer_load_dwordx4 v0, s[24:27], s14 offen offset:1024 lds
    v_add_f32 v132, 1.0, v132
    v_mfma_f32_16x16x32_bf16 v[120:123], a[68:71], v[112:115], v[120:123]
    s_waitcnt lgkmcnt(4)
    s_add_u32 m0, s12, 12288
    s_add_u32 s14, s70, 1179648
    ds_read_b128 v[112:115], v18 offset:11264
    v_mfma_f32_16x16x32_bf16 v[80:83], a[72:75], v[92:95], v[80:83]
    v_exp_f32 v133, v133
    v_mfma_f32_16x16x32_bf16 v[84:87], a[76:79], v[92:95], v[84:87]
    s_waitcnt lgkmcnt(4)
    v_exp_f32 v134, v134
    v_mfma_f32_16x16x32_bf16 v[120:123], a[80:83], v[92:95], v[120:123]
    ds_read_b128 v[92:95], v18 offset:12288
    v_add_f32 v133, 1.0, v133
    v_mfma_f32_16x16x32_bf16 v[80:83], a[84:87], v[96:99], v[80:83]
    v_exp_f32 v135, v135
    v_mfma_f32_16x16x32_bf16 v[84:87], a[88:91], v[96:99], v[84:87]
    s_waitcnt lgkmcnt(4)
    buffer_load_dwordx4 v[208:211], v2, s[36:39], s8 offen offset:0 sc1
    v_add_f32 v134, 1.0, v134
    v_mfma_f32_16x16x32_bf16 v[120:123], a[92:95], v[96:99], v[120:123]
    v_add_f32 v135, 1.0, v135
    v_mul_f32 v36, v32, v36
    v_mfma_f32_16x16x32_bf16 v[80:83], a[96:99], v[100:103], v[80:83]
    v_rcp_f32 v132, v132
    v_mfma_f32_16x16x32_bf16 v[84:87], a[100:103], v[100:103], v[84:87]
    s_waitcnt lgkmcnt(3)
    v_rcp_f32 v133, v133
    v_mfma_f32_16x16x32_bf16 v[120:123], a[104:107], v[100:103], v[120:123]
    buffer_load_dwordx4 v62, s[24:27], s14 offen offset:0 lds
    v_mul_f32 v37, v33, v37
    v_mfma_f32_16x16x32_bf16 v[80:83], a[108:111], v[104:107], v[80:83]
    v_rcp_f32 v134, v134
    v_mfma_f32_16x16x32_bf16 v[84:87], a[112:115], v[104:107], v[84:87]
    s_waitcnt lgkmcnt(2)
    ds_read_b128 v[96:99], v18 offset:13312
    v_rcp_f32 v135, v135
    v_mfma_f32_16x16x32_bf16 v[120:123], a[116:119], v[104:107], v[120:123]
    v_mul_f32 v38, v34, v38
    v_mul_f32 v39, v35, v39
    v_mfma_f32_16x16x32_bf16 v[80:83], a[120:123], v[108:111], v[80:83]
    v_mul_f32 v36, v36, v132
    v_mul_f32 v37, v37, v133
    v_mfma_f32_16x16x32_bf16 v[84:87], a[124:127], v[108:111], v[84:87]
    s_waitcnt lgkmcnt(2)
    ds_read_b128 v[100:103], v18 offset:14336
    v_mul_f32 v38, v38, v134
    v_mul_f32 v39, v39, v135
    v_mfma_f32_16x16x32_bf16 v[120:123], a[128:131], v[108:111], v[120:123]
    buffer_load_dwordx4 v[212:215], v2, s[36:39], s8 offen offset:1024 sc1
    v_cvt_pk_bf16_f32 v42, v36, v37
    v_mfma_f32_16x16x32_bf16 v[80:83], a[132:135], v[112:115], v[80:83]
    ds_read_b128 v[104:107], v18 offset:15360
    v_cvt_pk_bf16_f32 v43, v38, v39
    v_mfma_f32_16x16x32_bf16 v[84:87], a[136:139], v[112:115], v[84:87]
    s_waitcnt vmcnt(9) lgkmcnt(3)
    buffer_store_dword v3, v24, s[36:39], s20 offen offset:2176
    ds_read_b128 v[108:111], v19 offset:1536
    v_mfma_f32_16x16x32_bf16 v[120:123], a[140:143], v[112:115], v[120:123]
    v_permlane32_swap_b32 v40, v42
    v_mfma_f32_16x16x32_bf16 v[80:83], a[144:147], v[92:95], v[80:83]
    v_permlane32_swap_b32 v41, v43
    v_mfma_f32_16x16x32_bf16 v[84:87], a[148:151], v[92:95], v[84:87]
    buffer_store_dwordx4 v[40:43], v22, s[36:39], s18 offen
    ds_read_b128 v[112:115], v18 offset:16384
    v_mfma_f32_16x16x32_bf16 v[120:123], a[152:155], v[92:95], v[120:123]
    s_waitcnt lgkmcnt(4)
    ds_read_b128 v[92:95], v18 offset:17408
    v_mfma_f32_16x16x32_bf16 v[80:83], a[156:159], v[96:99], v[80:83]
    ds_read_b64 v[12:13], v20 offset:768
    v_mfma_f32_16x16x32_bf16 v[84:87], a[160:163], v[96:99], v[84:87]
    v_permlane32_swap_b32 v88, v116
    v_mfma_f32_16x16x32_bf16 v[120:123], a[164:167], v[96:99], v[120:123]
    s_waitcnt lgkmcnt(5)
    buffer_load_dwordx4 v0, s[24:27], s14 offen offset:1024 lds
    ds_read_b128 v[96:99], v18 offset:18432
    v_mfma_f32_16x16x32_bf16 v[80:83], a[168:171], v[100:103], v[80:83]
    s_add_u32 m0, s12, 0
    s_add_u32 s14, s71, 1245184
    v_mul_f32 v136, v88, v88
    v_mfma_f32_16x16x32_bf16 v[84:87], a[172:175], v[100:103], v[84:87]
    s_waitcnt lgkmcnt(5)
    v_permlane32_swap_b32 v89, v117
    v_mfma_f32_16x16x32_bf16 v[120:123], a[176:179], v[100:103], v[120:123]
    v_permlane32_swap_b32 v90, v118
    v_mfma_f32_16x16x32_bf16 v[80:83], a[180:183], v[104:107], v[80:83]
    v_permlane32_swap_b32 v91, v119
    v_mfma_f32_16x16x32_bf16 v[84:87], a[184:187], v[104:107], v[84:87]
    s_waitcnt lgkmcnt(4)
    v_mul_f32 v137, v89, v89
    v_mul_f32 v138, v90, v90
    v_mfma_f32_16x16x32_bf16 v[120:123], a[188:191], v[104:107], v[120:123]
    buffer_load_dwordx4 v[216:219], v2, s[36:39], s8 offen offset:2048 sc1
    v_mul_f32 v139, v91, v91
    v_mfma_f32_16x16x32_bf16 v[80:83], v[44:47], v[108:111], v[80:83]
    v_fma_f32 v136, v136, v17, v16
    v_fma_f32 v137, v137, v17, v16
    v_mfma_f32_16x16x32_bf16 v[84:87], v[48:51], v[108:111], v[84:87]
    s_waitcnt lgkmcnt(3)
    ds_read_b128 v[100:103], v18 offset:19456
    v_fma_f32 v138, v138, v17, v16
    v_fma_f32 v139, v139, v17, v16
    v_mfma_f32_16x16x32_bf16 v[120:123], v[52:55], v[108:111], v[120:123]
    v_mul_f32 v136, v136, v88
    v_mul_f32 v137, v137, v89
    v_mfma_f32_16x16x32_bf16 v[32:35], a[0:3], v[112:115], 0
    buffer_load_dwordx4 v[220:223], v2, s[36:39], s8 offen offset:3072 sc1
    v_mul_f32 v138, v138, v90
    v_mfma_f32_16x16x32_bf16 v[36:39], a[4:7], v[112:115], 0
    s_waitcnt lgkmcnt(2)
    ds_read_b128 v[104:107], v18 offset:20480
    v_mul_f32 v139, v139, v91
    v_mul_f32 v116, v88, v116
    v_mfma_f32_16x16x32_bf16 v[124:127], a[8:11], v[112:115], 0
    v_exp_f32 v136, v136
    v_mfma_f32_16x16x32_bf16 v[32:35], a[12:15], v[92:95], v[32:35]
    v_exp_f32 v137, v137
    v_mfma_f32_16x16x32_bf16 v[36:39], a[16:19], v[92:95], v[36:39]
    s_waitcnt lgkmcnt(2)
    buffer_load_dwordx4 v62, s[24:27], s14 offen offset:0 lds
    ds_read_b128 v[108:111], v18 offset:21504
    v_add_f32 v136, 1.0, v136
    v_mfma_f32_16x16x32_bf16 v[124:127], a[20:23], v[92:95], v[124:127]
    v_exp_f32 v138, v138
    v_mfma_f32_16x16x32_bf16 v[32:35], a[24:27], v[96:99], v[32:35]
    v_exp_f32 v139, v139
    v_mfma_f32_16x16x32_bf16 v[36:39], a[28:31], v[96:99], v[36:39]
    ds_read_b128 v[112:115], v18 offset:22528
    v_add_f32 v137, 1.0, v137
    v_add_f32 v138, 1.0, v138
    v_mfma_f32_16x16x32_bf16 v[124:127], a[32:35], v[96:99], v[124:127]
    s_waitcnt lgkmcnt(3)
    v_add_f32 v139, 1.0, v139
    v_mul_f32 v117, v89, v117
    v_mfma_f32_16x16x32_bf16 v[32:35], a[36:39], v[100:103], v[32:35]
    v_rcp_f32 v136, v136
    v_mfma_f32_16x16x32_bf16 v[36:39], a[40:43], v[100:103], v[36:39]
    buffer_load_dwordx4 v[224:227], v25, s[36:39], s8 offen offset:0 sc1
    ds_read_b128 v[92:95], v18 offset:23552
    v_mul_f32 v118, v90, v118
    v_mfma_f32_16x16x32_bf16 v[124:127], a[44:47], v[100:103], v[124:127]
    s_waitcnt lgkmcnt(3)
    v_rcp_f32 v137, v137
    v_mfma_f32_16x16x32_bf16 v[32:35], a[48:51], v[104:107], v[32:35]
    v_rcp_f32 v138, v138
    v_mfma_f32_16x16x32_bf16 v[36:39], a[52:55], v[104:107], v[36:39]
    ds_read_b128 v[96:99], v18 offset:24576
    v_rcp_f32 v139, v139
    v_mfma_f32_16x16x32_bf16 v[124:127], a[56:59], v[104:107], v[124:127]
    s_waitcnt lgkmcnt(3)
    buffer_load_dwordx4 v0, s[24:27], s14 offen offset:1024 lds
    v_mul_f32 v119, v91, v119
    v_mfma_f32_16x16x32_bf16 v[32:35], a[60:63], v[108:111], v[32:35]
    v_mul_f32 v116, v116, v136
    v_mul_f32 v117, v117, v137
    v_mfma_f32_16x16x32_bf16 v[36:39], a[64:67], v[108:111], v[36:39]
    ds_read_b128 v[100:103], v18 offset:25600
    v_mul_f32 v118, v118, v138
    v_mul_f32 v119, v119, v139
    v_mfma_f32_16x16x32_bf16 v[124:127], a[68:71], v[108:111], v[124:127]
    s_waitcnt lgkmcnt(3)
    v_cvt_pk_bf16_f32 v28, v116, v117
    v_cvt_pk_bf16_f32 v29, v118, v119
    v_mfma_f32_16x16x32_bf16 v[32:35], a[72:75], v[112:115], v[32:35]
    v_cvt_pk_bf16_f32 v30, v116, v117
    v_cvt_pk_bf16_f32 v31, v118, v119
    v_mfma_f32_16x16x32_bf16 v[36:39], a[76:79], v[112:115], v[36:39]
    buffer_load_dword v27, v58, s[36:39], s13 offen offset:2176 sc1
    ds_read_b128 v[104:107], v18 offset:26624
    v_mfma_f32_16x16x32_bf16 v[124:127], a[80:83], v[112:115], v[124:127]
    s_waitcnt lgkmcnt(3)
    v_permlane16_swap_b32 v28, v30
    v_mfma_f32_16x16x32_bf16 v[32:35], a[84:87], v[92:95], v[32:35]
    buffer_load_dwordx4 v[228:231], v25, s[36:39], s8 offen offset:1024 sc1
    ds_read_b128 v[108:111], v18 offset:27648
    v_mfma_f32_16x16x32_bf16 v[36:39], a[88:91], v[92:95], v[36:39]
    v_permlane16_swap_b32 v29, v31
    v_mfma_f32_16x16x32_bf16 v[124:127], a[92:95], v[92:95], v[124:127]
    s_waitcnt lgkmcnt(3)
    buffer_store_dwordx4 v[28:31], v23, s[36:39], s18 offen
    ds_read_b128 v[112:115], v18 offset:28672
    v_mfma_f32_16x16x32_bf16 v[32:35], a[96:99], v[96:99], v[32:35]
    ds_read_b128 v[92:95], v18 offset:29696
    v_mul_f32 v128, v80, v80
    v_mfma_f32_16x16x32_bf16 v[36:39], a[100:103], v[96:99], v[36:39]
    v_mul_f32 v129, v81, v81
    v_mul_f32 v130, v82, v82
    v_mfma_f32_16x16x32_bf16 v[124:127], a[104:107], v[96:99], v[124:127]
    s_waitcnt lgkmcnt(4)
    ds_read_b128 v[96:99], v18 offset:30720
    v_mul_f32 v131, v83, v83
    v_mfma_f32_16x16x32_bf16 v[32:35], a[108:111], v[100:103], v[32:35]
    buffer_load_dwordx4 v[232:235], v25, s[36:39], s8 offen offset:2048 sc1
    v_fma_f32 v128, v128, v13, v12
    v_mfma_f32_16x16x32_bf16 v[36:39], a[112:115], v[100:103], v[36:39]
    v_fma_f32 v129, v129, v13, v12
    v_fma_f32 v130, v130, v13, v12
    v_mfma_f32_16x16x32_bf16 v[124:127], a[116:119], v[100:103], v[124:127]
    s_waitcnt lgkmcnt(4)
    ds_read_b128 v[100:103], v18 offset:31744
    v_fma_f32 v131, v131, v13, v12
    v_mfma_f32_16x16x32_bf16 v[32:35], a[120:123], v[104:107], v[32:35]
    v_mul_f32 v128, v128, v80
    v_mul_f32 v129, v129, v81
    v_mfma_f32_16x16x32_bf16 v[36:39], a[124:127], v[104:107], v[36:39]
    s_waitcnt lgkmcnt(4)
    buffer_load_dwordx4 v[236:239], v25, s[36:39], s8 offen offset:3072 sc1
    v_mul_f32 v130, v130, v82
    v_mfma_f32_16x16x32_bf16 v[124:127], a[128:131], v[104:107], v[124:127]
    ds_read_b128 v[104:107], v19 offset:1792
    v_mul_f32 v131, v131, v83
    v_mfma_f32_16x16x32_bf16 v[32:35], a[132:135], v[108:111], v[32:35]
    v_exp_f32 v128, v128
    v_mfma_f32_16x16x32_bf16 v[36:39], a[136:139], v[108:111], v[36:39]
    s_waitcnt lgkmcnt(4)
    v_exp_f32 v129, v129
    v_mfma_f32_16x16x32_bf16 v[124:127], a[140:143], v[108:111], v[124:127]
    buffer_load_dwordx4 v[240:243], v26, s[36:39], s8 offen offset:0 sc1
    v_add_f32 v128, 1.0, v128
    v_mfma_f32_16x16x32_bf16 v[32:35], a[144:147], v[112:115], v[32:35]
    v_exp_f32 v130, v130
    v_mfma_f32_16x16x32_bf16 v[36:39], a[148:151], v[112:115], v[36:39]
    s_waitcnt lgkmcnt(3)
    v_exp_f32 v131, v131
    v_mfma_f32_16x16x32_bf16 v[124:127], a[152:155], v[112:115], v[124:127]
    v_add_f32 v129, 1.0, v129
    v_add_f32 v130, 1.0, v130
    v_mfma_f32_16x16x32_bf16 v[32:35], a[156:159], v[92:95], v[32:35]
    ds_read_b64 v[14:15], v20 offset:896
    v_add_f32 v131, 1.0, v131
    v_mfma_f32_16x16x32_bf16 v[36:39], a[160:163], v[92:95], v[36:39]
    s_waitcnt lgkmcnt(3)
    buffer_load_dwordx4 v[244:247], v26, s[36:39], s8 offen offset:1024 sc1
    ds_read_b64 v[16:17], v21 offset:768
    v_mfma_f32_16x16x32_bf16 v[124:127], a[164:167], v[92:95], v[124:127]
    v_rcp_f32 v128, v128
    v_mfma_f32_16x16x32_bf16 v[32:35], a[168:171], v[96:99], v[32:35]
    v_rcp_f32 v129, v129
    v_mfma_f32_16x16x32_bf16 v[36:39], a[172:175], v[96:99], v[36:39]
    s_waitcnt lgkmcnt(3)
    v_rcp_f32 v130, v130
    v_mfma_f32_16x16x32_bf16 v[124:127], a[176:179], v[96:99], v[124:127]
    buffer_load_dwordx4 v[248:251], v26, s[36:39], s8 offen offset:2048 sc1
    v_mul_f32 v84, v80, v84
    v_mfma_f32_16x16x32_bf16 v[32:35], a[180:183], v[100:103], v[32:35]
    v_rcp_f32 v131, v131
    v_mfma_f32_16x16x32_bf16 v[36:39], a[184:187], v[100:103], v[36:39]
    s_waitcnt lgkmcnt(2)
    v_mul_f32 v85, v81, v85
    v_mul_f32 v86, v82, v86
    v_mfma_f32_16x16x32_bf16 v[124:127], a[188:191], v[100:103], v[124:127]
    s_waitcnt vmcnt(5)
    buffer_store_dword v3, v24, s[36:39], s21 offen offset:2304
    v_mul_f32 v87, v83, v87
    v_mfma_f32_16x16x32_bf16 v[32:35], v[44:47], v[104:107], v[32:35]
    v_mul_f32 v84, v84, v128
    v_mul_f32 v85, v85, v129
    v_mfma_f32_16x16x32_bf16 v[36:39], v[48:51], v[104:107], v[36:39]
PP_25:
    v_cmp_ne_u32 vcc, s44, v27
    s_cbranch_vccnz PR_27
PC_26:
    v_mul_f32 v86, v86, v130
    v_mul_f32 v87, v87, v131
    v_mfma_f32_16x16x32_bf16 v[124:127], v[52:55], v[104:107], v[124:127]
    buffer_load_dwordx4 a[0:3], v2, s[36:39], s9 offen offset:0 sc1
    v_cvt_pk_bf16_f32 v40, v84, v85
    v_cvt_pk_bf16_f32 v41, v86, v87
    v_mfma_f32_32x32x16_bf16 v[80:95], a[192:195], v[208:211], 0
    v_mul_f32 v132, v32, v32
    v_mul_f32 v133, v33, v33
    v_mul_f32 v134, v34, v34
    v_mul_f32 v135, v35, v35
    v_mfma_f32_32x32x16_bf16 v[96:111], a[196:199], v[208:211], 0
    s_waitcnt lgkmcnt(0)
    buffer_load_dwordx4 a[4:7], v2, s[36:39], s9 offen offset:1024 sc1
    v_fma_f32 v132, v132, v15, v14
    v_fma_f32 v133, v133, v15, v14
    v_fma_f32 v134, v134, v15, v14
    v_fma_f32 v135, v135, v15, v14
    v_mul_f32 v132, v132, v32
    v_mfma_f32_32x32x16_bf16 v[80:95], a[200:203], v[212:215], v[80:95]
    v_permlane32_swap_b32 v120, v124
    v_permlane32_swap_b32 v121, v125
    v_permlane32_swap_b32 v122, v126
    v_mfma_f32_32x32x16_bf16 v[96:111], a[204:207], v[212:215], v[96:111]
    buffer_load_dwordx4 a[8:11], v2, s[36:39], s9 offen offset:2048 sc1
    v_permlane32_swap_b32 v123, v127
    v_mul_f32 v133, v133, v33
    v_mul_f32 v134, v134, v34
    v_mul_f32 v135, v135, v35
    v_mfma_f32_32x32x16_bf16 v[80:95], a[208:211], v[216:219], v[80:95]
    v_exp_f32 v132, v132
    v_exp_f32 v133, v133
    v_exp_f32 v134, v134
    v_mfma_f32_32x32x16_bf16 v[96:111], a[212:215], v[216:219], v[96:111]
    buffer_load_dwordx4 a[12:15], v2, s[36:39], s9 offen offset:3072 sc1
    v_exp_f32 v135, v135
    v_mul_f32 v136, v120, v120
    v_mul_f32 v137, v121, v121
    v_mul_f32 v138, v122, v122
    v_mfma_f32_32x32x16_bf16 v[80:95], a[216:219], v[220:223], v[80:95]
    v_mul_f32 v139, v123, v123
    v_fma_f32 v136, v136, v17, v16
    v_fma_f32 v137, v137, v17, v16
    v_fma_f32 v138, v138, v17, v16
    v_fma_f32 v139, v139, v17, v16
    v_mul_f32 v136, v136, v120
    v_mfma_f32_32x32x16_bf16 v[96:111], a[220:223], v[220:223], v[96:111]
    buffer_load_dwordx4 a[16:19], v25, s[36:39], s9 offen offset:0 sc1
    v_mul_f32 v137, v137, v121
    v_mul_f32 v138, v138, v122
    v_mul_f32 v139, v139, v123
    v_exp_f32 v136, v136
    v_mfma_f32_32x32x16_bf16 v[80:95], a[224:227], v[224:227], v[80:95]
    v_exp_f32 v137, v137
    v_exp_f32 v138, v138
    v_exp_f32 v139, v139
    v_mfma_f32_32x32x16_bf16 v[96:111], a[228:231], v[224:227], v[96:111]
    buffer_load_dwordx4 a[20:23], v25, s[36:39], s9 offen offset:1024 sc1
    v_add_f32 v132, 1.0, v132
    v_add_f32 v133, 1.0, v133
    v_add_f32 v134, 1.0, v134
    v_add_f32 v135, 1.0, v135
    v_add_f32 v136, 1.0, v136
    v_mfma_f32_32x32x16_bf16 v[80:95], a[232:235], v[228:231], v[80:95]
    s_waitcnt vmcnt(11)
    buffer_load_dword v27, v5, s[36:39], s22 offen offset:2304 sc1
    v_rcp_f32 v132, v132
    v_rcp_f32 v133, v133
    v_add_f32 v137, 1.0, v137
    v_mfma_f32_32x32x16_bf16 v[96:111], a[236:239], v[228:231], v[96:111]
    v_rcp_f32 v134, v134
    v_rcp_f32 v135, v135
    v_add_f32 v138, 1.0, v138
    v_add_f32 v139, 1.0, v139
    v_mfma_f32_32x32x16_bf16 v[80:95], a[240:243], v[232:235], v[80:95]
    s_waitcnt vmcnt(11)
    buffer_load_dwordx4 a[24:27], v25, s[36:39], s9 offen offset:2048 sc1
    v_rcp_f32 v136, v136
    v_rcp_f32 v137, v137
    v_mul_f32 v36, v32, v36
    v_mfma_f32_32x32x16_bf16 v[96:111], a[244:247], v[232:235], v[96:111]
    v_rcp_f32 v138, v138
    v_rcp_f32 v139, v139
    v_mul_f32 v37, v33, v37
    v_mul_f32 v38, v34, v38
    v_mfma_f32_32x32x16_bf16 v[80:95], a[248:251], v[236:239], v[80:95]
    s_waitcnt vmcnt(11)
    buffer_load_dwordx4 a[28:31], v25, s[36:39], s9 offen offset:3072 sc1
    v_mul_f32 v39, v35, v39
    v_mul_f32 v36, v36, v132
    v_mul_f32 v37, v37, v133
    v_mul_f32 v38, v38, v134
    v_mul_f32 v39, v39, v135
    v_mfma_f32_32x32x16_bf16 v[96:111], a[252:255], v[236:239], v[96:111]
    v_cvt_pk_bf16_f32 v42, v36, v37
    v_cvt_pk_bf16_f32 v43, v38, v39
    v_mul_f32 v124, v120, v124
    v_mul_f32 v125, v121, v125
    v_mul_f32 v126, v122, v126
    v_mul_f32 v127, v123, v127
    v_mfma_f32_32x32x16_bf16 v[80:95], v[144:147], v[240:243], v[80:95]
    s_waitcnt vmcnt(11)
    buffer_load_dwordx4 a[32:35], v26, s[36:39], s9 offen offset:0 sc1
    v_mul_f32 v124, v124, v136
    v_mul_f32 v125, v125, v137
    v_mul_f32 v126, v126, v138
    v_mul_f32 v127, v127, v139
    v_cvt_pk_bf16_f32 v28, v124, v125
    v_mfma_f32_32x32x16_bf16 v[96:111], v[148:151], v[240:243], v[96:111]
    v_cvt_pk_bf16_f32 v29, v126, v127
    v_cvt_pk_bf16_f32 v30, v124, v125
    v_cvt_pk_bf16_f32 v31, v126, v127
    v_permlane32_swap_b32 v40, v42
    v_mfma_f32_32x32x16_bf16 v[80:95], v[152:155], v[244:247], v[80:95]
    s_waitcnt vmcnt(11)
    buffer_load_dwordx4 a[36:39], v26, s[36:39], s9 offen offset:1024 sc1
    ds_read_b64_tr_b16 v[200:201], v56 offset:2048
    v_permlane32_swap_b32 v41, v43
    v_permlane16_swap_b32 v28, v30
    v_permlane16_swap_b32 v29, v31
    v_mfma_f32_32x32x16_bf16 v[96:111], v[156:159], v[244:247], v[96:111]
    buffer_store_dwordx4 v[40:43], v22, s[36:39], s19 offen
    buffer_store_dwordx4 v[28:31], v23, s[36:39], s19 offen
    v_mfma_f32_32x32x16_bf16 v[80:95], v[160:163], v[248:251], v[80:95]
    s_waitcnt vmcnt(12)
    ds_read_b64_tr_b16 v[202:203], v56 offset:2304
    ds_read_b64_tr_b16 v[204:205], v56 offset:2560
    v_and_b32 v40, 7, v1
    v_lshrrev_b32 v41, 3, v1
    v_lshlrev_b32 v42, 2, v8
    v_xor_b32 v42, v42, v40
    v_mfma_f32_32x32x16_bf16 v[96:111], v[164:167], v[248:251], v[96:111]
    s_xor_b32 s4, s50, s49
    ds_read_b64_tr_b16 v[206:207], v56 offset:2816
    v_lshl_add_u32 v43, v42, 4, s83
    v_lshl_add_u32 v12, v7, 8, v43
    v_lshl_add_u32 v43, v42, 4, s12
    v_lshl_add_u32 v18, v7, 7, v43
    v_lshl_add_u32 v42, s47, 3, v41
    v_mfma_f32_32x32x16_bf16 a[160:175], a[192:195], a[0:3], 0
    s_waitcnt vmcnt(11)
    ds_read_b64_tr_b16 v[208:209], v56 offset:4096
    v_lshlrev_b32 v43, 1, v40
    v_xor_b32 v43, v43, v41
    v_lshlrev_b32 v28, 8, v42
    v_lshl_add_u32 v16, v43, 4, v28
    v_lshrrev_b32 v28, 3, v43
    v_mfma_f32_32x32x16_bf16 a[176:191], a[196:199], a[0:3], 0
    s_and_b32 s4, s4, 1
    ds_read_b64_tr_b16 v[210:211], v56 offset:4352
    v_mul_u32_u24 v28, 14208, v28
    v_lshl_add_u32 v28, v43, 4, v28
    v_lshl_add_u32 v28, v42, 7, v28
    v_add_u32 v22, 98304, v28
    v_xor_b32 v13, 16, v12
    v_mfma_f32_32x32x16_bf16 a[160:175], a[200:203], a[4:7], a[160:175]
    s_waitcnt vmcnt(6)
PP_28:
    v_cmp_ne_u32 vcc, s44, v27
    s_cbranch_vccnz PR_30
PC_29:
    buffer_load_dwordx4 a[40:43], v26, s[36:39], s9 offen offset:2048 sc1
    ds_read_b64_tr_b16 v[212:213], v56 offset:4608
    v_xor_b32 v19, 16, v18
    v_mfma_f32_32x32x16_bf16 a[176:191], a[204:207], a[4:7], a[176:191]
    ds_read_b64_tr_b16 v[216:217], v56 offset:6144
    ds_read_b64_tr_b16 v[214:215], v56 offset:4864
    v_xor_b32 v14, 32, v12
    v_xor_b32 v20, 32, v18
    v_xor_b32 v15, 48, v12
    v_xor_b32 v21, 48, v18
    v_mfma_f32_32x32x16_bf16 a[160:175], a[208:211], a[8:11], a[160:175]
    buffer_load_dwordx4 a[44:47], v2, s[36:39], s10 offen offset:0 sc1
    ds_read_b64_tr_b16 v[218:219], v56 offset:6400
    v_xor_b32 v17, 16, v16
    v_xor_b32 v23, 16, v22
    v_mfma_f32_32x32x16_bf16 a[176:191], a[212:215], a[8:11], a[176:191]
    s_lshl_b32 s4, s4, 8
    ds_read_b64_tr_b16 v[220:221], v56 offset:6656
    v_mfma_f32_32x32x16_bf16 a[160:175], a[216:219], a[12:15], a[160:175]
    buffer_load_dwordx4 a[48:51], v2, s[36:39], s10 offen offset:1024 sc1
    ds_read_b64_tr_b16 v[224:225], v56 offset:8192
    v_mfma_f32_32x32x16_bf16 a[176:191], a[220:223], a[12:15], a[176:191]
    s_add_u32 s4, s4, 163328
    ds_read_b64_tr_b16 v[226:227], v56 offset:8448
    ds_read_b64_tr_b16 v[222:223], v56 offset:6912
    v_lshl_add_u32 v42, v42, 2, s4
    v_mfma_f32_32x32x16_bf16 a[160:175], a[224:227], a[16:19], a[160:175]
    buffer_load_dwordx4 a[52:55], v2, s[36:39], s10 offen offset:2048 sc1
    ds_read_b64_tr_b16 v[228:229], v56 offset:8704
    v_mfma_f32_32x32x16_bf16 a[176:191], a[228:231], a[16:19], a[176:191]
    s_waitcnt vmcnt(4)
    ds_read_b64_tr_b16 v[232:233], v56 offset:10240
    ds_read_b64_tr_b16 v[230:231], v56 offset:8960
    buffer_store_dword v3, v24, s[36:39], s21 offen offset:2432
    v_mfma_f32_32x32x16_bf16 a[160:175], a[232:235], a[20:23], a[160:175]
    ds_read_b64_tr_b16 v[234:235], v56 offset:10496
    ds_read2_b32 v[42:43], v42 offset1:32
    v_mfma_f32_32x32x16_bf16 a[176:191], a[236:239], a[20:23], a[176:191]
    s_lshl_b32 s5, s51, 1
    buffer_load_dwordx4 a[56:59], v2, s[36:39], s10 offen offset:3072 sc1
    ds_read_b64_tr_b16 v[236:237], v56 offset:10752
    v_mfma_f32_32x32x16_bf16 a[160:175], a[240:243], a[24:27], a[160:175]
    ds_read_b64_tr_b16 v[240:241], v56 offset:12288
    ds_read_b64_tr_b16 v[238:239], v56 offset:11008
    v_mfma_f32_32x32x16_bf16 a[176:191], a[244:247], a[24:27], a[176:191]
    s_xor_b32 s5, s5, s78
    buffer_load_dwordx4 a[60:63], v25, s[36:39], s10 offen offset:0 sc1
    ds_read_b64_tr_b16 v[242:243], v56 offset:12544
    v_mfma_f32_32x32x16_bf16 a[160:175], a[248:251], a[28:31], a[160:175]
    ds_read_b64_tr_b16 v[244:245], v56 offset:12800
    v_mfma_f32_32x32x16_bf16 a[176:191], a[252:255], a[28:31], a[176:191]
    buffer_load_dwordx4 a[64:67], v25, s[36:39], s10 offen offset:1024 sc1
    ds_read_b64_tr_b16 v[248:249], v56 offset:0
    v_mfma_f32_32x32x16_bf16 a[160:175], v[144:147], a[32:35], a[160:175]
    ds_read_b64_tr_b16 v[250:251], v56 offset:256
    ds_read_b64_tr_b16 v[246:247], v56 offset:13056
    v_mfma_f32_32x32x16_bf16 a[176:191], v[148:151], a[32:35], a[176:191]
    s_lshl_b32 s5, s5, 6
    ds_read_b64_tr_b16 v[252:253], v56 offset:512
    v_mfma_f32_32x32x16_bf16 a[160:175], v[152:155], a[36:39], a[160:175]
    s_waitcnt vmcnt(7)
    buffer_load_dwordx4 a[68:71], v25, s[36:39], s10 offen offset:2048 sc1
    ds_read_b64_tr_b16 v[254:255], v56 offset:768
    v_mfma_f32_32x32x16_bf16 a[176:191], v[156:159], a[36:39], a[176:191]
    s_add_u32 s5, s5, 159232
    v_lshl_add_u32 v40, v40, 4, s5
    v_mfma_f32_32x32x16_bf16 a[160:175], v[160:163], a[40:43], a[160:175]
    s_waitcnt vmcnt(7)
    buffer_load_dwordx4 a[72:75], v25, s[36:39], s10 offen offset:3072 sc1
    ds_read_b128 v[28:31], v40
    v_mfma_f32_32x32x16_bf16 a[176:191], v[164:167], a[40:43], a[176:191]
    s_add_u32 s6, s3, 32768
    buffer_load_dword v27, v5, s[36:39], s22 offen offset:2432 sc1
    v_mfma_f32_32x32x16_bf16 v[80:95], v[168:171], a[44:47], v[80:95]
    s_waitcnt vmcnt(8) lgkmcnt(0)
    v_lshlrev_b32 v32, 16, v28
    v_and_b32 v33, 0xffff0000, v28
    v_lshlrev_b32 v34, 16, v29
    v_and_b32 v35, 0xffff0000, v29
    v_lshlrev_b32 v36, 16, v30
    v_and_b32 v37, 0xffff0000, v30
    v_mfma_f32_32x32x16_bf16 v[96:111], v[172:175], a[44:47], v[96:111]
    buffer_load_dwordx4 a[76:79], v26, s[36:39], s10 offen offset:0 sc1
    v_lshlrev_b32 v38, 16, v31
    v_and_b32 v39, 0xffff0000, v31
    v_mul_f32 v44, v32, v43
    v_mul_f32 v32, v32, v42
    v_mul_f32 v45, v33, v43
    v_mfma_f32_32x32x16_bf16 v[80:95], v[176:179], a[48:51], v[80:95]
    s_waitcnt vmcnt(8)
    v_mul_f32 v33, v33, v42
    v_mul_f32 v46, v34, v43
    v_mul_f32 v34, v34, v42
    v_mul_f32 v47, v35, v43
    v_mul_f32 v35, v35, v42
    v_mul_f32 v48, v36, v43
    v_mfma_f32_32x32x16_bf16 v[96:111], v[180:183], a[48:51], v[96:111]
    buffer_load_dwordx4 a[80:83], v26, s[36:39], s10 offen offset:1024 sc1
    v_mul_f32 v36, v36, v42
    v_mul_f32 v49, v37, v43
    v_mul_f32 v37, v37, v42
    v_mul_f32 v50, v38, v43
    v_mul_f32 v38, v38, v42
    v_mfma_f32_32x32x16_bf16 v[80:95], v[184:187], a[52:55], v[80:95]
    s_waitcnt vmcnt(7)
    v_mul_f32 v51, v39, v43
    v_mul_f32 v39, v39, v42
    v_mfma_f32_32x32x16_bf16 v[96:111], v[188:191], a[52:55], v[96:111]
    buffer_load_dwordx4 a[84:87], v26, s[36:39], s10 offen offset:2048 sc1
    v_mfma_f32_32x32x16_bf16 v[80:95], v[192:195], a[56:59], v[80:95]
    s_waitcnt vmcnt(7)
    ds_write_b128 v18, v[64:67]
    v_mfma_f32_32x32x16_bf16 v[96:111], v[196:199], a[56:59], v[96:111]
    v_mfma_f32_32x32x16_bf16 v[80:95], v[200:203], a[60:63], v[80:95]
    s_waitcnt vmcnt(6)
    ds_write_b128 v19, v[68:71]
    v_mfma_f32_32x32x16_bf16 v[96:111], v[204:207], a[60:63], v[96:111]
    v_mfma_f32_32x32x16_bf16 v[80:95], v[208:211], a[64:67], v[80:95]
    s_waitcnt vmcnt(5)
    ds_write_b128 v20, v[72:75]
    v_mfma_f32_32x32x16_bf16 v[96:111], v[212:215], a[64:67], v[96:111]
    v_mfma_f32_32x32x16_bf16 v[80:95], v[216:219], a[68:71], v[80:95]
    s_waitcnt vmcnt(4)
    ds_write_b128 v21, v[76:79]
    v_mfma_f32_32x32x16_bf16 v[96:111], v[220:223], a[68:71], v[96:111]
    s_waitcnt vmcnt(3)
PP_31:
    v_cmp_ne_u32 vcc, s44, v27
    s_cbranch_vccnz PR_33
PC_32:
    buffer_load_dwordx4 a[88:91], v2, s[36:39], s11 offen offset:0 sc1
    v_mfma_f32_32x32x16_bf16 v[80:95], v[224:227], a[72:75], v[80:95]
    s_waitcnt vmcnt(3)
    buffer_load_dwordx4 a[92:95], v2, s[36:39], s11 offen offset:1024 sc1
    v_mfma_f32_32x32x16_bf16 v[96:111], v[228:231], a[72:75], v[96:111]
    v_mfma_f32_32x32x16_bf16 v[80:95], v[232:235], a[76:79], v[80:95]
    s_waitcnt vmcnt(3)
    buffer_load_dwordx4 a[96:99], v2, s[36:39], s11 offen offset:2048 sc1
    v_mfma_f32_32x32x16_bf16 v[96:111], v[236:239], a[76:79], v[96:111]
    v_mfma_f32_32x32x16_bf16 v[80:95], v[240:243], a[80:83], v[80:95]
    s_waitcnt vmcnt(3)
    buffer_load_dwordx4 a[100:103], v2, s[36:39], s11 offen offset:3072 sc1
    v_mfma_f32_32x32x16_bf16 v[96:111], v[244:247], a[80:83], v[96:111]
    v_mfma_f32_32x32x16_bf16 v[80:95], v[248:251], a[84:87], v[80:95]
    v_mfma_f32_32x32x16_bf16 v[96:111], v[252:255], a[84:87], v[96:111]
    s_waitcnt vmcnt(3)
    buffer_load_dwordx4 a[104:107], v25, s[36:39], s11 offen offset:0 sc1
    v_mfma_f32_32x32x16_bf16 a[160:175], v[168:171], a[88:91], a[160:175]
    s_waitcnt vmcnt(3)
    s_nop 6
    ds_write_b128 v12, v[80:83] offset:0
    ds_write_b128 v13, v[84:87] offset:0
    v_mfma_f32_32x32x16_bf16 a[176:191], v[172:175], a[88:91], a[176:191]
    buffer_load_dwordx4 a[108:111], v25, s[36:39], s11 offen offset:1024 sc1
    ds_write_b128 v14, v[88:91] offset:0
    v_mfma_f32_32x32x16_bf16 a[160:175], v[176:179], a[92:95], a[160:175]
    s_waitcnt vmcnt(3)
    ds_write_b128 v15, v[92:95] offset:0
    ds_write_b128 v12, v[96:99] offset:128
    v_mfma_f32_32x32x16_bf16 a[176:191], v[180:183], a[92:95], a[176:191]
    buffer_load_dwordx4 a[112:115], v25, s[36:39], s11 offen offset:2048 sc1
    ds_write_b128 v13, v[100:103] offset:128
    v_mfma_f32_32x32x16_bf16 a[160:175], v[184:187], a[96:99], a[160:175]
    s_waitcnt vmcnt(3)
    ds_write_b128 v14, v[104:107] offset:128
    ds_write_b128 v15, v[108:111] offset:128
    v_mfma_f32_32x32x16_bf16 a[176:191], v[188:191], a[96:99], a[176:191]
    s_waitcnt lgkmcnt(0)
    s_barrier
    buffer_load_dwordx4 a[116:119], v25, s[36:39], s11 offen offset:3072 sc1
    ds_read_b128 v[112:115], v16 offset:0
    v_mfma_f32_32x32x16_bf16 a[160:175], v[192:195], a[100:103], a[160:175]
    ds_read_b128 v[116:119], v17 offset:0
    ds_read_b128 v[120:123], v16 offset:8192
    v_mfma_f32_32x32x16_bf16 a[176:191], v[196:199], a[100:103], a[176:191]
    s_waitcnt vmcnt(3)
    ds_read_b128 v[124:127], v17 offset:8192
    ds_read_b128 v[128:131], v16 offset:16384
    buffer_load_dwordx4 a[120:123], v26, s[36:39], s11 offen offset:0 sc1
    v_mfma_f32_32x32x16_bf16 a[160:175], v[200:203], a[104:107], a[160:175]
    ds_read_b128 v[132:135], v17 offset:16384
    ds_read_b128 v[136:139], v16 offset:24576
    v_mfma_f32_32x32x16_bf16 a[176:191], v[204:207], a[104:107], a[176:191]
    s_waitcnt vmcnt(3)
    ds_read_b128 v[140:143], v17 offset:24576
    ds_read_b128 v[64:67], v22 offset:0
    buffer_load_dwordx4 a[124:127], v26, s[36:39], s11 offen offset:1024 sc1
    v_mfma_f32_32x32x16_bf16 a[160:175], v[208:211], a[108:111], a[160:175]
    s_waitcnt lgkmcnt(5)
    ds_read_b128 v[68:71], v23 offset:0
    ds_read_b128 v[72:75], v22 offset:28672
    v_add_f32 v112, v112, v120
    v_add_f32 v113, v113, v121
    v_add_f32 v114, v114, v122
    v_add_f32 v115, v115, v123
    v_mfma_f32_32x32x16_bf16 a[176:191], v[212:215], a[108:111], a[176:191]
    s_waitcnt vmcnt(3)
    ds_read_b128 v[76:79], v23 offset:28672
    buffer_load_dwordx4 a[128:131], v26, s[36:39], s11 offen offset:2048 sc1
    v_add_f32 v116, v116, v124
    v_add_f32 v117, v117, v125
    v_add_f32 v118, v118, v126
    v_add_f32 v119, v119, v127
    v_mfma_f32_32x32x16_bf16 a[160:175], v[216:219], a[112:115], a[160:175]
    s_waitcnt lgkmcnt(4)
    v_add_f32 v128, v128, v136
    v_add_f32 v129, v129, v137
    v_add_f32 v130, v130, v138
    v_add_f32 v131, v131, v139
    v_add_f32 v132, v132, v140
    v_add_f32 v133, v133, v141
    v_mfma_f32_32x32x16_bf16 a[176:191], v[220:223], a[112:115], a[176:191]
    s_waitcnt vmcnt(3)
    v_add_f32 v134, v134, v142
    v_add_f32 v135, v135, v143
    v_add_f32 v112, v112, v128
    v_add_f32 v113, v113, v129
    v_add_f32 v114, v114, v130
    v_add_f32 v115, v115, v131
    v_mfma_f32_32x32x16_bf16 a[160:175], v[224:227], a[116:119], a[160:175]
    s_waitcnt lgkmcnt(0)
    v_add_f32 v116, v116, v132
    v_add_f32 v117, v117, v133
    v_add_f32 v118, v118, v134
    v_add_f32 v119, v119, v135
    v_fma_f32 v112, v112, v32, v64
    v_fma_f32 v113, v113, v33, v65
    v_mfma_f32_32x32x16_bf16 a[176:191], v[228:231], a[116:119], a[176:191]
    s_waitcnt vmcnt(2)
    v_fma_f32 v114, v114, v34, v66
    v_fma_f32 v115, v115, v35, v67
    v_fma_f32 v116, v116, v36, v68
    v_fma_f32 v117, v117, v37, v69
    v_fma_f32 v118, v118, v38, v70
    v_fma_f32 v119, v119, v39, v71
    v_mfma_f32_32x32x16_bf16 a[160:175], v[232:235], a[120:123], a[160:175]
    v_cvt_pk_bf16_f32 v40, v112, v113
    v_cvt_pk_bf16_f32 v41, v114, v115
    v_cvt_pk_bf16_f32 v42, v116, v117
    v_cvt_pk_bf16_f32 v43, v118, v119
    v_mfma_f32_32x32x16_bf16 a[176:191], v[236:239], a[120:123], a[176:191]
    s_waitcnt vmcnt(1)
    buffer_store_dwordx4 v[40:43], v63, s[32:35], s3 offen
    v_mfma_f32_32x32x16_bf16 a[160:175], v[240:243], a[124:127], a[160:175]
    v_mfma_f32_32x32x16_bf16 a[176:191], v[244:247], a[124:127], a[176:191]
    s_waitcnt vmcnt(1)
    v_mfma_f32_32x32x16_bf16 a[160:175], v[248:251], a[128:131], a[160:175]
    v_mfma_f32_32x32x16_bf16 a[176:191], v[252:255], a[128:131], a[176:191]
    s_nop 10
    ds_write_b128 v12, a[160:163] offset:32768
    ds_write_b128 v13, a[164:167] offset:32768
    ds_write_b128 v14, a[168:171] offset:32768
    ds_write_b128 v15, a[172:175] offset:32768
    ds_write_b128 v12, a[176:179] offset:32896
    ds_write_b128 v13, a[180:183] offset:32896
    ds_write_b128 v14, a[184:187] offset:32896
    ds_write_b128 v15, a[188:191] offset:32896
    s_waitcnt lgkmcnt(0)
    s_barrier
    ds_read_b128 v[112:115], v16 offset:32768
    ds_read_b128 v[116:119], v17 offset:32768
    ds_read_b128 v[120:123], v16 offset:40960
    ds_read_b128 v[124:127], v17 offset:40960
    ds_read_b128 v[128:131], v16 offset:49152
    ds_read_b128 v[132:135], v17 offset:49152
    ds_read_b128 v[136:139], v16 offset:57344
    ds_read_b128 v[140:143], v17 offset:57344
    s_waitcnt lgkmcnt(4)
    v_pk_add_f32 v[112:113], v[112:113], v[120:121]
    v_pk_add_f32 v[114:115], v[114:115], v[122:123]
    v_pk_add_f32 v[116:117], v[116:117], v[124:125]
    v_pk_add_f32 v[118:119], v[118:119], v[126:127]
    s_waitcnt lgkmcnt(0)
    v_pk_add_f32 v[128:129], v[128:129], v[136:137]
    v_pk_add_f32 v[130:131], v[130:131], v[138:139]
    v_pk_add_f32 v[132:133], v[132:133], v[140:141]
    v_pk_add_f32 v[134:135], v[134:135], v[142:143]
    v_pk_add_f32 v[112:113], v[112:113], v[128:129]
    v_pk_add_f32 v[114:115], v[114:115], v[130:131]
    v_pk_add_f32 v[116:117], v[116:117], v[132:133]
    v_pk_add_f32 v[118:119], v[118:119], v[134:135]
    v_pk_fma_f32 v[112:113], v[112:113], v[44:45], v[72:73]
    v_pk_fma_f32 v[114:115], v[114:115], v[46:47], v[74:75]
    v_pk_fma_f32 v[116:117], v[116:117], v[48:49], v[76:77]
    v_pk_fma_f32 v[118:119], v[118:119], v[50:51], v[78:79]
    v_cvt_pk_bf16_f32 v40, v112, v113
    v_cvt_pk_bf16_f32 v41, v114, v115
    v_cvt_pk_bf16_f32 v42, v116, v117
    v_cvt_pk_bf16_f32 v43, v118, v119
    buffer_store_dwordx4 v[40:43], v63, s[32:35], s6 offen
    s_endpgm
PR_3:
    s_sub_u32 s64, s64, 1
    s_cbranch_scc1 PC_2
    s_nop 7
    buffer_load_dwordx2 v[80:81], v26, s[36:39], 0 offen sc1
    buffer_load_dwordx4 v[64:67], v25, s[36:39], s56 offen sc1
    buffer_load_dwordx4 v[68:71], v25, s[36:39], s57 offen sc1
    buffer_load_dwordx4 v[72:75], v25, s[36:39], s58 offen sc1
    buffer_load_dwordx4 v[76:79], v25, s[36:39], s59 offen sc1
    s_waitcnt vmcnt(0)
    s_branch PP_1
PR_6:
    s_sub_u32 s64, s64, 1
    s_cbranch_scc1 PC_5
    s_nop 7
    buffer_load_dwordx4 v[64:67], v25, s[36:39], s56 offen sc1
    buffer_load_dwordx4 v[68:71], v25, s[36:39], s57 offen sc1
    buffer_load_dwordx4 v[72:75], v25, s[36:39], s58 offen sc1
    buffer_load_dwordx4 v[76:79], v25, s[36:39], s59 offen sc1
    buffer_load_dwordx4 v[80:83], v52, s[36:39], s60 offen sc1
    s_waitcnt vmcnt(0)
    s_branch PP_4
PR_9:
    s_sub_u32 s64, s64, 1
    s_cbranch_scc1 PC_8
    s_nop 7
    buffer_load_dword v13, v14, s[36:39], s56 offen offset:0 sc1
    s_waitcnt vmcnt(0)
    s_branch PP_7
PR_12:
    s_sub_u32 s64, s64, 1
    s_cbranch_scc1 PC_11
    s_nop 7
    buffer_load_dword v14, v31, s[36:39], 0 offen offset:0 sc1
    s_waitcnt vmcnt(0)
    s_branch PP_10
PR_15:
    s_sub_u32 s64, s64, 1
    s_cbranch_scc1 PC_14
    s_nop 7
    s_mov_b32 exec_lo, 0xffff
    s_mov_b32 exec_hi, 0xffff
    buffer_load_dwordx4 v[160:163], v14, s[36:39], s58 offen sc1
    s_mov_b64 exec, -1
    buffer_load_dwordx4 v[128:131], v2, s[36:39], s56 offen offset:0 sc1
    buffer_load_dwordx4 v[132:135], v2, s[36:39], s56 offen offset:1024 sc1
    buffer_load_dwordx4 v[136:139], v2, s[36:39], s56 offen offset:2048 sc1
    buffer_load_dwordx4 v[140:143], v2, s[36:39], s56 offen offset:3072 sc1
    buffer_load_dwordx4 v[144:147], v2, s[36:39], s57 offen offset:0 sc1
    buffer_load_dwordx4 v[148:151], v2, s[36:39], s57 offen offset:1024 sc1
    buffer_load_dwordx4 v[152:155], v2, s[36:39], s57 offen offset:2048 sc1
    buffer_load_dwordx4 v[156:159], v2, s[36:39], s57 offen offset:3072 sc1
    s_waitcnt vmcnt(0)
    s_branch PP_13
PR_18:
    s_sub_u32 s64, s64, 1
    s_cbranch_scc1 PC_17
    s_nop 7
    buffer_load_dword v17, v5, s[36:39], s56 offen offset:1024 sc1
    s_waitcnt vmcnt(0)
    s_branch PP_16
PR_21:
    s_sub_u32 s64, s64, 1
    s_cbranch_scc1 PC_20
    s_nop 7
    buffer_load_dword v17, v4, s[36:39], s56 offen offset:1536 sc1
    s_waitcnt vmcnt(0)
    s_branch PP_19
PR_24:
    s_cmp_eq_u32 s64, 0
    s_cbranch_scc1 PC_23
    s_sub_u32 s64, s64, 1
    s_nop 7
    buffer_load_dword v27, v5, s[36:39], s22 offen offset:2048 sc1
    s_waitcnt vmcnt(0)
    s_branch PP_22
PR_27:
    s_cmp_eq_u32 s64, 0
    s_cbranch_scc1 PC_26
    s_sub_u32 s64, s64, 1
    s_nop 7
    buffer_load_dword v27, v58, s[36:39], s13 offen offset:2176 sc1
    s_waitcnt vmcnt(0)
    s_branch PP_25
PR_30:
    s_cmp_eq_u32 s64, 0
    s_cbranch_scc1 PC_29
    s_sub_u32 s64, s64, 1
    s_nop 7
    buffer_load_dword v27, v5, s[36:39], s22 offen offset:2304 sc1
    s_waitcnt vmcnt(0)
    s_branch PP_28
PR_33:
    s_cmp_eq_u32 s64, 0
    s_cbranch_scc1 PC_32
    s_sub_u32 s64, s64, 1
    s_nop 7
    buffer_load_dword v27, v5, s[36:39], s22 offen offset:2432 sc1
    s_waitcnt vmcnt(0)
    s_branch PP_31
SLOW:

    buffer_store_dwordx4 v[32:35], v27, s[36:39], s60 offen sc1
    s_waitcnt lgkmcnt(2)
    v_pk_fma_f32 v[176:177], v[176:177], v[120:121], v[112:113]
    v_pk_fma_f32 v[178:179], v[178:179], v[122:123], v[114:115]
    s_waitcnt lgkmcnt(0)
    v_pk_fma_f32 v[180:181], v[180:181], v[124:125], v[116:117]
    v_pk_fma_f32 v[182:183], v[182:183], v[126:127], v[118:119]
    v_cvt_pk_bf16_f32 v36, v176, v177
    v_cvt_pk_bf16_f32 v37, v178, v179
    v_cvt_pk_bf16_f32 v38, v180, v181
    v_cvt_pk_bf16_f32 v39, v182, v183
    buffer_store_dwordx4 v[36:39], v27, s[36:39], s61 offen sc1
    s_add_u32 s56, s56, 6144
    s_add_u32 s57, s57, 6144
    s_add_u32 s58, s58, 6144
    s_add_u32 s59, s59, 6144
    s_and_b32 s62, s47, 1
    s_mul_i32 s60, s62, 6144
    s_lshl_b32 s63, s51, 8
    s_add_u32 s60, s60, s63
    s_add_u32 s60, s60, 135168
    v_mul_u32_u24 v13, 12288, v9
    v_lshl_add_u32 v52, v10, 4, v13
    s_mov_b32 s64, 30000
    buffer_load_dwordx4 v[64:67], v25, s[36:39], s56 offen
    buffer_load_dwordx4 v[68:71], v25, s[36:39], s57 offen
    buffer_load_dwordx4 v[72:75], v25, s[36:39], s58 offen
    buffer_load_dwordx4 v[76:79], v25, s[36:39], s59 offen
    buffer_load_dwordx4 v[80:83], v52, s[36:39], s60 offen
    s_cmp_eq_u32 s48, 0
    s_cselect_b32 s78, 0, 0
    s_lshl_b32 s61, s47, 2
    s_xor_b32 s61, s61, s78
    s_lshl_b32 s61, s61, 6
    s_add_u32 s61, s61, 157184
    v_lshl_add_u32 v53, v8, 10, s61
    v_lshl_add_u32 v53, v7, 3, v53
    s_lshl_b32 s61, s51, 1
    s_xor_b32 s61, s61, s78
    s_lshl_b32 s61, s61, 6
    s_mul_i32 s63, s62, 3072
    s_add_u32 s61, s61, s63
    s_add_u32 s61, s61, 156160
    v_lshl_add_u32 v54, v10, 3, s61
    v_lshl_add_u32 v54, v9, 1, v54
    s_waitcnt vmcnt(5)
    s_mov_b64 exec, 1
    buffer_store_dword v3, off, s[36:39], s82 offset:0 sc1
    s_mov_b64 exec, -1
    s_mov_b64 exec, 1
    buffer_store_dword v3, off, s[36:39], s83 sc1
    s_mov_b64 exec, -1
    s_lshr_b32 s61, s47, 1
    s_lshl_b32 s61, s61, 12
    s_lshl_b32 s63, s62, 6
    s_add_u32 s61, s61, s63
    s_add_u32 s61, s61, 57344
    v_lshl_add_u32 v12, v7, 7, s61
    v_lshl_add_u32 v12, v8, 5, v12
    ds_read_b128 a[192:195], v12
    ds_read_b128 a[196:199], v12 offset:16
    s_add_u32 m0, s80, 0
    s_add_u32 s81, s79, 0
    buffer_load_dwordx4 v31, s[8:11], s81 offen offset:0 lds
    s_add_u32 s81, s79, 48128
    buffer_load_dwordx4 v31, s[8:11], s81 offen offset:1024 lds
    s_add_u32 s81, s79, 96256
    buffer_load_dwordx4 v31, s[8:11], s81 offen offset:2048 lds
    s_add_u32 s81, s79, 144384
    buffer_load_dwordx4 v31, s[8:11], s81 offen offset:3072 lds
    s_add_u32 m0, s80, 4096
    s_add_u32 s81, s79, 196608
    buffer_load_dwordx4 v31, s[8:11], s81 offen offset:0 lds
    s_waitcnt vmcnt(7)
PP_37:
    v_xor_b32 v64, s0, v64
    v_xor_b32 v65, s1, v65
    v_xor_b32 v66, s40, v66
    v_xor_b32 v67, s41, v67
    v_xor_b32 v68, s0, v68
    v_xor_b32 v69, s1, v69
    v_xor_b32 v70, s40, v70
    v_xor_b32 v71, s41, v71
    v_xor_b32 v72, s0, v72
    v_xor_b32 v73, s1, v73
    v_xor_b32 v74, s40, v74
    v_xor_b32 v75, s41, v75
    v_xor_b32 v76, s0, v76
    v_xor_b32 v77, s1, v77
    v_xor_b32 v78, s40, v78
    v_xor_b32 v79, s41, v79
    v_pk_add_f32 v[44:45], v[64:65], v[68:69]
    v_pk_add_f32 v[46:47], v[66:67], v[70:71]
    v_pk_add_f32 v[48:49], v[72:73], v[76:77]
    v_pk_add_f32 v[50:51], v[74:75], v[78:79]
    v_pk_add_f32 v[44:45], v[44:45], v[48:49]
    v_pk_add_f32 v[46:47], v[46:47], v[50:51]
    v_cvt_pk_bf16_f32 v48, v44, v45
    v_cvt_pk_bf16_f32 v49, v46, v47
    v_lshlrev_b32 v44, 16, v48
    v_and_b32 v45, 0xffff0000, v48
    v_lshlrev_b32 v46, 16, v49
    v_and_b32 v47, 0xffff0000, v49
    v_pk_add_f32 v[44:45], v[44:45], v[42:43]
    v_pk_add_f32 v[46:47], v[46:47], v[42:43]
    v_cvt_pk_bf16_f32 v48, v44, v45
    v_cvt_pk_bf16_f32 v49, v46, v47
    ds_write_b64 v53, v[48:49]
    v_xor_b32 v80, s0, v80
    v_xor_b32 v81, s1, v81
    v_xor_b32 v82, s40, v82
    v_xor_b32 v83, s41, v83
    v_or3_b32 v12, v64, v65, v66
    v_or3_b32 v12, v12, v67, v68
    v_or3_b32 v12, v12, v69, v70
    v_or3_b32 v12, v12, v71, v72
    v_or3_b32 v12, v12, v73, v74
    v_or3_b32 v12, v12, v75, v76
    v_or3_b32 v12, v12, v77, v78
    v_or3_b32 v12, v12, v79, v80
    v_or3_b32 v12, v12, v81, v82
    v_or_b32 v12, v12, v83
    v_and_b32 v12, 0xff, v12
    v_permlane32_swap_b32 v80, v82
    v_permlane32_swap_b32 v81, v83
    v_add_f32 v80, v80, v82
    v_add_f32 v81, v81, v83
    s_nop 1
    v_permlane16_swap_b32 v80, v81
    v_add_f32 v80, v80, v81
    v_cvt_pk_bf16_f32 v80, v80, v80
    ds_write_b16 v54, v80
    v_cmp_ne_u32 vcc, 0, v12
    s_cbranch_vccnz PR_39
PC_38:
    s_lshl_b32 s59, s48, 2
    s_add_u32 s59, s59, s47
    s_lshl_b32 s56, s59, 7
    s_add_u32 s56, s56, s66
    v_lshlrev_b32 v14, 2, v10
    s_mov_b32 s64, 30000
    buffer_load_dword v13, v14, s[36:39], s56 offen offset:0 sc1
    s_lshl_b32 s57, s45, 3
    s_add_u32 s57, s57, s59
    s_lshl_b32 s58, s57, 15
    s_add_u32 s58, s58, 2097152
    s_lshl_b32 s60, s57, 15
    s_lshl_b32 s63, s49, 11
    s_add_u32 s60, s60, s63
    s_add_u32 s60, s60, 7340032
    s_lshl_b32 s59, s59, 6
    s_lshl_b32 s63, s49, 2
    s_add_u32 s59, s59, s63
    s_add_u32 s59, s59, s66
    s_waitcnt vmcnt(0)
PP_40:
    v_cmp_ne_u32 vcc, s44, v13
    s_cbranch_vccnz PR_42
PC_41:
    buffer_load_dwordx4 v[128:131], v2, s[36:39], s58 offen offset:0 sc1
    buffer_load_dwordx4 v[132:135], v2, s[36:39], s58 offen offset:1024 sc1
    buffer_load_dwordx4 v[136:139], v2, s[36:39], s58 offen offset:2048 sc1
    buffer_load_dwordx4 v[140:143], v2, s[36:39], s58 offen offset:3072 sc1
    s_add_u32 s58, s58, 4096
    buffer_load_dwordx4 v[144:147], v2, s[36:39], s58 offen offset:0 sc1
    buffer_load_dwordx4 v[148:151], v2, s[36:39], s58 offen offset:1024 sc1
    buffer_load_dwordx4 v[152:155], v2, s[36:39], s58 offen offset:2048 sc1
    buffer_load_dwordx4 v[156:159], v2, s[36:39], s58 offen offset:3072 sc1
    s_add_u32 s58, s58, 4096
    buffer_load_dwordx4 v[160:163], v2, s[36:39], s58 offen offset:0 sc1
    buffer_load_dwordx4 v[164:167], v2, s[36:39], s58 offen offset:1024 sc1
    s_waitcnt lgkmcnt(0)
    s_barrier
    v_bfe_u32 v12, v1, 2, 2
    v_lshl_add_u32 v12, v8, 2, v12
    v_lshlrev_b32 v12, 5, v12
    v_bfe_u32 v13, v1, 1, 1
    v_and_b32 v14, 1, v9
    v_lshl_add_u32 v13, v14, 1, v13
    v_lshl_add_u32 v12, v13, 3, v12
    v_add_u32 v12, 160256, v12
    ds_read_b64_tr_b16 v[20:21], v12 offset:0
    ds_read_b64_tr_b16 v[22:23], v12 offset:256
    ds_read_b64_tr_b16 v[24:25], v12 offset:512
    ds_read_b64_tr_b16 v[26:27], v12 offset:768
    v_bfe_i32 v13, v1, 2, 1
    v_and_b32 v13, 0x80008000, v13
    v_add_u32 v14, 65536, v5
    v_add_u32 v18, 98304, v6
    s_waitcnt lgkmcnt(0)
    v_xor_b32 v20, v13, v20
    v_xor_b32 v21, v13, v21
    v_xor_b32 v22, v13, v22
    v_xor_b32 v23, v13, v23
    v_xor_b32 v24, v13, v24
    v_xor_b32 v25, v13, v25
    v_xor_b32 v26, v13, v26
    v_xor_b32 v27, v13, v27
    s_lshl_b32 s56, s47, 10
    s_add_u32 s56, s56, 32768
    v_lshl_add_u32 v15, v7, 5, s56
    v_lshl_add_u32 v15, v8, 12, v15
    ds_read_b64_tr_b16 v[32:33], v14 offset:0
    ds_read_b64_tr_b16 v[34:35], v14 offset:256
    ds_read_b64_tr_b16 v[36:37], v18 offset:0
    ds_read_b64_tr_b16 v[38:39], v18 offset:256
    ds_read_b64_tr_b16 v[40:41], v14 offset:1024
    ds_read_b64_tr_b16 v[42:43], v14 offset:1280
    ds_read_b64_tr_b16 v[44:45], v18 offset:1024
    ds_read_b64_tr_b16 v[46:47], v18 offset:1280
    ds_read_b64_tr_b16 v[48:49], v14 offset:2048
    ds_read_b64_tr_b16 v[50:51], v14 offset:2304
    s_waitcnt vmcnt(9) lgkmcnt(8)
    v_mfma_f32_32x32x16_bf16 v[64:79], v[32:35], v[128:131], 0
    buffer_load_dwordx4 v[168:171], v2, s[36:39], s58 offen offset:2048 sc1
    ds_read_b64_tr_b16 v[52:53], v18 offset:2048
    ds_read_b64_tr_b16 v[54:55], v18 offset:2304
    s_waitcnt lgkmcnt(8)
    v_mfma_f32_32x32x16_bf16 v[80:95], v[36:39], v[128:131], 0
    ds_read_b64_tr_b16 v[32:33], v14 offset:3072
    ds_read_b64_tr_b16 v[34:35], v14 offset:3328
    s_waitcnt vmcnt(9) lgkmcnt(8)
    v_mfma_f32_32x32x16_bf16 v[64:79], v[40:43], v[132:135], v[64:79]
    buffer_load_dwordx4 v[172:175], v2, s[36:39], s58 offen offset:3072 sc1
    s_add_u32 s58, s58, 4096
    ds_read_b64_tr_b16 v[36:37], v18 offset:3072
    ds_read_b64_tr_b16 v[38:39], v18 offset:3328
    s_waitcnt lgkmcnt(8)
    v_mfma_f32_32x32x16_bf16 v[80:95], v[44:47], v[132:135], v[80:95]
    ds_read_b64_tr_b16 v[40:41], v14 offset:4096
    ds_read_b64_tr_b16 v[42:43], v14 offset:4352
    s_waitcnt vmcnt(9) lgkmcnt(8)
    v_mfma_f32_32x32x16_bf16 v[64:79], v[48:51], v[136:139], v[64:79]
    buffer_load_dwordx4 v[176:179], v2, s[36:39], s58 offen offset:0 sc1
    ds_read_b64_tr_b16 v[44:45], v18 offset:4096
    ds_read_b64_tr_b16 v[46:47], v18 offset:4352
    s_waitcnt lgkmcnt(8)
    v_mfma_f32_32x32x16_bf16 v[80:95], v[52:55], v[136:139], v[80:95]
    ds_read_b64_tr_b16 v[48:49], v14 offset:5120
    ds_read_b64_tr_b16 v[50:51], v14 offset:5376
    s_waitcnt vmcnt(9) lgkmcnt(8)
    v_mfma_f32_32x32x16_bf16 v[64:79], v[32:35], v[140:143], v[64:79]
    buffer_load_dwordx4 v[180:183], v2, s[36:39], s58 offen offset:1024 sc1
    ds_read_b64_tr_b16 v[52:53], v18 offset:5120
    ds_read_b64_tr_b16 v[54:55], v18 offset:5376
    s_waitcnt lgkmcnt(8)
    v_mfma_f32_32x32x16_bf16 v[80:95], v[36:39], v[140:143], v[80:95]
    ds_read_b64_tr_b16 v[32:33], v14 offset:6144
    ds_read_b64_tr_b16 v[34:35], v14 offset:6400
    s_waitcnt vmcnt(9) lgkmcnt(8)
    v_mfma_f32_32x32x16_bf16 v[64:79], v[40:43], v[144:147], v[64:79]
    buffer_load_dwordx4 v[184:187], v2, s[36:39], s58 offen offset:2048 sc1
    ds_read_b64_tr_b16 v[36:37], v18 offset:6144
    ds_read_b64_tr_b16 v[38:39], v18 offset:6400
    s_waitcnt lgkmcnt(8)
    v_mfma_f32_32x32x16_bf16 v[80:95], v[44:47], v[144:147], v[80:95]
    ds_read_b64_tr_b16 v[40:41], v14 offset:7168
    ds_read_b64_tr_b16 v[42:43], v14 offset:7424
    s_waitcnt vmcnt(9) lgkmcnt(8)
    v_mfma_f32_32x32x16_bf16 v[64:79], v[48:51], v[148:151], v[64:79]
    buffer_load_dwordx4 v[188:191], v2, s[36:39], s58 offen offset:3072 sc1
    s_add_u32 s58, s58, 4096
    ds_read_b64_tr_b16 v[44:45], v18 offset:7168
    ds_read_b64_tr_b16 v[46:47], v18 offset:7424
    s_waitcnt lgkmcnt(8)
    v_mfma_f32_32x32x16_bf16 v[80:95], v[52:55], v[148:151], v[80:95]
    ds_read_b64_tr_b16 v[48:49], v14 offset:8192
    ds_read_b64_tr_b16 v[50:51], v14 offset:8448
    s_waitcnt vmcnt(9) lgkmcnt(8)
    v_mfma_f32_32x32x16_bf16 v[64:79], v[32:35], v[152:155], v[64:79]
    buffer_load_dwordx4 v[192:195], v2, s[36:39], s58 offen offset:0 sc1
    ds_read_b64_tr_b16 v[52:53], v18 offset:8192
    ds_read_b64_tr_b16 v[54:55], v18 offset:8448
    s_waitcnt lgkmcnt(8)
    v_mfma_f32_32x32x16_bf16 v[80:95], v[36:39], v[152:155], v[80:95]
    ds_read_b64_tr_b16 v[32:33], v14 offset:9216
    ds_read_b64_tr_b16 v[34:35], v14 offset:9472
    s_waitcnt vmcnt(9) lgkmcnt(8)
    v_mfma_f32_32x32x16_bf16 v[64:79], v[40:43], v[156:159], v[64:79]
    buffer_load_dwordx4 v[196:199], v2, s[36:39], s58 offen offset:1024 sc1
    ds_read_b64_tr_b16 v[36:37], v18 offset:9216
    ds_read_b64_tr_b16 v[38:39], v18 offset:9472
    s_waitcnt lgkmcnt(8)
    v_mfma_f32_32x32x16_bf16 v[80:95], v[44:47], v[156:159], v[80:95]
    ds_read_b64_tr_b16 v[40:41], v14 offset:10240
    ds_read_b64_tr_b16 v[42:43], v14 offset:10496
    s_waitcnt vmcnt(9) lgkmcnt(8)
    v_mfma_f32_32x32x16_bf16 v[64:79], v[48:51], v[160:163], v[64:79]
    buffer_load_dwordx4 v[200:203], v2, s[36:39], s58 offen offset:2048 sc1
    ds_read_b64_tr_b16 v[44:45], v18 offset:10240
    ds_read_b64_tr_b16 v[46:47], v18 offset:10496
    s_waitcnt lgkmcnt(8)
    v_mfma_f32_32x32x16_bf16 v[80:95], v[52:55], v[160:163], v[80:95]
    ds_read_b64_tr_b16 v[48:49], v14 offset:11264
    ds_read_b64_tr_b16 v[50:51], v14 offset:11520
    s_waitcnt vmcnt(9) lgkmcnt(8)
    v_mfma_f32_32x32x16_bf16 v[64:79], v[32:35], v[164:167], v[64:79]
    buffer_load_dwordx4 v[204:207], v2, s[36:39], s58 offen offset:3072 sc1
    s_add_u32 s58, s58, 4096
    ds_read_b64_tr_b16 v[52:53], v18 offset:11264
    ds_read_b64_tr_b16 v[54:55], v18 offset:11520
    s_waitcnt lgkmcnt(8)
    v_mfma_f32_32x32x16_bf16 v[80:95], v[36:39], v[164:167], v[80:95]
    ds_read_b64_tr_b16 v[32:33], v14 offset:12288
    ds_read_b64_tr_b16 v[34:35], v14 offset:12544
    s_waitcnt vmcnt(9) lgkmcnt(8)
    v_mfma_f32_32x32x16_bf16 v[64:79], v[40:43], v[168:171], v[64:79]
    buffer_load_dwordx4 v[208:211], v2, s[36:39], s58 offen offset:0 sc1
    ds_read_b64_tr_b16 v[36:37], v18 offset:12288
    ds_read_b64_tr_b16 v[38:39], v18 offset:12544
    s_waitcnt lgkmcnt(8)
    v_mfma_f32_32x32x16_bf16 v[80:95], v[44:47], v[168:171], v[80:95]
    ds_read_b64_tr_b16 v[40:41], v14 offset:13312
    ds_read_b64_tr_b16 v[42:43], v14 offset:13568
    s_waitcnt vmcnt(9) lgkmcnt(8)
    v_mfma_f32_32x32x16_bf16 v[64:79], v[48:51], v[172:175], v[64:79]
    buffer_load_dwordx4 v[212:215], v2, s[36:39], s58 offen offset:1024 sc1
    ds_read_b64_tr_b16 v[44:45], v18 offset:13312
    ds_read_b64_tr_b16 v[46:47], v18 offset:13568
    s_waitcnt lgkmcnt(8)
    v_mfma_f32_32x32x16_bf16 v[80:95], v[52:55], v[172:175], v[80:95]
    ds_read_b64_tr_b16 v[48:49], v14 offset:14336
    ds_read_b64_tr_b16 v[50:51], v14 offset:14592
    s_waitcnt vmcnt(9) lgkmcnt(8)
    v_mfma_f32_32x32x16_bf16 v[64:79], v[32:35], v[176:179], v[64:79]
    buffer_load_dwordx4 v[216:219], v2, s[36:39], s58 offen offset:2048 sc1
    ds_read_b64_tr_b16 v[52:53], v18 offset:14336
    ds_read_b64_tr_b16 v[54:55], v18 offset:14592
    s_waitcnt lgkmcnt(8)
    v_mfma_f32_32x32x16_bf16 v[80:95], v[36:39], v[176:179], v[80:95]
    ds_read_b64_tr_b16 v[32:33], v14 offset:15360
    ds_read_b64_tr_b16 v[34:35], v14 offset:15616
    s_waitcnt vmcnt(9) lgkmcnt(8)
    v_mfma_f32_32x32x16_bf16 v[64:79], v[40:43], v[180:183], v[64:79]
    buffer_load_dwordx4 v[220:223], v2, s[36:39], s58 offen offset:3072 sc1
    s_add_u32 s58, s58, 4096
    ds_read_b64_tr_b16 v[36:37], v18 offset:15360
    ds_read_b64_tr_b16 v[38:39], v18 offset:15616
    s_waitcnt lgkmcnt(8)
    v_mfma_f32_32x32x16_bf16 v[80:95], v[44:47], v[180:183], v[80:95]
    ds_read_b64_tr_b16 v[40:41], v14 offset:16384
    ds_read_b64_tr_b16 v[42:43], v14 offset:16640
    s_waitcnt vmcnt(9) lgkmcnt(8)
    v_mfma_f32_32x32x16_bf16 v[64:79], v[48:51], v[184:187], v[64:79]
    buffer_load_dwordx4 v[224:227], v2, s[36:39], s58 offen offset:0 sc1
    ds_read_b64_tr_b16 v[44:45], v18 offset:16384
    ds_read_b64_tr_b16 v[46:47], v18 offset:16640
    s_waitcnt lgkmcnt(8)
    v_mfma_f32_32x32x16_bf16 v[80:95], v[52:55], v[184:187], v[80:95]
    ds_read_b64_tr_b16 v[48:49], v14 offset:17408
    ds_read_b64_tr_b16 v[50:51], v14 offset:17664
    s_waitcnt vmcnt(9) lgkmcnt(8)
    v_mfma_f32_32x32x16_bf16 v[64:79], v[32:35], v[188:191], v[64:79]
    buffer_load_dwordx4 v[228:231], v2, s[36:39], s58 offen offset:1024 sc1
    ds_read_b64_tr_b16 v[52:53], v18 offset:17408
    ds_read_b64_tr_b16 v[54:55], v18 offset:17664
    s_waitcnt lgkmcnt(8)
    v_mfma_f32_32x32x16_bf16 v[80:95], v[36:39], v[188:191], v[80:95]
    ds_read_b64_tr_b16 v[32:33], v14 offset:18432
    ds_read_b64_tr_b16 v[34:35], v14 offset:18688
    s_waitcnt vmcnt(9) lgkmcnt(8)
    v_mfma_f32_32x32x16_bf16 v[64:79], v[40:43], v[192:195], v[64:79]
    buffer_load_dwordx4 v[232:235], v2, s[36:39], s58 offen offset:2048 sc1
    ds_read_b64_tr_b16 v[36:37], v18 offset:18432
    ds_read_b64_tr_b16 v[38:39], v18 offset:18688
    s_waitcnt lgkmcnt(8)
    v_mfma_f32_32x32x16_bf16 v[80:95], v[44:47], v[192:195], v[80:95]
    ds_read_b64_tr_b16 v[40:41], v14 offset:19456
    ds_read_b64_tr_b16 v[42:43], v14 offset:19712
    s_waitcnt vmcnt(9) lgkmcnt(8)
    v_mfma_f32_32x32x16_bf16 v[64:79], v[48:51], v[196:199], v[64:79]
    buffer_load_dwordx4 v[236:239], v2, s[36:39], s58 offen offset:3072 sc1
    s_add_u32 s58, s58, 4096
    ds_read_b64_tr_b16 v[44:45], v18 offset:19456
    ds_read_b64_tr_b16 v[46:47], v18 offset:19712
    s_waitcnt lgkmcnt(8)
    v_mfma_f32_32x32x16_bf16 v[80:95], v[52:55], v[196:199], v[80:95]
    ds_read_b64_tr_b16 v[48:49], v14 offset:20480
    ds_read_b64_tr_b16 v[50:51], v14 offset:20736
    s_waitcnt vmcnt(9) lgkmcnt(8)
    v_mfma_f32_32x32x16_bf16 v[64:79], v[32:35], v[200:203], v[64:79]
    buffer_load_dwordx4 v[240:243], v2, s[36:39], s58 offen offset:0 sc1
    ds_read_b64_tr_b16 v[52:53], v18 offset:20480
    ds_read_b64_tr_b16 v[54:55], v18 offset:20736
    s_waitcnt lgkmcnt(8)
    v_mfma_f32_32x32x16_bf16 v[80:95], v[36:39], v[200:203], v[80:95]
    ds_read_b64_tr_b16 v[32:33], v14 offset:21504
    ds_read_b64_tr_b16 v[34:35], v14 offset:21760
    s_waitcnt vmcnt(9) lgkmcnt(8)
    v_mfma_f32_32x32x16_bf16 v[64:79], v[40:43], v[204:207], v[64:79]
    buffer_load_dwordx4 v[244:247], v2, s[36:39], s58 offen offset:1024 sc1
    ds_read_b64_tr_b16 v[36:37], v18 offset:21504
    ds_read_b64_tr_b16 v[38:39], v18 offset:21760
    s_waitcnt lgkmcnt(8)
    v_mfma_f32_32x32x16_bf16 v[80:95], v[44:47], v[204:207], v[80:95]
    ds_read_b64_tr_b16 v[40:41], v14 offset:22528
    ds_read_b64_tr_b16 v[42:43], v14 offset:22784
    s_waitcnt vmcnt(9) lgkmcnt(8)
    v_mfma_f32_32x32x16_bf16 v[64:79], v[48:51], v[208:211], v[64:79]
    buffer_load_dwordx4 v[248:251], v2, s[36:39], s58 offen offset:2048 sc1
    ds_read_b64_tr_b16 v[44:45], v18 offset:22528
    ds_read_b64_tr_b16 v[46:47], v18 offset:22784
    s_waitcnt lgkmcnt(8)
    v_mfma_f32_32x32x16_bf16 v[80:95], v[52:55], v[208:211], v[80:95]
    ds_read_b64_tr_b16 v[48:49], v14 offset:23552
    ds_read_b64_tr_b16 v[50:51], v14 offset:23808
    s_waitcnt vmcnt(9) lgkmcnt(8)
    v_mfma_f32_32x32x16_bf16 v[64:79], v[32:35], v[212:215], v[64:79]
    buffer_load_dwordx4 v[252:255], v2, s[36:39], s58 offen offset:3072 sc1
    ds_read_b64_tr_b16 v[52:53], v18 offset:23552
    ds_read_b64_tr_b16 v[54:55], v18 offset:23808
    s_waitcnt lgkmcnt(8)
    v_mfma_f32_32x32x16_bf16 v[80:95], v[36:39], v[212:215], v[80:95]
    ds_read_b64_tr_b16 v[32:33], v14 offset:24576
    ds_read_b64_tr_b16 v[34:35], v14 offset:24832
    s_waitcnt vmcnt(9) lgkmcnt(8)
    v_mfma_f32_32x32x16_bf16 v[64:79], v[40:43], v[216:219], v[64:79]
    v_lshlrev_b32 v12, 7, v1
    s_lshr_b32 s7, s47, 1
    s_lshl1_add_u32 s7, s2, s7
    s_mul_i32 s6, s7, 2816
    s_mov_b64 exec, 0x3fffff
    buffer_load_dword v11, v12, s[52:55], s6 offen
    s_mov_b64 exec, -1
    ds_read_b64_tr_b16 v[36:37], v18 offset:24576
    ds_read_b64_tr_b16 v[38:39], v18 offset:24832
    s_waitcnt lgkmcnt(8)
    v_mfma_f32_32x32x16_bf16 v[80:95], v[44:47], v[216:219], v[80:95]
    ds_read_b64_tr_b16 v[40:41], v14 offset:25600
    ds_read_b64_tr_b16 v[42:43], v14 offset:25856
    s_waitcnt vmcnt(9) lgkmcnt(8)
    v_mfma_f32_32x32x16_bf16 v[64:79], v[48:51], v[220:223], v[64:79]
    s_add_u32 s81, s79, 244736
    buffer_load_dwordx4 v31, s[8:11], s81 offen offset:1024 lds
    ds_read_b64_tr_b16 v[44:45], v18 offset:25600
    ds_read_b64_tr_b16 v[46:47], v18 offset:25856
    s_waitcnt lgkmcnt(8)
    v_mfma_f32_32x32x16_bf16 v[80:95], v[52:55], v[220:223], v[80:95]
    ds_read_b64_tr_b16 v[48:49], v14 offset:26624
    ds_read_b64_tr_b16 v[50:51], v14 offset:26880
    s_waitcnt vmcnt(9) lgkmcnt(8)
    v_mfma_f32_32x32x16_bf16 v[64:79], v[32:35], v[224:227], v[64:79]
    s_add_u32 s81, s79, 292864
    buffer_load_dwordx4 v31, s[8:11], s81 offen offset:2048 lds
    ds_read_b64_tr_b16 v[52:53], v18 offset:26624
    ds_read_b64_tr_b16 v[54:55], v18 offset:26880
    s_waitcnt lgkmcnt(8)
    v_mfma_f32_32x32x16_bf16 v[80:95], v[36:39], v[224:227], v[80:95]
    ds_read_b64_tr_b16 v[32:33], v14 offset:27648
    ds_read_b64_tr_b16 v[34:35], v14 offset:27904
    s_waitcnt vmcnt(9) lgkmcnt(8)
    v_mfma_f32_32x32x16_bf16 v[64:79], v[40:43], v[228:231], v[64:79]
    s_add_u32 s81, s79, 340992
    buffer_load_dwordx4 v31, s[8:11], s81 offen offset:3072 lds
    ds_read_b64_tr_b16 v[36:37], v18 offset:27648
    ds_read_b64_tr_b16 v[38:39], v18 offset:27904
    s_waitcnt lgkmcnt(8)
    v_mfma_f32_32x32x16_bf16 v[80:95], v[44:47], v[228:231], v[80:95]
    ds_read_b64_tr_b16 v[40:41], v14 offset:28672
    ds_read_b64_tr_b16 v[42:43], v14 offset:28928
    s_waitcnt vmcnt(9) lgkmcnt(8)
    v_mfma_f32_32x32x16_bf16 v[64:79], v[48:51], v[232:235], v[64:79]
    ds_read_b64_tr_b16 v[44:45], v18 offset:28672
    ds_read_b64_tr_b16 v[46:47], v18 offset:28928
    s_waitcnt lgkmcnt(8)
    v_mfma_f32_32x32x16_bf16 v[80:95], v[52:55], v[232:235], v[80:95]
    ds_read_b64_tr_b16 v[48:49], v14 offset:29696
    ds_read_b64_tr_b16 v[50:51], v14 offset:29952
    s_waitcnt vmcnt(8) lgkmcnt(8)
    v_mfma_f32_32x32x16_bf16 v[64:79], v[32:35], v[236:239], v[64:79]
    ds_read_b64_tr_b16 v[52:53], v18 offset:29696
    ds_read_b64_tr_b16 v[54:55], v18 offset:29952
    s_waitcnt lgkmcnt(8)
    v_mfma_f32_32x32x16_bf16 v[80:95], v[36:39], v[236:239], v[80:95]
    ds_read_b64_tr_b16 v[32:33], v14 offset:30720
    ds_read_b64_tr_b16 v[34:35], v14 offset:30976
    s_waitcnt vmcnt(7) lgkmcnt(8)
    v_mfma_f32_32x32x16_bf16 v[64:79], v[40:43], v[240:243], v[64:79]
    ds_read_b64_tr_b16 v[36:37], v18 offset:30720
    ds_read_b64_tr_b16 v[38:39], v18 offset:30976
    s_waitcnt lgkmcnt(8)
    v_mfma_f32_32x32x16_bf16 v[80:95], v[44:47], v[240:243], v[80:95]
    ds_read_b64_tr_b16 v[40:41], v14 offset:31744
    ds_read_b64_tr_b16 v[42:43], v14 offset:32000
    s_waitcnt vmcnt(6) lgkmcnt(8)
    v_mfma_f32_32x32x16_bf16 v[64:79], v[48:51], v[244:247], v[64:79]
    ds_read_b64_tr_b16 v[44:45], v18 offset:31744
    ds_read_b64_tr_b16 v[46:47], v18 offset:32000
    s_waitcnt lgkmcnt(8)
    v_mfma_f32_32x32x16_bf16 v[80:95], v[52:55], v[244:247], v[80:95]
    s_waitcnt vmcnt(5) lgkmcnt(6)
    v_mfma_f32_32x32x16_bf16 v[64:79], v[32:35], v[248:251], v[64:79]
    s_waitcnt lgkmcnt(4)
    v_mfma_f32_32x32x16_bf16 v[80:95], v[36:39], v[248:251], v[80:95]
    s_waitcnt vmcnt(4) lgkmcnt(2)
    v_mfma_f32_32x32x16_bf16 v[64:79], v[40:43], v[252:255], v[64:79]
    s_waitcnt lgkmcnt(0)
    v_mfma_f32_32x32x16_bf16 v[80:95], v[44:47], v[252:255], v[80:95]
    s_lshl_b32 s56, s47, 13
    s_lshl_b32 s63, s49, 7
    s_add_u32 s56, s56, s63
    s_add_u32 s56, s56, 98304
    v_and_b32 v31, 3, v1
    v_lshl_add_u32 v31, v31, 11, s56
    s_mov_b32 s64, 30000
    buffer_load_dword v14, v31, s[36:39], 0 offen offset:0 sc1
    v_lshlrev_b32 v12, 7, v1
    s_lshl_b32 s6, s2, 11
    s_lshl_b32 s7, s47, 9
    s_add_u32 s6, s6, s7
    s_mov_b64 exec, 0xf
    buffer_load_dword v11, v12, s[12:15], s6 offen
    s_mov_b64 exec, -1
    s_lshr_b32 s57, s47, 1
    s_mul_i32 s79, s57, 44032
    s_mul_i32 s63, s49, 192
    s_add_u32 s79, s79, s63
    s_mul_i32 s80, s47, 3088
    v_cvt_pk_bf16_f32 v32, v64, v65
    v_cvt_pk_bf16_f32 v33, v66, v67
    v_cvt_pk_bf16_f32 v34, v68, v69
    v_cvt_pk_bf16_f32 v35, v70, v71
    v_cvt_pk_bf16_f32 v36, v72, v73
    v_cvt_pk_bf16_f32 v37, v74, v75
    v_cvt_pk_bf16_f32 v38, v76, v77
    v_cvt_pk_bf16_f32 v39, v78, v79
    v_mfma_f32_32x32x16_bf16 v[112:127], v[20:23], v[32:35], 0
    s_nop 0
    v_mfma_f32_32x32x16_bf16 v[96:111], v[24:27], v[36:39], 0
    v_cvt_pk_bf16_f32 v40, v80, v81
    v_cvt_pk_bf16_f32 v41, v82, v83
    v_cvt_pk_bf16_f32 v42, v84, v85
    v_cvt_pk_bf16_f32 v43, v86, v87
    v_cvt_pk_bf16_f32 v44, v88, v89
    v_cvt_pk_bf16_f32 v45, v90, v91
    v_cvt_pk_bf16_f32 v46, v92, v93
    v_cvt_pk_bf16_f32 v47, v94, v95
    ds_write_b128 v15, v[40:43] offset:16384
    ds_write_b128 v15, v[44:47] offset:16400
    v_max3_f32 v12, v112, v113, v114
    v_max3_f32 v13, v115, v116, v117
    v_max3_f32 v12, v12, v118, v119
    v_max3_f32 v13, v13, v120, v121
    v_max3_f32 v12, v12, v122, v123
    v_max3_f32 v13, v13, v124, v125
    v_max3_f32 v12, v12, v126, v127
    v_max_f32 v12, v12, v13
    v_pk_add_f32 v[112:113], v[112:113], v[12:13] op_sel_hi:[1,0] neg_lo:[0,1] neg_hi:[0,1]
    v_pk_add_f32 v[114:115], v[114:115], v[12:13] op_sel_hi:[1,0] neg_lo:[0,1] neg_hi:[0,1]
    v_pk_add_f32 v[116:117], v[116:117], v[12:13] op_sel_hi:[1,0] neg_lo:[0,1] neg_hi:[0,1]
    v_pk_add_f32 v[118:119], v[118:119], v[12:13] op_sel_hi:[1,0] neg_lo:[0,1] neg_hi:[0,1]
    v_pk_add_f32 v[120:121], v[120:121], v[12:13] op_sel_hi:[1,0] neg_lo:[0,1] neg_hi:[0,1]
    v_pk_add_f32 v[122:123], v[122:123], v[12:13] op_sel_hi:[1,0] neg_lo:[0,1] neg_hi:[0,1]
    v_pk_add_f32 v[124:125], v[124:125], v[12:13] op_sel_hi:[1,0] neg_lo:[0,1] neg_hi:[0,1]
    v_pk_add_f32 v[126:127], v[126:127], v[12:13] op_sel_hi:[1,0] neg_lo:[0,1] neg_hi:[0,1]
    v_pk_mul_f32 v[112:113], v[112:113], s[64:65] op_sel:[0,1]
    v_pk_mul_f32 v[114:115], v[114:115], s[64:65] op_sel:[0,1]
    v_pk_mul_f32 v[116:117], v[116:117], s[64:65] op_sel:[0,1]
    v_pk_mul_f32 v[118:119], v[118:119], s[64:65] op_sel:[0,1]
    v_pk_mul_f32 v[120:121], v[120:121], s[64:65] op_sel:[0,1]
    v_pk_mul_f32 v[122:123], v[122:123], s[64:65] op_sel:[0,1]
    v_pk_mul_f32 v[124:125], v[124:125], s[64:65] op_sel:[0,1]
    v_pk_mul_f32 v[126:127], v[126:127], s[64:65] op_sel:[0,1]
    v_exp_f32 v112, v112
    v_exp_f32 v113, v113
    v_exp_f32 v114, v114
    v_exp_f32 v115, v115
    v_exp_f32 v116, v116
    v_exp_f32 v117, v117
    v_exp_f32 v118, v118
    v_exp_f32 v119, v119
    v_exp_f32 v120, v120
    v_exp_f32 v121, v121
    v_exp_f32 v122, v122
    v_exp_f32 v123, v123
    v_exp_f32 v124, v124
    v_exp_f32 v125, v125
    v_exp_f32 v126, v126
    v_exp_f32 v127, v127
    v_pk_add_f32 v[12:13], v[112:113], v[114:115]
    v_pk_add_f32 v[16:17], v[116:117], v[118:119]
    v_pk_add_f32 v[12:13], v[12:13], v[120:121]
    v_pk_add_f32 v[16:17], v[16:17], v[122:123]
    v_pk_add_f32 v[12:13], v[12:13], v[124:125]
    v_pk_add_f32 v[16:17], v[16:17], v[126:127]
    v_pk_add_f32 v[12:13], v[12:13], v[16:17]
    v_add_f32 v12, v12, v13
    v_rcp_f32 v12, v12
    s_nop 0
    v_pk_mul_f32 v[112:113], v[112:113], v[12:13] op_sel_hi:[1,0]
    v_pk_mul_f32 v[114:115], v[114:115], v[12:13] op_sel_hi:[1,0]
    v_pk_mul_f32 v[116:117], v[116:117], v[12:13] op_sel_hi:[1,0]
    v_pk_mul_f32 v[118:119], v[118:119], v[12:13] op_sel_hi:[1,0]
    v_pk_mul_f32 v[120:121], v[120:121], v[12:13] op_sel_hi:[1,0]
    v_pk_mul_f32 v[122:123], v[122:123], v[12:13] op_sel_hi:[1,0]
    v_pk_mul_f32 v[124:125], v[124:125], v[12:13] op_sel_hi:[1,0]
    v_pk_mul_f32 v[126:127], v[126:127], v[12:13] op_sel_hi:[1,0]
    v_cvt_pk_bf16_f32 v32, v112, v113
    v_cvt_pk_bf16_f32 v33, v114, v115
    v_cvt_pk_bf16_f32 v34, v116, v117
    v_cvt_pk_bf16_f32 v35, v118, v119
    v_cvt_pk_bf16_f32 v36, v120, v121
    v_cvt_pk_bf16_f32 v37, v122, v123
    v_cvt_pk_bf16_f32 v38, v124, v125
    v_cvt_pk_bf16_f32 v39, v126, v127
    ds_write_b128 v15, v[32:35]
    ds_write_b128 v15, v[36:39] offset:16
    v_lshlrev_b32 v40, 7, v1
    s_lshl_b32 s6, s45, 18
    s_lshl_b32 s7, s46, 13
    s_add_u32 s6, s6, s7
    s_lshl_b32 s7, s47, 11
    s_add_u32 s6, s6, s7
    s_add_u32 s6, s6, 7340032
    s_mov_b64 exec, 0xffff
    buffer_load_dword v11, v40, s[36:39], s6 offen
    s_lshl_b32 s6, s45, 15
    s_lshl_b32 s7, s46, 10
    s_add_u32 s6, s6, s7
    s_lshl_b32 s7, s47, 8
    s_add_u32 s6, s6, s7
    s_add_u32 s6, s6, 524288
    s_mov_b64 exec, 0x3
    buffer_load_dword v11, v40, s[36:39], s6 offen
    s_mov_b64 exec, -1
    v_max3_f32 v12, v96, v97, v98
    v_max3_f32 v13, v99, v100, v101
    v_max3_f32 v12, v12, v102, v103
    v_max3_f32 v13, v13, v104, v105
    v_max3_f32 v12, v12, v106, v107
    v_max3_f32 v13, v13, v108, v109
    v_max3_f32 v12, v12, v110, v111
    v_max_f32 v12, v12, v13
    v_pk_add_f32 v[96:97], v[96:97], v[12:13] op_sel_hi:[1,0] neg_lo:[0,1] neg_hi:[0,1]
    v_pk_add_f32 v[98:99], v[98:99], v[12:13] op_sel_hi:[1,0] neg_lo:[0,1] neg_hi:[0,1]
    v_pk_add_f32 v[100:101], v[100:101], v[12:13] op_sel_hi:[1,0] neg_lo:[0,1] neg_hi:[0,1]
    v_pk_add_f32 v[102:103], v[102:103], v[12:13] op_sel_hi:[1,0] neg_lo:[0,1] neg_hi:[0,1]
    v_pk_add_f32 v[104:105], v[104:105], v[12:13] op_sel_hi:[1,0] neg_lo:[0,1] neg_hi:[0,1]
    v_pk_add_f32 v[106:107], v[106:107], v[12:13] op_sel_hi:[1,0] neg_lo:[0,1] neg_hi:[0,1]
    v_pk_add_f32 v[108:109], v[108:109], v[12:13] op_sel_hi:[1,0] neg_lo:[0,1] neg_hi:[0,1]
    v_pk_add_f32 v[110:111], v[110:111], v[12:13] op_sel_hi:[1,0] neg_lo:[0,1] neg_hi:[0,1]
    v_pk_mul_f32 v[96:97], v[96:97], s[64:65] op_sel:[0,1]
    v_pk_mul_f32 v[98:99], v[98:99], s[64:65] op_sel:[0,1]
    v_pk_mul_f32 v[100:101], v[100:101], s[64:65] op_sel:[0,1]
    v_pk_mul_f32 v[102:103], v[102:103], s[64:65] op_sel:[0,1]
    v_pk_mul_f32 v[104:105], v[104:105], s[64:65] op_sel:[0,1]
    v_pk_mul_f32 v[106:107], v[106:107], s[64:65] op_sel:[0,1]
    v_pk_mul_f32 v[108:109], v[108:109], s[64:65] op_sel:[0,1]
    v_pk_mul_f32 v[110:111], v[110:111], s[64:65] op_sel:[0,1]
    v_exp_f32 v96, v96
    v_exp_f32 v97, v97
    v_exp_f32 v98, v98
    v_exp_f32 v99, v99
    v_exp_f32 v100, v100
    v_exp_f32 v101, v101
    v_exp_f32 v102, v102
    v_exp_f32 v103, v103
    v_exp_f32 v104, v104
    v_exp_f32 v105, v105
    v_exp_f32 v106, v106
    v_exp_f32 v107, v107
    v_exp_f32 v108, v108
    v_exp_f32 v109, v109
    v_exp_f32 v110, v110
    v_exp_f32 v111, v111
    v_pk_add_f32 v[12:13], v[96:97], v[98:99]
    v_pk_add_f32 v[16:17], v[100:101], v[102:103]
    v_pk_add_f32 v[12:13], v[12:13], v[104:105]
    v_pk_add_f32 v[16:17], v[16:17], v[106:107]
    v_pk_add_f32 v[12:13], v[12:13], v[108:109]
    v_pk_add_f32 v[16:17], v[16:17], v[110:111]
    v_pk_add_f32 v[12:13], v[12:13], v[16:17]
    v_add_f32 v12, v12, v13
    v_rcp_f32 v12, v12
    s_nop 0
    v_pk_mul_f32 v[96:97], v[96:97], v[12:13] op_sel_hi:[1,0]
    v_pk_mul_f32 v[98:99], v[98:99], v[12:13] op_sel_hi:[1,0]
    v_pk_mul_f32 v[100:101], v[100:101], v[12:13] op_sel_hi:[1,0]
    v_pk_mul_f32 v[102:103], v[102:103], v[12:13] op_sel_hi:[1,0]
    v_pk_mul_f32 v[104:105], v[104:105], v[12:13] op_sel_hi:[1,0]
    v_pk_mul_f32 v[106:107], v[106:107], v[12:13] op_sel_hi:[1,0]
    v_pk_mul_f32 v[108:109], v[108:109], v[12:13] op_sel_hi:[1,0]
    v_pk_mul_f32 v[110:111], v[110:111], v[12:13] op_sel_hi:[1,0]
    v_cvt_pk_bf16_f32 v48, v96, v97
    v_cvt_pk_bf16_f32 v49, v98, v99
    v_cvt_pk_bf16_f32 v50, v100, v101
    v_cvt_pk_bf16_f32 v51, v102, v103
    v_cvt_pk_bf16_f32 v52, v104, v105
    v_cvt_pk_bf16_f32 v53, v106, v107
    v_cvt_pk_bf16_f32 v54, v108, v109
    v_cvt_pk_bf16_f32 v55, v110, v111
    ds_write_b128 v15, v[48:51] offset:8192
    ds_write_b128 v15, v[52:55] offset:8208
    s_lshl_b32 s56, s47, 12
    s_add_u32 s56, s56, 32768
    v_lshl_add_u32 v12, v1, 3, s56
    s_lshl_b32 s56, s57, 12
    s_add_u32 s56, s56, 49152
    v_lshl_add_u32 v13, v1, 3, s56
    v_mov_b32 v16, 0x3f803f80
    v_mov_b32 v17, 0x3f803f80
    v_mov_b32 v18, 0x3f803f80
    v_mov_b32 v19, 0x3f803f80
    s_waitcnt lgkmcnt(0)
    s_barrier
    ds_read_b64_tr_b16 v[64:65], v12 offset:0
    ds_read_b64_tr_b16 v[66:67], v12 offset:512
    ds_read_b64_tr_b16 v[68:69], v13 offset:0
    ds_read_b64_tr_b16 v[70:71], v13 offset:512
    ds_read_b64_tr_b16 v[72:73], v12 offset:1024
    ds_read_b64_tr_b16 v[74:75], v12 offset:1536
    ds_read_b64_tr_b16 v[76:77], v13 offset:1024
    ds_read_b64_tr_b16 v[78:79], v13 offset:1536
    ds_read_b64_tr_b16 v[80:81], v12 offset:2048
    ds_read_b64_tr_b16 v[82:83], v12 offset:2560
    ds_read_b64_tr_b16 v[84:85], v13 offset:2048
    ds_read_b64_tr_b16 v[86:87], v13 offset:2560
    ds_read_b64_tr_b16 v[88:89], v12 offset:3072
    ds_read_b64_tr_b16 v[90:91], v12 offset:3584
    ds_read_b64_tr_b16 v[92:93], v13 offset:3072
    ds_read_b64_tr_b16 v[94:95], v13 offset:3584
    s_lshl_b32 s82, s47, 16
    s_lshl_b32 s63, s51, 7
    s_add_u32 s82, s82, s63
    s_lshl_b32 s83, s47, 13
    s_waitcnt lgkmcnt(12)
    v_mfma_f32_16x16x32_bf16 v[112:115], v[64:67], v[68:71], 0
    v_mfma_f32_16x16x32_bf16 v[116:119], v[64:67], v[16:19], 0
    s_waitcnt lgkmcnt(8)
    v_mfma_f32_16x16x32_bf16 v[112:115], v[72:75], v[76:79], v[112:115]
    v_mfma_f32_16x16x32_bf16 v[116:119], v[72:75], v[16:19], v[116:119]
    s_waitcnt lgkmcnt(4)
    v_mfma_f32_16x16x32_bf16 v[112:115], v[80:83], v[84:87], v[112:115]
    v_mfma_f32_16x16x32_bf16 v[116:119], v[80:83], v[16:19], v[116:119]
    s_waitcnt lgkmcnt(0)
    v_mfma_f32_16x16x32_bf16 v[112:115], v[88:91], v[92:95], v[112:115]
    v_mfma_f32_16x16x32_bf16 v[116:119], v[88:91], v[16:19], v[116:119]
    s_nop 6
    v_cvt_pk_bf16_f32 v112, v112, v113
    v_cvt_pk_bf16_f32 v113, v114, v115
    v_cvt_pk_bf16_f32 v114, v116, v117
    v_cvt_pk_bf16_f32 v115, v118, v119
    s_nop 0
    v_permlane16_swap_b32 v112, v114
    v_permlane16_swap_b32 v113, v115
    s_mov_b32 exec_lo, 0x1ffff
    s_mov_b32 exec_hi, 0x1ffff
    buffer_store_dwordx4 v[112:115], v0, s[36:39], 0 offen sc1
    s_mov_b64 exec, -1
    s_cmp_eq_u32 s49, 15
    s_cselect_b32 s54, 0, s54
    s_add_u32 m0, s80, 131072
    s_add_u32 s81, s79, 0
    buffer_load_dwordx4 v28, s[52:55], s81 offen offset:0 lds
    s_waitcnt vmcnt(5)
PP_43:
    v_cmp_ne_u32 vcc, s44, v14
    s_cbranch_vccnz PR_45
PC_44:
    s_barrier
    ds_read_b64_tr_b16 v[32:33], v5 offset:0
    ds_read_b64_tr_b16 v[34:35], v5 offset:256
    ds_read_b64_tr_b16 v[36:37], v5 offset:1024
    ds_read_b64_tr_b16 v[38:39], v5 offset:1280
    ds_read_b64_tr_b16 v[40:41], v5 offset:2048
    ds_read_b64_tr_b16 v[42:43], v5 offset:2304
    ds_read_b64_tr_b16 v[44:45], v5 offset:3072
    ds_read_b64_tr_b16 v[46:47], v5 offset:3328
    ds_read_b64_tr_b16 v[48:49], v5 offset:4096
    ds_read_b64_tr_b16 v[50:51], v5 offset:4352
    s_waitcnt lgkmcnt(8)
    v_mfma_f32_32x32x16_bf16 v[96:111], v[32:35], v[128:131], 0
    buffer_load_dwordx4 v29, s[52:55], s81 offen offset:1024 lds
    ds_read_b64_tr_b16 v[52:53], v5 offset:5120
    ds_read_b64_tr_b16 v[54:55], v5 offset:5376
    s_waitcnt lgkmcnt(8)
    v_mfma_f32_32x32x16_bf16 v[96:111], v[36:39], v[132:135], v[96:111]
    ds_read_b64_tr_b16 v[32:33], v5 offset:6144
    ds_read_b64_tr_b16 v[34:35], v5 offset:6400
    s_waitcnt lgkmcnt(8)
    v_mfma_f32_32x32x16_bf16 v[96:111], v[40:43], v[136:139], v[96:111]
    ds_read_b64_tr_b16 v[36:37], v5 offset:7168
    ds_read_b64_tr_b16 v[38:39], v5 offset:7424
    s_waitcnt lgkmcnt(8)
    v_mfma_f32_32x32x16_bf16 v[96:111], v[44:47], v[140:143], v[96:111]
    buffer_load_dwordx4 v30, s[52:55], s81 offen offset:2048 lds
    ds_read_b64_tr_b16 v[40:41], v5 offset:8192
    ds_read_b64_tr_b16 v[42:43], v5 offset:8448
    s_waitcnt lgkmcnt(8)
    v_mfma_f32_32x32x16_bf16 v[96:111], v[48:51], v[144:147], v[96:111]
    ds_read_b64_tr_b16 v[44:45], v5 offset:9216
    ds_read_b64_tr_b16 v[46:47], v5 offset:9472
    s_waitcnt lgkmcnt(8)
    v_mfma_f32_32x32x16_bf16 v[96:111], v[52:55], v[148:151], v[96:111]
    ds_read_b64_tr_b16 v[48:49], v5 offset:10240
    ds_read_b64_tr_b16 v[50:51], v5 offset:10496
    s_waitcnt lgkmcnt(8)
    v_mfma_f32_32x32x16_bf16 v[96:111], v[32:35], v[152:155], v[96:111]
    s_add_u32 m0, s80, 143424
    s_add_u32 s81, s79, 88064
    buffer_load_dwordx4 v28, s[52:55], s81 offen offset:0 lds
    ds_read_b64_tr_b16 v[52:53], v5 offset:11264
    ds_read_b64_tr_b16 v[54:55], v5 offset:11520
    s_waitcnt lgkmcnt(8)
    v_mfma_f32_32x32x16_bf16 v[96:111], v[36:39], v[156:159], v[96:111]
    ds_read_b64_tr_b16 v[32:33], v5 offset:12288
    ds_read_b64_tr_b16 v[34:35], v5 offset:12544
    s_waitcnt lgkmcnt(8)
    v_mfma_f32_32x32x16_bf16 v[96:111], v[40:43], v[160:163], v[96:111]
    ds_read_b64_tr_b16 v[36:37], v5 offset:13312
    ds_read_b64_tr_b16 v[38:39], v5 offset:13568
    s_waitcnt lgkmcnt(8)
    v_mfma_f32_32x32x16_bf16 v[96:111], v[44:47], v[164:167], v[96:111]
    buffer_load_dwordx4 v29, s[52:55], s81 offen offset:1024 lds
    ds_read_b64_tr_b16 v[40:41], v5 offset:14336
    ds_read_b64_tr_b16 v[42:43], v5 offset:14592
    s_waitcnt lgkmcnt(8)
    v_mfma_f32_32x32x16_bf16 v[96:111], v[48:51], v[168:171], v[96:111]
    ds_read_b64_tr_b16 v[44:45], v5 offset:15360
    ds_read_b64_tr_b16 v[46:47], v5 offset:15616
    s_waitcnt lgkmcnt(8)
    v_mfma_f32_32x32x16_bf16 v[96:111], v[52:55], v[172:175], v[96:111]
    ds_read_b64_tr_b16 v[48:49], v5 offset:16384
    ds_read_b64_tr_b16 v[50:51], v5 offset:16640
    s_waitcnt lgkmcnt(8)
    v_mfma_f32_32x32x16_bf16 v[96:111], v[32:35], v[176:179], v[96:111]
    buffer_load_dwordx4 v30, s[52:55], s81 offen offset:2048 lds
    ds_read_b64_tr_b16 v[52:53], v5 offset:17408
    ds_read_b64_tr_b16 v[54:55], v5 offset:17664
    s_waitcnt lgkmcnt(8)
    v_mfma_f32_32x32x16_bf16 v[96:111], v[36:39], v[180:183], v[96:111]
    ds_read_b64_tr_b16 v[32:33], v5 offset:18432
    ds_read_b64_tr_b16 v[34:35], v5 offset:18688
    s_waitcnt lgkmcnt(8)
    v_mfma_f32_32x32x16_bf16 v[96:111], v[40:43], v[184:187], v[96:111]
    ds_read_b64_tr_b16 v[36:37], v5 offset:19456
    ds_read_b64_tr_b16 v[38:39], v5 offset:19712
    s_waitcnt lgkmcnt(8)
    v_mfma_f32_32x32x16_bf16 v[96:111], v[44:47], v[188:191], v[96:111]
    s_add_u32 m0, s80, 65536
    s_add_u32 s81, s79, 176128
    buffer_load_dwordx4 v28, s[52:55], s81 offen offset:0 lds
    ds_read_b64_tr_b16 v[40:41], v5 offset:20480
    ds_read_b64_tr_b16 v[42:43], v5 offset:20736
    s_waitcnt lgkmcnt(8)
    v_mfma_f32_32x32x16_bf16 v[96:111], v[48:51], v[192:195], v[96:111]
    ds_read_b64_tr_b16 v[44:45], v5 offset:21504
    ds_read_b64_tr_b16 v[46:47], v5 offset:21760
    s_waitcnt lgkmcnt(8)
    v_mfma_f32_32x32x16_bf16 v[96:111], v[52:55], v[196:199], v[96:111]
    ds_read_b64_tr_b16 v[48:49], v5 offset:22528
    ds_read_b64_tr_b16 v[50:51], v5 offset:22784
    s_waitcnt lgkmcnt(8)
    v_mfma_f32_32x32x16_bf16 v[96:111], v[32:35], v[200:203], v[96:111]
    buffer_load_dwordx4 v29, s[52:55], s81 offen offset:1024 lds
    ds_read_b64_tr_b16 v[52:53], v5 offset:23552
    ds_read_b64_tr_b16 v[54:55], v5 offset:23808
    s_waitcnt lgkmcnt(8)
    v_mfma_f32_32x32x16_bf16 v[96:111], v[36:39], v[204:207], v[96:111]
    ds_read_b64_tr_b16 v[32:33], v5 offset:24576
    ds_read_b64_tr_b16 v[34:35], v5 offset:24832
    s_waitcnt lgkmcnt(8)
    v_mfma_f32_32x32x16_bf16 v[96:111], v[40:43], v[208:211], v[96:111]
    ds_read_b64_tr_b16 v[36:37], v5 offset:25600
    ds_read_b64_tr_b16 v[38:39], v5 offset:25856
    s_waitcnt lgkmcnt(8)
    v_mfma_f32_32x32x16_bf16 v[96:111], v[44:47], v[212:215], v[96:111]
    buffer_load_dwordx4 v30, s[52:55], s81 offen offset:2048 lds
    ds_read_b64_tr_b16 v[40:41], v5 offset:26624
    ds_read_b64_tr_b16 v[42:43], v5 offset:26880
    s_waitcnt lgkmcnt(8)
    v_mfma_f32_32x32x16_bf16 v[96:111], v[48:51], v[216:219], v[96:111]
    ds_read_b64_tr_b16 v[44:45], v5 offset:27648
    ds_read_b64_tr_b16 v[46:47], v5 offset:27904
    s_waitcnt lgkmcnt(8)
    v_mfma_f32_32x32x16_bf16 v[96:111], v[52:55], v[220:223], v[96:111]
    ds_read_b64_tr_b16 v[48:49], v5 offset:28672
    ds_read_b64_tr_b16 v[50:51], v5 offset:28928
    s_waitcnt lgkmcnt(8)
    v_mfma_f32_32x32x16_bf16 v[96:111], v[32:35], v[224:227], v[96:111]
    s_add_u32 m0, s80, 77888
    s_add_u32 s81, s79, 264192
    buffer_load_dwordx4 v28, s[52:55], s81 offen offset:0 lds
    ds_read_b64_tr_b16 v[52:53], v5 offset:29696
    ds_read_b64_tr_b16 v[54:55], v5 offset:29952
    s_waitcnt lgkmcnt(8)
    v_mfma_f32_32x32x16_bf16 v[96:111], v[36:39], v[228:231], v[96:111]
    ds_read_b64_tr_b16 v[32:33], v5 offset:30720
    ds_read_b64_tr_b16 v[34:35], v5 offset:30976
    s_waitcnt lgkmcnt(8)
    v_mfma_f32_32x32x16_bf16 v[96:111], v[40:43], v[232:235], v[96:111]
    ds_read_b64_tr_b16 v[36:37], v5 offset:31744
    ds_read_b64_tr_b16 v[38:39], v5 offset:32000
    s_waitcnt lgkmcnt(8)
    v_mfma_f32_32x32x16_bf16 v[96:111], v[44:47], v[236:239], v[96:111]
    buffer_load_dwordx4 v29, s[52:55], s81 offen offset:1024 lds
    s_waitcnt lgkmcnt(6)
    v_mfma_f32_32x32x16_bf16 v[96:111], v[48:51], v[240:243], v[96:111]
    s_waitcnt lgkmcnt(4)
    v_mfma_f32_32x32x16_bf16 v[96:111], v[52:55], v[244:247], v[96:111]
    s_waitcnt lgkmcnt(2)
    v_mfma_f32_32x32x16_bf16 v[96:111], v[32:35], v[248:251], v[96:111]
    buffer_load_dwordx4 v30, s[52:55], s81 offen offset:2048 lds
    s_waitcnt lgkmcnt(0)
    v_mfma_f32_32x32x16_bf16 v[96:111], v[36:39], v[252:255], v[96:111]
    s_lshl_b32 s61, s49, 2
    s_add_u32 s61, s61, s47
    s_lshl_b32 s56, s61, 13
    s_add_u32 s56, s56, 1048576
    s_add_u32 s57, s56, 4096
    s_lshl_b32 s58, s49, 11
    s_lshl_b32 s63, s47, 5
    s_add_u32 s58, s58, s63
    s_add_u32 s58, s58, 262144
    v_lshrrev_b32 v14, 1, v10
    v_lshl_add_u32 v14, v8, 3, v14
    v_and_b32 v15, 1, v1
    v_lshlrev_b32 v15, 4, v15
    v_lshl_add_u32 v14, v14, 7, v15
    v_cvt_pk_bf16_f32 v32, v96, v97
    v_cvt_pk_bf16_f32 v33, v98, v99
    v_cvt_pk_bf16_f32 v34, v100, v101
    v_cvt_pk_bf16_f32 v35, v102, v103
    v_cvt_pk_bf16_f32 v36, v104, v105
    v_cvt_pk_bf16_f32 v37, v106, v107
    v_cvt_pk_bf16_f32 v38, v108, v109
    v_cvt_pk_bf16_f32 v39, v110, v111
    v_mfma_f32_32x32x16_bf16 v[112:127], v[20:23], v[32:35], 0
    s_nop 0
    v_mfma_f32_32x32x16_bf16 v[64:79], v[24:27], v[36:39], 0
    v_mov_b32 v160, 0
    v_mov_b32 v161, 0
    v_mov_b32 v162, 0
    v_mov_b32 v163, 0
    s_nop 5
    v_max3_f32 v12, v112, v113, v114
    v_max3_f32 v13, v115, v116, v117
    v_max3_f32 v12, v12, v118, v119
    v_max3_f32 v13, v13, v120, v121
    v_max3_f32 v12, v12, v122, v123
    v_max3_f32 v13, v13, v124, v125
    v_max3_f32 v12, v12, v126, v127
    v_max_f32 v12, v12, v13
    v_pk_add_f32 v[112:113], v[112:113], v[12:13] op_sel_hi:[1,0] neg_lo:[0,1] neg_hi:[0,1]
    v_pk_add_f32 v[114:115], v[114:115], v[12:13] op_sel_hi:[1,0] neg_lo:[0,1] neg_hi:[0,1]
    v_pk_add_f32 v[116:117], v[116:117], v[12:13] op_sel_hi:[1,0] neg_lo:[0,1] neg_hi:[0,1]
    v_pk_add_f32 v[118:119], v[118:119], v[12:13] op_sel_hi:[1,0] neg_lo:[0,1] neg_hi:[0,1]
    v_pk_add_f32 v[120:121], v[120:121], v[12:13] op_sel_hi:[1,0] neg_lo:[0,1] neg_hi:[0,1]
    v_pk_add_f32 v[122:123], v[122:123], v[12:13] op_sel_hi:[1,0] neg_lo:[0,1] neg_hi:[0,1]
    v_pk_add_f32 v[124:125], v[124:125], v[12:13] op_sel_hi:[1,0] neg_lo:[0,1] neg_hi:[0,1]
    v_pk_add_f32 v[126:127], v[126:127], v[12:13] op_sel_hi:[1,0] neg_lo:[0,1] neg_hi:[0,1]
    v_pk_mul_f32 v[112:113], v[112:113], s[64:65] op_sel:[0,1]
    v_pk_mul_f32 v[114:115], v[114:115], s[64:65] op_sel:[0,1]
    v_pk_mul_f32 v[116:117], v[116:117], s[64:65] op_sel:[0,1]
    v_pk_mul_f32 v[118:119], v[118:119], s[64:65] op_sel:[0,1]
    v_pk_mul_f32 v[120:121], v[120:121], s[64:65] op_sel:[0,1]
    v_pk_mul_f32 v[122:123], v[122:123], s[64:65] op_sel:[0,1]
    v_pk_mul_f32 v[124:125], v[124:125], s[64:65] op_sel:[0,1]
    v_pk_mul_f32 v[126:127], v[126:127], s[64:65] op_sel:[0,1]
    v_exp_f32 v112, v112
    v_exp_f32 v113, v113
    v_exp_f32 v114, v114
    v_exp_f32 v115, v115
    v_exp_f32 v116, v116
    v_exp_f32 v117, v117
    v_exp_f32 v118, v118
    v_exp_f32 v119, v119
    v_exp_f32 v120, v120
    v_exp_f32 v121, v121
    v_exp_f32 v122, v122
    v_exp_f32 v123, v123
    v_exp_f32 v124, v124
    v_exp_f32 v125, v125
    v_exp_f32 v126, v126
    v_exp_f32 v127, v127
    v_pk_add_f32 v[12:13], v[112:113], v[114:115]
    v_pk_add_f32 v[16:17], v[116:117], v[118:119]
    v_pk_add_f32 v[12:13], v[12:13], v[120:121]
    v_pk_add_f32 v[16:17], v[16:17], v[122:123]
    v_pk_add_f32 v[12:13], v[12:13], v[124:125]
    v_pk_add_f32 v[16:17], v[16:17], v[126:127]
    v_pk_add_f32 v[12:13], v[12:13], v[16:17]
    v_add_f32 v12, v12, v13
    v_rcp_f32 v12, v12
    s_nop 0
    v_pk_mul_f32 v[112:113], v[112:113], v[12:13] op_sel_hi:[1,0]
    v_pk_mul_f32 v[114:115], v[114:115], v[12:13] op_sel_hi:[1,0]
    v_pk_mul_f32 v[116:117], v[116:117], v[12:13] op_sel_hi:[1,0]
    v_pk_mul_f32 v[118:119], v[118:119], v[12:13] op_sel_hi:[1,0]
    v_pk_mul_f32 v[120:121], v[120:121], v[12:13] op_sel_hi:[1,0]
    v_pk_mul_f32 v[122:123], v[122:123], v[12:13] op_sel_hi:[1,0]
    v_pk_mul_f32 v[124:125], v[124:125], v[12:13] op_sel_hi:[1,0]
    v_pk_mul_f32 v[126:127], v[126:127], v[12:13] op_sel_hi:[1,0]
    v_cvt_pk_bf16_f32 v40, v112, v113
    v_cvt_pk_bf16_f32 v41, v114, v115
    v_cvt_pk_bf16_f32 v42, v116, v117
    v_cvt_pk_bf16_f32 v43, v118, v119
    v_cvt_pk_bf16_f32 v44, v120, v121
    v_cvt_pk_bf16_f32 v45, v122, v123
    v_cvt_pk_bf16_f32 v46, v124, v125
    v_cvt_pk_bf16_f32 v47, v126, v127
    v_max3_f32 v12, v64, v65, v66
    v_max3_f32 v13, v67, v68, v69
    v_max3_f32 v12, v12, v70, v71
    v_max3_f32 v13, v13, v72, v73
    v_max3_f32 v12, v12, v74, v75
    v_max3_f32 v13, v13, v76, v77
    v_max3_f32 v12, v12, v78, v79
    v_max_f32 v12, v12, v13
    v_pk_add_f32 v[64:65], v[64:65], v[12:13] op_sel_hi:[1,0] neg_lo:[0,1] neg_hi:[0,1]
    v_pk_add_f32 v[66:67], v[66:67], v[12:13] op_sel_hi:[1,0] neg_lo:[0,1] neg_hi:[0,1]
    v_pk_add_f32 v[68:69], v[68:69], v[12:13] op_sel_hi:[1,0] neg_lo:[0,1] neg_hi:[0,1]
    v_pk_add_f32 v[70:71], v[70:71], v[12:13] op_sel_hi:[1,0] neg_lo:[0,1] neg_hi:[0,1]
    v_pk_add_f32 v[72:73], v[72:73], v[12:13] op_sel_hi:[1,0] neg_lo:[0,1] neg_hi:[0,1]
    v_pk_add_f32 v[74:75], v[74:75], v[12:13] op_sel_hi:[1,0] neg_lo:[0,1] neg_hi:[0,1]
    v_pk_add_f32 v[76:77], v[76:77], v[12:13] op_sel_hi:[1,0] neg_lo:[0,1] neg_hi:[0,1]
    v_pk_add_f32 v[78:79], v[78:79], v[12:13] op_sel_hi:[1,0] neg_lo:[0,1] neg_hi:[0,1]
    v_pk_mul_f32 v[64:65], v[64:65], s[64:65] op_sel:[0,1]
    v_pk_mul_f32 v[66:67], v[66:67], s[64:65] op_sel:[0,1]
    v_pk_mul_f32 v[68:69], v[68:69], s[64:65] op_sel:[0,1]
    v_pk_mul_f32 v[70:71], v[70:71], s[64:65] op_sel:[0,1]
    v_pk_mul_f32 v[72:73], v[72:73], s[64:65] op_sel:[0,1]
    s_mov_b32 s64, 30000
    s_mov_b32 exec_lo, 0xffff
    s_mov_b32 exec_hi, 0xffff
    buffer_load_dwordx4 v[160:163], v14, s[36:39], s58 offen sc1
    s_mov_b64 exec, -1
    buffer_load_dwordx4 v[128:131], v2, s[36:39], s56 offen offset:0 sc1
    buffer_load_dwordx4 v[132:135], v2, s[36:39], s56 offen offset:1024 sc1
    buffer_load_dwordx4 v[136:139], v2, s[36:39], s56 offen offset:2048 sc1
    buffer_load_dwordx4 v[140:143], v2, s[36:39], s56 offen offset:3072 sc1
    buffer_load_dwordx4 v[144:147], v2, s[36:39], s57 offen offset:0 sc1
    buffer_load_dwordx4 v[148:151], v2, s[36:39], s57 offen offset:1024 sc1
    buffer_load_dwordx4 v[152:155], v2, s[36:39], s57 offen offset:2048 sc1
    buffer_load_dwordx4 v[156:159], v2, s[36:39], s57 offen offset:3072 sc1
    v_pk_mul_f32 v[74:75], v[74:75], s[64:65] op_sel:[0,1]
    v_pk_mul_f32 v[76:77], v[76:77], s[64:65] op_sel:[0,1]
    v_pk_mul_f32 v[78:79], v[78:79], s[64:65] op_sel:[0,1]
    v_exp_f32 v64, v64
    s_add_u32 m0, s80, 90240
    s_add_u32 s81, s79, 352256
    buffer_load_dwordx4 v28, s[52:55], s81 offen offset:0 lds
    v_exp_f32 v65, v65
    v_exp_f32 v66, v66
    v_exp_f32 v67, v67
    v_exp_f32 v68, v68
    v_exp_f32 v69, v69
    v_exp_f32 v70, v70
    v_exp_f32 v71, v71
    v_exp_f32 v72, v72
    v_exp_f32 v73, v73
    v_exp_f32 v74, v74
    v_exp_f32 v75, v75
    v_exp_f32 v76, v76
    buffer_load_dwordx4 v29, s[52:55], s81 offen offset:1024 lds
    v_exp_f32 v77, v77
    v_exp_f32 v78, v78
    v_exp_f32 v79, v79
    v_pk_add_f32 v[12:13], v[64:65], v[66:67]
    v_pk_add_f32 v[16:17], v[68:69], v[70:71]
    v_pk_add_f32 v[12:13], v[12:13], v[72:73]
    v_pk_add_f32 v[16:17], v[16:17], v[74:75]
    v_pk_add_f32 v[12:13], v[12:13], v[76:77]
    v_pk_add_f32 v[16:17], v[16:17], v[78:79]
    v_pk_add_f32 v[12:13], v[12:13], v[16:17]
    v_add_f32 v12, v12, v13
    v_rcp_f32 v12, v12
    buffer_load_dwordx4 v30, s[52:55], s81 offen offset:2048 lds
    v_pk_mul_f32 v[64:65], v[64:65], v[12:13] op_sel_hi:[1,0]
    v_pk_mul_f32 v[66:67], v[66:67], v[12:13] op_sel_hi:[1,0]
    v_pk_mul_f32 v[68:69], v[68:69], v[12:13] op_sel_hi:[1,0]
    v_pk_mul_f32 v[70:71], v[70:71], v[12:13] op_sel_hi:[1,0]
    v_pk_mul_f32 v[72:73], v[72:73], v[12:13] op_sel_hi:[1,0]
    v_pk_mul_f32 v[74:75], v[74:75], v[12:13] op_sel_hi:[1,0]
    v_pk_mul_f32 v[76:77], v[76:77], v[12:13] op_sel_hi:[1,0]
    v_pk_mul_f32 v[78:79], v[78:79], v[12:13] op_sel_hi:[1,0]
    v_cvt_pk_bf16_f32 v48, v64, v65
    v_cvt_pk_bf16_f32 v49, v66, v67
    v_cvt_pk_bf16_f32 v50, v68, v69
    v_cvt_pk_bf16_f32 v51, v70, v71
    s_add_u32 m0, s80, 102592
    s_add_u32 s81, s79, 440320
    buffer_load_dwordx4 v28, s[52:55], s81 offen offset:0 lds
    v_cvt_pk_bf16_f32 v52, v72, v73
    v_cvt_pk_bf16_f32 v53, v74, v75
    v_cvt_pk_bf16_f32 v54, v76, v77
    v_cvt_pk_bf16_f32 v55, v78, v79
    s_mul_i32 s62, s47, 576
    s_add_u32 s62, s62, 161280
    v_lshl_add_u32 v16, v9, 3, s62
    v_lshl_add_u32 v17, v10, 5, v16
    v_lshl_add_u32 v16, v8, 4, v16
    v_add_u32 v16, v16, v15
    v_bfe_u32 v12, v1, 2, 1
    v_bfe_u32 v13, v1, 3, 1
    buffer_load_dwordx4 v29, s[52:55], s81 offen offset:1024 lds
    v_and_b32 v18, 3, v1
    v_lshl_add_u32 v18, v12, 3, v18
    v_lshl_add_u32 v18, v13, 2, v18
    v_cmp_lt_u32 vcc, 15, v7
    s_nop 1
    v_cndmask_b32 v18, v18, 16, vcc
    v_lshlrev_b32 v18, 5, v18
    v_mul_u32_u24 v12, 576, v8
    v_add_u32 v12, 161280, v12
    v_add_u32 v18, v18, v12
    buffer_load_dwordx4 v30, s[52:55], s81 offen offset:2048 lds
    s_add_u32 m0, s80, 114944
    s_add_u32 s81, s79, 528384
    buffer_load_dwordx4 v28, s[52:55], s81 offen offset:0 lds
    buffer_load_dwordx4 v29, s[52:55], s81 offen offset:1024 lds
    buffer_load_dwordx4 v30, s[52:55], s81 offen offset:2048 lds
    s_waitcnt vmcnt(9)
PP_46:
    v_mfma_f32_16x16x32_bf16 v[116:119], v[56:59], v[160:163], 0
    v_mfma_f32_16x16x32_bf16 v[112:115], v[56:59], v[128:131], 0
    v_max3_u32 v12, v128, v132, v136
    v_mfma_f32_16x16x32_bf16 v[112:115], v[56:59], v[132:135], v[112:115]
    v_max3_u32 v12, v12, v140, v144
    v_mfma_f32_16x16x32_bf16 v[112:115], v[56:59], v[136:139], v[112:115]
    v_max3_u32 v12, v12, v148, v152
    v_mfma_f32_16x16x32_bf16 v[112:115], v[56:59], v[140:143], v[112:115]
    v_max3_u32 v12, v12, v156, v160
    v_add_f32_dpp v116, v116, v116 row_ror:2 row_mask:0xf bank_mask:0xf
    v_add_f32_dpp v117, v117, v117 row_ror:2 row_mask:0xf bank_mask:0xf
    v_add_f32_dpp v118, v118, v118 row_ror:2 row_mask:0xf bank_mask:0xf
    v_add_f32_dpp v119, v119, v119 row_ror:2 row_mask:0xf bank_mask:0xf
    v_mfma_f32_16x16x32_bf16 v[112:115], v[56:59], v[144:147], v[112:115]
    v_add_f32_dpp v116, v116, v116 row_ror:4 row_mask:0xf bank_mask:0xf
    v_add_f32_dpp v117, v117, v117 row_ror:4 row_mask:0xf bank_mask:0xf
    v_add_f32_dpp v118, v118, v118 row_ror:4 row_mask:0xf bank_mask:0xf
    v_add_f32_dpp v119, v119, v119 row_ror:4 row_mask:0xf bank_mask:0xf
    v_mfma_f32_16x16x32_bf16 v[112:115], v[56:59], v[148:151], v[112:115]
    v_add_f32_dpp v116, v116, v116 row_ror:8 row_mask:0xf bank_mask:0xf
    v_add_f32_dpp v117, v117, v117 row_ror:8 row_mask:0xf bank_mask:0xf
    v_add_f32_dpp v118, v118, v118 row_ror:8 row_mask:0xf bank_mask:0xf
    v_add_f32_dpp v119, v119, v119 row_ror:8 row_mask:0xf bank_mask:0xf
    v_mfma_f32_16x16x32_bf16 v[112:115], v[56:59], v[152:155], v[112:115]
    v_mfma_f32_16x16x32_bf16 v[112:115], v[56:59], v[156:159], v[112:115]
    v_cvt_pk_bf16_f32 v116, v116, v117
    v_cvt_pk_bf16_f32 v117, v118, v119
    v_cmp_eq_u32 vcc, -1, v12
    s_cbranch_vccnz PR_48
PC_47:
    ds_write_b64 v16, v[116:117] offset:512
    s_nop 2
    v_cvt_pk_bf16_f32 v112, v112, v113
    v_cvt_pk_bf16_f32 v113, v114, v115
    ds_write_b64 v17, v[112:113]
    s_waitcnt lgkmcnt(0)
    s_barrier
    ds_read_b128 v[64:67], v18 offset:0
    ds_read_b128 v[68:71], v18 offset:16
    ds_read_b128 v[72:75], v18 offset:1152
    ds_read_b128 v[76:79], v18 offset:1168
    s_waitcnt lgkmcnt(3)
    v_mfma_f32_32x32x16_bf16 v[96:111], v[64:67], v[40:43], 0
    s_waitcnt lgkmcnt(2)
    v_mfma_f32_32x32x16_bf16 v[96:111], v[68:71], v[44:47], v[96:111]
    s_waitcnt lgkmcnt(1)
    v_mfma_f32_32x32x16_bf16 v[112:127], v[72:75], v[48:51], 0
    s_waitcnt lgkmcnt(0)
    v_mfma_f32_32x32x16_bf16 v[112:127], v[76:79], v[52:55], v[112:127]
    s_nop 7
    v_add_f32 v104, 0x358637bd, v104
    v_rcp_f32 v104, v104
    s_nop 0
    v_pk_mul_f32 v[96:97], v[96:97], v[104:105] op_sel_hi:[1,0]
    v_pk_mul_f32 v[98:99], v[98:99], v[104:105] op_sel_hi:[1,0]
    v_pk_mul_f32 v[100:101], v[100:101], v[104:105] op_sel_hi:[1,0]
    v_pk_mul_f32 v[102:103], v[102:103], v[104:105] op_sel_hi:[1,0]
    v_cvt_pk_bf16_f32 v32, v96, v97
    v_cvt_pk_bf16_f32 v33, v98, v99
    v_cvt_pk_bf16_f32 v34, v100, v101
    v_cvt_pk_bf16_f32 v35, v102, v103
    buffer_store_dwordx4 v[32:35], v2, s[36:39], s60 offen offset:0 sc1
    v_add_f32 v120, 0x358637bd, v120
    v_rcp_f32 v120, v120
    s_nop 0
    v_pk_mul_f32 v[112:113], v[112:113], v[120:121] op_sel_hi:[1,0]
    v_pk_mul_f32 v[114:115], v[114:115], v[120:121] op_sel_hi:[1,0]
    v_pk_mul_f32 v[116:117], v[116:117], v[120:121] op_sel_hi:[1,0]
    v_pk_mul_f32 v[118:119], v[118:119], v[120:121] op_sel_hi:[1,0]
    v_cvt_pk_bf16_f32 v36, v112, v113
    v_cvt_pk_bf16_f32 v37, v114, v115
    v_cvt_pk_bf16_f32 v38, v116, v117
    v_cvt_pk_bf16_f32 v39, v118, v119
    buffer_store_dwordx4 v[36:39], v2, s[36:39], s60 offen offset:1024 sc1
    s_add_u32 m0, s83, 32768
    s_add_u32 s81, s82, 262144
    buffer_load_dwordx4 v62, s[12:15], s81 offen offset:0 lds
    v_and_b32 v12, 1, v1
    v_lshlrev_b32 v12, 10, v12
    v_sub_u32 v12, 158208, v12
    v_lshl_add_u32 v12, v9, 4, v12
    ds_read_b128 v[80:83], v12 offset:0
    ds_read_b128 v[84:87], v12 offset:64
    ds_read_b128 v[88:91], v12 offset:128
    ds_read_b128 v[92:95], v12 offset:192
    v_add_u32 v12, 131072, v60
    s_add_u32 s81, s82, 269312
    buffer_load_dwordx4 v62, s[12:15], s81 offen offset:1024 lds
    v_add_u32 v13, 131072, v61
    ds_read_b64_tr_b16 a[0:1], v12 offset:0
    ds_read_b64_tr_b16 a[2:3], v12 offset:768
    ds_read_b64_tr_b16 a[4:5], v12 offset:3088
    ds_read_b64_tr_b16 a[6:7], v12 offset:3856
    ds_read_b64_tr_b16 a[8:9], v13 offset:0
    ds_read_b64_tr_b16 a[10:11], v13 offset:768
    ds_read_b64_tr_b16 a[12:13], v12 offset:12352
    ds_read_b64_tr_b16 a[14:15], v12 offset:13120
    s_add_u32 s81, s82, 276480
    buffer_load_dwordx4 v62, s[12:15], s81 offen offset:2048 lds
    ds_read_b64_tr_b16 a[16:17], v12 offset:15440
    ds_read_b64_tr_b16 a[18:19], v12 offset:16208
    ds_read_b64_tr_b16 a[20:21], v13 offset:12352
    ds_read_b64_tr_b16 a[22:23], v13 offset:13120
    v_add_u32 v12, 65536, v60
    v_add_u32 v13, 65536, v61
    ds_read_b64_tr_b16 a[24:25], v12 offset:0
    ds_read_b64_tr_b16 a[26:27], v12 offset:768
    ds_read_b64_tr_b16 a[28:29], v12 offset:3088
    s_add_u32 s81, s82, 283648
    buffer_load_dwordx4 v62, s[12:15], s81 offen offset:3072 lds
    ds_read_b64_tr_b16 a[30:31], v12 offset:3856
    ds_read_b64_tr_b16 a[32:33], v13 offset:0
    ds_read_b64_tr_b16 a[34:35], v13 offset:768
    s_waitcnt lgkmcnt(12)
    v_mfma_f32_16x16x32_bf16 v[116:119], v[80:83], a[0:3], 0
    v_mfma_f32_16x16x32_bf16 v[120:123], v[80:83], a[4:7], 0
    v_mfma_f32_16x16x32_bf16 v[124:127], v[80:83], a[8:11], 0
    ds_read_b64_tr_b16 a[36:37], v12 offset:12352
    ds_read_b64_tr_b16 a[38:39], v12 offset:13120
    ds_read_b64_tr_b16 a[40:41], v12 offset:15440
    s_add_u32 m0, s83, 36864
    s_add_u32 s81, s82, 294912
    buffer_load_dwordx4 v62, s[12:15], s81 offen offset:0 lds
    ds_read_b64_tr_b16 a[42:43], v12 offset:16208
    ds_read_b64_tr_b16 a[44:45], v13 offset:12352
    ds_read_b64_tr_b16 a[46:47], v13 offset:13120
    s_waitcnt lgkmcnt(12)
    v_mfma_f32_16x16x32_bf16 v[116:119], v[84:87], a[12:15], v[116:119]
    v_mfma_f32_16x16x32_bf16 v[120:123], v[84:87], a[16:19], v[120:123]
    v_mfma_f32_16x16x32_bf16 v[124:127], v[84:87], a[20:23], v[124:127]
    s_waitcnt lgkmcnt(6)
    v_mfma_f32_16x16x32_bf16 v[116:119], v[88:91], a[24:27], v[116:119]
    v_mfma_f32_16x16x32_bf16 v[120:123], v[88:91], a[28:31], v[120:123]
    v_mfma_f32_16x16x32_bf16 v[124:127], v[88:91], a[32:35], v[124:127]
    s_add_u32 s81, s82, 302080
    buffer_load_dwordx4 v62, s[12:15], s81 offen offset:1024 lds
    s_waitcnt lgkmcnt(0)
    v_mfma_f32_16x16x32_bf16 v[116:119], v[92:95], a[36:39], v[116:119]
    v_mfma_f32_16x16x32_bf16 v[120:123], v[92:95], a[40:43], v[120:123]
    v_mfma_f32_16x16x32_bf16 v[124:127], v[92:95], a[44:47], v[124:127]
    s_waitcnt vmcnt(6)
    s_mov_b64 exec, 1
    buffer_store_dword v3, off, s[36:39], s59 offset:1024 sc1
    s_mov_b64 exec, -1
    s_add_u32 s81, s82, 309248
    buffer_load_dwordx4 v62, s[12:15], s81 offen offset:2048 lds
    s_add_u32 s81, s82, 316416
    buffer_load_dwordx4 v62, s[12:15], s81 offen offset:3072 lds
    s_add_u32 m0, s83, 0
    s_add_u32 s81, s82, 0
    buffer_load_dwordx4 v62, s[12:15], s81 offen offset:0 lds
    s_add_u32 s81, s82, 7168
    buffer_load_dwordx4 v62, s[12:15], s81 offen offset:1024 lds
    s_add_u32 s81, s82, 14336
    buffer_load_dwordx4 v62, s[12:15], s81 offen offset:2048 lds
    s_add_u32 s81, s82, 21504
    buffer_load_dwordx4 v62, s[12:15], s81 offen offset:3072 lds
    s_add_u32 m0, s83, 4096
    s_add_u32 s81, s82, 32768
    buffer_load_dwordx4 v62, s[12:15], s81 offen offset:0 lds
    s_add_u32 s81, s82, 39936
    buffer_load_dwordx4 v62, s[12:15], s81 offen offset:1024 lds
    s_add_u32 s81, s82, 47104
    buffer_load_dwordx4 v62, s[12:15], s81 offen offset:2048 lds
    s_add_u32 s81, s82, 54272
    buffer_load_dwordx4 v62, s[12:15], s81 offen offset:3072 lds
    s_waitcnt lgkmcnt(0)
    s_barrier
    s_lshl_b32 s59, s45, 2
    s_add_u32 s59, s59, s50
    s_lshl_b32 s56, s50, 7
    s_add_u32 s56, s56, s66
    v_lshlrev_b32 v5, 2, v7
    s_mov_b32 s64, 30000
    buffer_load_dword v17, v5, s[36:39], s56 offen offset:1024 sc1
    v_and_b32 v12, 1, v1
    v_lshlrev_b32 v12, 10, v12
    v_sub_u32 v12, 158208, v12
    v_lshl_add_u32 v12, v9, 4, v12
    ds_read_b128 v[80:83], v12 offset:256
    ds_read_b128 v[84:87], v12 offset:320
    ds_read_b128 v[88:91], v12 offset:384
    v_add_u32 v12, 90240, v60
    v_add_u32 v13, 90240, v61
    ds_read_b64_tr_b16 a[48:49], v12 offset:0
    ds_read_b64_tr_b16 a[50:51], v12 offset:768
    ds_read_b64_tr_b16 a[52:53], v12 offset:3088
    ds_read_b64_tr_b16 a[54:55], v12 offset:3856
    ds_read_b64_tr_b16 a[56:57], v13 offset:0
    ds_read_b64_tr_b16 a[58:59], v13 offset:768
    ds_read_b64_tr_b16 a[60:61], v12 offset:12352
    ds_read_b64_tr_b16 a[62:63], v12 offset:13120
    ds_read_b64_tr_b16 a[64:65], v12 offset:15440
    ds_read_b64_tr_b16 a[66:67], v12 offset:16208
    ds_read_b64_tr_b16 a[68:69], v13 offset:12352
    ds_read_b64_tr_b16 a[70:71], v13 offset:13120
    ds_read_b64_tr_b16 a[72:73], v12 offset:24704
    ds_read_b64_tr_b16 a[74:75], v12 offset:25472
    ds_read_b64_tr_b16 a[76:77], v12 offset:27792
    ds_read_b64_tr_b16 a[78:79], v12 offset:28560
    ds_read_b64_tr_b16 a[80:81], v13 offset:24704
    ds_read_b64_tr_b16 a[82:83], v13 offset:25472
    s_waitcnt lgkmcnt(12)
    v_mfma_f32_16x16x32_bf16 v[116:119], v[80:83], a[48:51], v[116:119]
    v_mfma_f32_16x16x32_bf16 v[120:123], v[80:83], a[52:55], v[120:123]
    v_mfma_f32_16x16x32_bf16 v[124:127], v[80:83], a[56:59], v[124:127]
    s_waitcnt lgkmcnt(6)
    v_mfma_f32_16x16x32_bf16 v[116:119], v[84:87], a[60:63], v[116:119]
    v_mfma_f32_16x16x32_bf16 v[120:123], v[84:87], a[64:67], v[120:123]
    v_mfma_f32_16x16x32_bf16 v[124:127], v[84:87], a[68:71], v[124:127]
    s_waitcnt lgkmcnt(0)
    v_mfma_f32_16x16x32_bf16 v[116:119], v[88:91], a[72:75], v[116:119]
    v_mfma_f32_16x16x32_bf16 v[120:123], v[88:91], a[76:79], v[120:123]
    v_mfma_f32_16x16x32_bf16 v[124:127], v[88:91], a[80:83], v[124:127]
    s_and_b32 s62, s47, 1
    s_lshl_b32 s63, s62, 9
    v_lshl_add_u32 v6, v8, 9, v6
    v_add_u32 v31, s63, v6
    s_lshr_b32 s61, s47, 1
    s_lshl_b32 s58, s61, 15
    s_lshl_b32 s63, s62, 12
    s_add_u32 s58, s58, s63
    s_lshl_b32 s57, s59, 16
    s_add_u32 s57, s57, s58
    s_add_u32 s57, s57, 7340032
    s_lshl_b32 s60, s61, 15
    s_add_u32 s60, s60, 65536
    v_add_u32 v14, s60, v2
    s_lshl_b32 s60, s51, 1
    s_add_u32 s60, s60, s62
    s_xor_b32 s62, s60, s78
    s_lshl_b32 s62, s62, 6
    s_add_u32 s62, s62, 156160
    v_lshl_add_u32 v16, v8, 5, s62
    s_waitcnt vmcnt(0)
PP_49:
    v_cmp_ne_u32 vcc, s44, v17
    s_cbranch_vccnz PR_51
PC_50:
    s_barrier
    s_add_u32 m0, s58, 65536
    s_nop 0
    buffer_load_dwordx4 v2, s[36:39], s57 offen offset:0 sc1 lds
    ds_read_b64_tr_b16 v[128:129], v31 offset:0
    ds_read_b64_tr_b16 v[130:131], v31 offset:256
    ds_read_b64_tr_b16 v[132:133], v31 offset:8192
    ds_read_b64_tr_b16 v[134:135], v31 offset:8448
    buffer_load_dwordx4 v2, s[36:39], s57 offen offset:1024 sc1 lds
    ds_read_b64_tr_b16 v[136:137], v31 offset:2048
    ds_read_b64_tr_b16 v[138:139], v31 offset:2304
    ds_read_b64_tr_b16 v[140:141], v31 offset:10240
    ds_read_b64_tr_b16 v[142:143], v31 offset:10496
    buffer_load_dwordx4 v2, s[36:39], s57 offen offset:2048 sc1 lds
    ds_read_b64_tr_b16 v[144:145], v31 offset:4096
    ds_read_b64_tr_b16 v[146:147], v31 offset:4352
    ds_read_b64_tr_b16 v[148:149], v31 offset:12288
    ds_read_b64_tr_b16 v[150:151], v31 offset:12544
    buffer_load_dwordx4 v2, s[36:39], s57 offen offset:3072 sc1 lds
    s_add_u32 s57, s57, 8192
    ds_read_b64_tr_b16 v[152:153], v31 offset:6144
    ds_read_b64_tr_b16 v[154:155], v31 offset:6400
    ds_read_b64_tr_b16 v[156:157], v31 offset:14336
    ds_read_b64_tr_b16 v[158:159], v31 offset:14592
    s_add_u32 m0, s58, 73728
    s_nop 0
    buffer_load_dwordx4 v2, s[36:39], s57 offen offset:0 sc1 lds
    ds_read_b64_tr_b16 v[160:161], v31 offset:16384
    ds_read_b64_tr_b16 v[162:163], v31 offset:16640
    ds_read_b64_tr_b16 v[164:165], v31 offset:24576
    ds_read_b64_tr_b16 v[166:167], v31 offset:24832
    buffer_load_dwordx4 v2, s[36:39], s57 offen offset:1024 sc1 lds
    ds_read_b64_tr_b16 v[168:169], v31 offset:18432
    ds_read_b64_tr_b16 v[170:171], v31 offset:18688
    ds_read_b64_tr_b16 v[172:173], v31 offset:26624
    ds_read_b64_tr_b16 v[174:175], v31 offset:26880
    buffer_load_dwordx4 v2, s[36:39], s57 offen offset:2048 sc1 lds
    ds_read_b64_tr_b16 v[176:177], v31 offset:20480
    ds_read_b64_tr_b16 v[178:179], v31 offset:20736
    ds_read_b64_tr_b16 v[180:181], v31 offset:28672
    ds_read_b64_tr_b16 v[182:183], v31 offset:28928
    buffer_load_dwordx4 v2, s[36:39], s57 offen offset:3072 sc1 lds
    s_add_u32 s57, s57, 8192
    ds_read_b64_tr_b16 v[184:185], v31 offset:22528
    ds_read_b64_tr_b16 v[186:187], v31 offset:22784
    ds_read_b64_tr_b16 v[188:189], v31 offset:30720
    ds_read_b64_tr_b16 v[190:191], v31 offset:30976
    s_add_u32 m0, s58, 81920
    s_nop 0
    buffer_load_dwordx4 v2, s[36:39], s57 offen offset:0 sc1 lds
    ds_read_b64_tr_b16 v[192:193], v31 offset:32768
    ds_read_b64_tr_b16 v[194:195], v31 offset:33024
    ds_read_b64_tr_b16 v[196:197], v31 offset:40960
    ds_read_b64_tr_b16 v[198:199], v31 offset:41216
    buffer_load_dwordx4 v2, s[36:39], s57 offen offset:1024 sc1 lds
    ds_read_b64_tr_b16 v[200:201], v31 offset:34816
    ds_read_b64_tr_b16 v[202:203], v31 offset:35072
    ds_read_b64_tr_b16 v[204:205], v31 offset:43008
    ds_read_b64_tr_b16 v[206:207], v31 offset:43264
    buffer_load_dwordx4 v2, s[36:39], s57 offen offset:2048 sc1 lds
    ds_read_b64_tr_b16 v[208:209], v31 offset:36864
    ds_read_b64_tr_b16 v[210:211], v31 offset:37120
    ds_read_b64_tr_b16 v[212:213], v31 offset:45056
    ds_read_b64_tr_b16 v[214:215], v31 offset:45312
    buffer_load_dwordx4 v2, s[36:39], s57 offen offset:3072 sc1 lds
    s_add_u32 s57, s57, 8192
    ds_read_b64_tr_b16 v[216:217], v31 offset:38912
    ds_read_b64_tr_b16 v[218:219], v31 offset:39168
    ds_read_b64_tr_b16 v[220:221], v31 offset:47104
    ds_read_b64_tr_b16 v[222:223], v31 offset:47360
    s_add_u32 m0, s58, 90112
    s_nop 0
    buffer_load_dwordx4 v2, s[36:39], s57 offen offset:0 sc1 lds
    ds_read_b64_tr_b16 v[224:225], v31 offset:49152
    ds_read_b64_tr_b16 v[226:227], v31 offset:49408
    ds_read_b64_tr_b16 v[228:229], v31 offset:57344
    ds_read_b64_tr_b16 v[230:231], v31 offset:57600
    buffer_load_dwordx4 v2, s[36:39], s57 offen offset:1024 sc1 lds
    ds_read_b64_tr_b16 v[232:233], v31 offset:51200
    ds_read_b64_tr_b16 v[234:235], v31 offset:51456
    ds_read_b64_tr_b16 v[236:237], v31 offset:59392
    ds_read_b64_tr_b16 v[238:239], v31 offset:59648
    buffer_load_dwordx4 v2, s[36:39], s57 offen offset:2048 sc1 lds
    ds_read_b64_tr_b16 v[240:241], v31 offset:53248
    ds_read_b64_tr_b16 v[242:243], v31 offset:53504
    ds_read_b64_tr_b16 v[244:245], v31 offset:61440
    ds_read_b64_tr_b16 v[246:247], v31 offset:61696
    buffer_load_dwordx4 v2, s[36:39], s57 offen offset:3072 sc1 lds
    ds_read_b64_tr_b16 v[248:249], v31 offset:55296
    ds_read_b64_tr_b16 v[250:251], v31 offset:55552
    ds_read_b64_tr_b16 v[252:253], v31 offset:63488
    ds_read_b64_tr_b16 v[254:255], v31 offset:63744
    ds_read_b128 v[80:83], v16 offset:0
    ds_read_b128 v[84:87], v16 offset:16
    ds_read_b128 v[88:91], v16 offset:2048
    ds_read_b128 v[92:95], v16 offset:2064
    v_lshlrev_b32 v12, 7, v1
    s_mul_i32 s6, s2, 5632
    s_mul_i32 s7, s47, 1408
    s_add_u32 s6, s6, s7
    s_mov_b64 exec, 0x7ff
    buffer_load_dword v11, v12, s[24:27], s6 offen
    s_mov_b64 exec, -1
    s_cmp_eq_u32 s2, 0
    s_cselect_b32 s56, 0, 0x7fff0000
    s_mov_b64 exec, 1
    buffer_store_dword v3, off, s[36:39], s56 sc1
    s_mov_b64 exec, -1
    v_accvgpr_read_b32 v20, a192
    v_accvgpr_read_b32 v21, a193
    v_accvgpr_read_b32 v22, a194
    v_accvgpr_read_b32 v23, a195
    v_accvgpr_read_b32 v24, a196
    v_accvgpr_read_b32 v25, a197
    v_accvgpr_read_b32 v26, a198
    v_accvgpr_read_b32 v27, a199
    s_lshl_b32 s63, s59, 1
    s_add_u32 s61, s61, s63
    s_lshl_b32 s56, s61, 15
    s_lshl_b32 s63, s60, 10
    s_add_u32 s56, s56, s63
    s_add_u32 s56, s56, 2097152
    s_lshl_b32 s57, s61, 12
    s_lshl_b32 s63, s60, 8
    s_add_u32 s57, s57, s63
    s_add_u32 s57, s57, 524288
    s_and_b32 s61, s61, 7
    s_lshl_b32 s58, s61, 6
    s_lshl_b32 s63, s60, 2
    s_add_u32 s58, s58, s63
    s_add_u32 s58, s58, s66
    v_and_b32 v12, 1, v9
    v_lshlrev_b32 v12, 14, v12
    v_lshl_add_u32 v12, v8, 9, v12
    v_lshl_add_u32 v15, v10, 4, v12
    s_waitcnt vmcnt(14) lgkmcnt(0)
    s_barrier
    ds_read_b128 v[32:35], v14 offset:0
    s_waitcnt lgkmcnt(0)
    ds_read_b128 v[36:39], v14 offset:4096
    ds_read_b128 v[40:43], v14 offset:1024
    v_mfma_f32_32x32x16_bf16 v[64:79], v[128:131], v[32:35], 0
    s_add_u32 m0, s80, 131072
    s_add_u32 s81, s79, 616448
    s_waitcnt lgkmcnt(1)
    ds_read_b128 v[44:47], v14 offset:5120
    ds_read_b128 v[48:51], v14 offset:2048
    v_mfma_f32_32x32x16_bf16 v[64:79], v[132:135], v[36:39], v[64:79]
    s_waitcnt lgkmcnt(2)
    buffer_load_dwordx4 v28, s[52:55], s81 offen offset:0 lds
    ds_read_b128 v[52:55], v14 offset:6144
    v_lshlrev_b32 v128, 16, v20
    v_and_b32 v129, 0xffff0000, v20
    v_lshlrev_b32 v130, 16, v21
    v_and_b32 v131, 0xffff0000, v21
    v_mfma_f32_32x32x16_bf16 v[64:79], v[136:139], v[40:43], v[64:79]
    s_waitcnt lgkmcnt(1)
    buffer_load_dwordx4 v29, s[52:55], s81 offen offset:1024 lds
    ds_read_b128 v[32:35], v14 offset:3072
    v_lshlrev_b32 v132, 16, v22
    v_and_b32 v133, 0xffff0000, v22
    v_lshlrev_b32 v134, 16, v23
    v_and_b32 v135, 0xffff0000, v23
    v_mfma_f32_32x32x16_bf16 v[64:79], v[140:143], v[44:47], v[64:79]
    s_waitcnt lgkmcnt(1)
    ds_read_b128 v[36:39], v14 offset:7168
    v_lshlrev_b32 v136, 16, v24
    v_and_b32 v137, 0xffff0000, v24
    v_lshlrev_b32 v138, 16, v25
    v_and_b32 v139, 0xffff0000, v25
    v_mfma_f32_32x32x16_bf16 v[64:79], v[144:147], v[48:51], v[64:79]
    s_waitcnt vmcnt(12) lgkmcnt(1)
    s_barrier
    buffer_load_dwordx4 v30, s[52:55], s81 offen offset:2048 lds
    ds_read_b128 v[40:43], v14 offset:8192
    v_lshlrev_b32 v140, 16, v26
    v_and_b32 v141, 0xffff0000, v26
    v_lshlrev_b32 v142, 16, v27
    v_mfma_f32_32x32x16_bf16 v[64:79], v[148:151], v[52:55], v[64:79]
    s_add_u32 m0, s80, 143424
    s_add_u32 s81, s79, 704512
    s_waitcnt lgkmcnt(1)
    ds_read_b128 v[44:47], v14 offset:12288
    ds_read_b128 v[48:51], v14 offset:9216
    v_and_b32 v143, 0xffff0000, v27
    v_lshlrev_b32 v144, 16, v80
    v_mfma_f32_32x32x16_bf16 v[64:79], v[152:155], v[32:35], v[64:79]
    s_waitcnt lgkmcnt(2)
    buffer_load_dwordx4 v28, s[52:55], s81 offen offset:0 lds
    ds_read_b128 v[52:55], v14 offset:13312
    v_and_b32 v145, 0xffff0000, v80
    v_lshlrev_b32 v146, 16, v81
    v_and_b32 v147, 0xffff0000, v81
    v_lshlrev_b32 v148, 16, v82
    v_mfma_f32_32x32x16_bf16 v[64:79], v[156:159], v[36:39], v[64:79]
    s_waitcnt lgkmcnt(2)
    ds_read_b128 v[32:35], v14 offset:10240
    ds_read_b128 v[36:39], v14 offset:14336
    v_and_b32 v149, 0xffff0000, v82
    v_lshlrev_b32 v150, 16, v83
    v_and_b32 v151, 0xffff0000, v83
    v_lshlrev_b32 v152, 16, v84
    v_mfma_f32_32x32x16_bf16 v[64:79], v[160:163], v[40:43], v[64:79]
    s_waitcnt lgkmcnt(3)
    buffer_load_dwordx4 v29, s[52:55], s81 offen offset:1024 lds
    ds_read_b128 v[40:43], v14 offset:11264
    v_and_b32 v153, 0xffff0000, v84
    v_lshlrev_b32 v154, 16, v85
    v_and_b32 v155, 0xffff0000, v85
    v_lshlrev_b32 v156, 16, v86
    v_mfma_f32_32x32x16_bf16 v[64:79], v[164:167], v[44:47], v[64:79]
    s_waitcnt lgkmcnt(3)
    ds_read_b128 v[44:47], v14 offset:15360
    v_and_b32 v157, 0xffff0000, v86
    v_lshlrev_b32 v158, 16, v87
    v_and_b32 v159, 0xffff0000, v87
    v_lshlrev_b32 v160, 16, v88
    v_and_b32 v161, 0xffff0000, v88
    v_mfma_f32_32x32x16_bf16 v[64:79], v[168:171], v[48:51], v[64:79]
    s_waitcnt lgkmcnt(3)
    buffer_load_dwordx4 v30, s[52:55], s81 offen offset:2048 lds
    v_lshlrev_b32 v162, 16, v89
    v_and_b32 v163, 0xffff0000, v89
    v_lshlrev_b32 v164, 16, v90
    v_and_b32 v165, 0xffff0000, v90
    v_lshlrev_b32 v166, 16, v91
    v_mfma_f32_32x32x16_bf16 v[64:79], v[172:175], v[52:55], v[64:79]
    s_add_u32 m0, s80, 0
    s_add_u32 s81, s79, 792576
    s_waitcnt lgkmcnt(2)
    v_and_b32 v167, 0xffff0000, v91
    v_lshlrev_b32 v168, 16, v92
    v_and_b32 v169, 0xffff0000, v92
    v_lshlrev_b32 v170, 16, v93
    v_mfma_f32_32x32x16_bf16 v[64:79], v[176:179], v[32:35], v[64:79]
    s_waitcnt vmcnt(12) lgkmcnt(1)
    s_barrier
    buffer_load_dwordx4 v28, s[52:55], s81 offen offset:0 lds
    ds_read_b128 v[48:51], v14 offset:16384
    v_and_b32 v171, 0xffff0000, v93
    v_lshlrev_b32 v172, 16, v94
    v_and_b32 v173, 0xffff0000, v94
    v_mfma_f32_32x32x16_bf16 v[64:79], v[180:183], v[36:39], v[64:79]
    s_waitcnt lgkmcnt(1)
    ds_read_b128 v[52:55], v14 offset:20480
    ds_read_b128 v[32:35], v14 offset:17408
    v_lshlrev_b32 v174, 16, v95
    v_and_b32 v175, 0xffff0000, v95
    v_mfma_f32_32x32x16_bf16 v[64:79], v[184:187], v[40:43], v[64:79]
    s_waitcnt lgkmcnt(2)
    buffer_load_dwordx4 v29, s[52:55], s81 offen offset:1024 lds
    ds_read_b128 v[36:39], v14 offset:21504
    v_mfma_f32_32x32x16_bf16 v[64:79], v[188:191], v[44:47], v[64:79]
    s_waitcnt lgkmcnt(2)
    ds_read_b128 v[40:43], v14 offset:18432
    ds_read_b128 v[44:47], v14 offset:22528
    v_mfma_f32_32x32x16_bf16 v[64:79], v[192:195], v[48:51], v[64:79]
    s_waitcnt lgkmcnt(3)
    buffer_load_dwordx4 v30, s[52:55], s81 offen offset:2048 lds
    ds_read_b128 v[48:51], v14 offset:19456
    v_mfma_f32_32x32x16_bf16 v[64:79], v[196:199], v[52:55], v[64:79]
    s_add_u32 m0, s80, 12352
    s_add_u32 s81, s79, 880640
    s_waitcnt lgkmcnt(3)
    ds_read_b128 v[52:55], v14 offset:23552
    v_mfma_f32_32x32x16_bf16 v[64:79], v[200:203], v[32:35], v[64:79]
    s_waitcnt lgkmcnt(3)
    buffer_load_dwordx4 v28, s[52:55], s81 offen offset:0 lds
    v_mfma_f32_32x32x16_bf16 v[64:79], v[204:207], v[36:39], v[64:79]
    s_waitcnt lgkmcnt(2)
    v_mfma_f32_32x32x16_bf16 v[64:79], v[208:211], v[40:43], v[64:79]
    s_waitcnt vmcnt(12) lgkmcnt(1)
    s_barrier
    buffer_load_dwordx4 v29, s[52:55], s81 offen offset:1024 lds
    ds_read_b128 v[32:35], v14 offset:24576
    v_mfma_f32_32x32x16_bf16 v[64:79], v[212:215], v[44:47], v[64:79]
    s_waitcnt lgkmcnt(1)
    ds_read_b128 v[36:39], v14 offset:28672
    ds_read_b128 v[40:43], v14 offset:25600
    v_mfma_f32_32x32x16_bf16 v[64:79], v[216:219], v[48:51], v[64:79]
    s_waitcnt lgkmcnt(2)
    buffer_load_dwordx4 v30, s[52:55], s81 offen offset:2048 lds
    ds_read_b128 v[44:47], v14 offset:29696
    v_mfma_f32_32x32x16_bf16 v[64:79], v[220:223], v[52:55], v[64:79]
    s_waitcnt lgkmcnt(2)
    ds_read_b128 v[48:51], v14 offset:26624
    ds_read_b128 v[52:55], v14 offset:30720
    v_mfma_f32_32x32x16_bf16 v[64:79], v[224:227], v[32:35], v[64:79]
    s_waitcnt lgkmcnt(3)
    ds_read_b128 v[32:35], v14 offset:27648
    v_mfma_f32_32x32x16_bf16 v[64:79], v[228:231], v[36:39], v[64:79]
    s_waitcnt lgkmcnt(3)
    ds_read_b128 v[36:39], v14 offset:31744
    v_mfma_f32_32x32x16_bf16 v[64:79], v[232:235], v[40:43], v[64:79]
    s_waitcnt lgkmcnt(3)
    v_mfma_f32_32x32x16_bf16 v[64:79], v[236:239], v[44:47], v[64:79]
    s_waitcnt lgkmcnt(2)
    v_mfma_f32_32x32x16_bf16 v[64:79], v[240:243], v[48:51], v[64:79]
    s_waitcnt lgkmcnt(1)
    v_mfma_f32_32x32x16_bf16 v[64:79], v[244:247], v[52:55], v[64:79]
    s_waitcnt lgkmcnt(0)
    s_barrier
    v_mfma_f32_32x32x16_bf16 v[64:79], v[248:251], v[32:35], v[64:79]
    v_mfma_f32_32x32x16_bf16 v[64:79], v[252:255], v[36:39], v[64:79]
    s_nop 11
    v_pk_fma_f32 v[64:65], v[64:65], v[144:145], v[128:129]
    v_pk_fma_f32 v[66:67], v[66:67], v[146:147], v[130:131]
    v_pk_fma_f32 v[68:69], v[68:69], v[148:149], v[132:133]
    v_pk_fma_f32 v[70:71], v[70:71], v[150:151], v[134:135]
    v_pk_fma_f32 v[72:73], v[72:73], v[152:153], v[136:137]
    v_pk_fma_f32 v[74:75], v[74:75], v[154:155], v[138:139]
    v_pk_fma_f32 v[76:77], v[76:77], v[156:157], v[140:141]
    v_pk_fma_f32 v[78:79], v[78:79], v[158:159], v[142:143]
    v_pk_mul_f32 v[160:161], v[64:65], v[160:161]
    v_pk_mul_f32 v[162:163], v[66:67], v[162:163]
    v_pk_mul_f32 v[164:165], v[68:69], v[164:165]
    v_pk_mul_f32 v[166:167], v[70:71], v[166:167]
    v_cvt_pk_bf16_f32 v32, v160, v161
    v_cvt_pk_bf16_f32 v33, v162, v163
    v_cvt_pk_bf16_f32 v34, v164, v165
    v_cvt_pk_bf16_f32 v35, v166, v167
    buffer_store_dwordx4 v[32:35], v15, s[36:39], s56 offen offset:0 sc1
    v_pk_mul_f32 v[168:169], v[72:73], v[168:169]
    v_pk_mul_f32 v[170:171], v[74:75], v[170:171]
    v_pk_mul_f32 v[172:173], v[76:77], v[172:173]
    v_pk_mul_f32 v[174:175], v[78:79], v[174:175]
    v_cvt_pk_bf16_f32 v36, v168, v169
    v_cvt_pk_bf16_f32 v37, v170, v171
    v_cvt_pk_bf16_f32 v38, v172, v173
    v_cvt_pk_bf16_f32 v39, v174, v175
    buffer_store_dwordx4 v[36:39], v15, s[36:39], s56 offen offset:256 sc1
    v_pk_add_f32 v[16:17], v[64:65], v[66:67]
    v_pk_mul_f32 v[18:19], v[64:65], v[64:65]
    v_pk_fma_f32 v[18:19], v[66:67], v[66:67], v[18:19]
    v_pk_add_f32 v[16:17], v[16:17], v[68:69]
    v_pk_fma_f32 v[18:19], v[68:69], v[68:69], v[18:19]
    v_pk_add_f32 v[16:17], v[16:17], v[70:71]
    v_pk_fma_f32 v[18:19], v[70:71], v[70:71], v[18:19]
    v_pk_add_f32 v[16:17], v[16:17], v[72:73]
    v_pk_fma_f32 v[18:19], v[72:73], v[72:73], v[18:19]
    v_pk_add_f32 v[16:17], v[16:17], v[74:75]
    v_pk_fma_f32 v[18:19], v[74:75], v[74:75], v[18:19]
    v_pk_add_f32 v[16:17], v[16:17], v[76:77]
    v_pk_fma_f32 v[18:19], v[76:77], v[76:77], v[18:19]
    v_pk_add_f32 v[16:17], v[16:17], v[78:79]
    v_pk_fma_f32 v[18:19], v[78:79], v[78:79], v[18:19]
    v_add_f32 v16, v16, v17
    v_add_f32 v18, v18, v19
    s_nop 1
    v_permlane32_swap_b32 v16, v18
    v_add_f32 v16, v16, v18
    buffer_store_dword v16, v4, s[36:39], s57 offen sc1
    s_add_u32 m0, s80, 24704
    s_add_u32 s81, s79, 968704
    buffer_load_dwordx4 v28, s[52:55], s81 offen offset:0 lds
    buffer_load_dwordx4 v29, s[52:55], s81 offen offset:1024 lds
    buffer_load_dwordx4 v30, s[52:55], s81 offen offset:2048 lds
    s_add_u32 m0, s80, 37056
    s_add_u32 s81, s79, 1056768
    buffer_load_dwordx4 v28, s[52:55], s81 offen offset:0 lds
    buffer_load_dwordx4 v29, s[52:55], s81 offen offset:1024 lds
    buffer_load_dwordx4 v30, s[52:55], s81 offen offset:2048 lds
    s_waitcnt vmcnt(6)
    s_mov_b64 exec, 1
    buffer_store_dword v3, off, s[36:39], s58 offset:1536 sc1
    s_mov_b64 exec, -1
    s_barrier
    s_add_u32 m0, s80, 49408
    s_add_u32 s81, s79, 1144832
    buffer_load_dwordx4 v28, s[52:55], s81 offen offset:0 lds
    v_and_b32 v12, 1, v1
    v_lshlrev_b32 v12, 10, v12
    v_sub_u32 v12, 158208, v12
    v_lshl_add_u32 v12, v9, 4, v12
    ds_read_b128 v[80:83], v12 offset:448
    ds_read_b128 v[84:87], v12 offset:512
    buffer_load_dwordx4 v29, s[52:55], s81 offen offset:1024 lds
    ds_read_b128 v[88:91], v12 offset:576
    ds_read_b128 v[92:95], v12 offset:640
    v_add_u32 v12, 131072, v60
    v_add_u32 v13, 131072, v61
    ds_read_b64_tr_b16 a[84:85], v12 offset:0
    ds_read_b64_tr_b16 a[86:87], v12 offset:768
    buffer_load_dwordx4 v30, s[52:55], s81 offen offset:2048 lds
    ds_read_b64_tr_b16 a[88:89], v12 offset:3088
    ds_read_b64_tr_b16 a[90:91], v12 offset:3856
    ds_read_b64_tr_b16 a[92:93], v13 offset:0
    ds_read_b64_tr_b16 a[94:95], v13 offset:768
    ds_read_b64_tr_b16 a[96:97], v12 offset:12352
    ds_read_b64_tr_b16 a[98:99], v12 offset:13120
    s_add_u32 m0, s80, 98304
    s_add_u32 s81, s79, 1232896
    buffer_load_dwordx4 v28, s[52:55], s81 offen offset:0 lds
    ds_read_b64_tr_b16 a[100:101], v12 offset:15440
    ds_read_b64_tr_b16 a[102:103], v12 offset:16208
    ds_read_b64_tr_b16 a[104:105], v13 offset:12352
    ds_read_b64_tr_b16 a[106:107], v13 offset:13120
    v_add_u32 v12, 0, v60
    v_add_u32 v13, 0, v61
    buffer_load_dwordx4 v29, s[52:55], s81 offen offset:1024 lds
    ds_read_b64_tr_b16 a[108:109], v12 offset:0
    ds_read_b64_tr_b16 a[110:111], v12 offset:768
    ds_read_b64_tr_b16 a[112:113], v12 offset:3088
    ds_read_b64_tr_b16 a[114:115], v12 offset:3856
    ds_read_b64_tr_b16 a[116:117], v13 offset:0
    ds_read_b64_tr_b16 a[118:119], v13 offset:768
    buffer_load_dwordx4 v30, s[52:55], s81 offen offset:2048 lds
    s_waitcnt lgkmcnt(12)
    v_mfma_f32_16x16x32_bf16 v[116:119], v[80:83], a[84:87], v[116:119]
    v_mfma_f32_16x16x32_bf16 v[120:123], v[80:83], a[88:91], v[120:123]
    v_mfma_f32_16x16x32_bf16 v[124:127], v[80:83], a[92:95], v[124:127]
    ds_read_b64_tr_b16 a[120:121], v12 offset:12352
    ds_read_b64_tr_b16 a[122:123], v12 offset:13120
    ds_read_b64_tr_b16 a[124:125], v12 offset:15440
    s_add_u32 m0, s80, 110656
    s_add_u32 s81, s79, 1320960
    buffer_load_dwordx4 v28, s[52:55], s81 offen offset:0 lds
    ds_read_b64_tr_b16 a[126:127], v12 offset:16208
    ds_read_b64_tr_b16 a[128:129], v13 offset:12352
    ds_read_b64_tr_b16 a[130:131], v13 offset:13120
    s_waitcnt lgkmcnt(12)
    v_mfma_f32_16x16x32_bf16 v[116:119], v[84:87], a[96:99], v[116:119]
    v_mfma_f32_16x16x32_bf16 v[120:123], v[84:87], a[100:103], v[120:123]
    v_mfma_f32_16x16x32_bf16 v[124:127], v[84:87], a[104:107], v[124:127]
    buffer_load_dwordx4 v29, s[52:55], s81 offen offset:1024 lds
    s_waitcnt lgkmcnt(6)
    v_mfma_f32_16x16x32_bf16 v[116:119], v[88:91], a[108:111], v[116:119]
    v_mfma_f32_16x16x32_bf16 v[120:123], v[88:91], a[112:115], v[120:123]
    v_mfma_f32_16x16x32_bf16 v[124:127], v[88:91], a[116:119], v[124:127]
    s_waitcnt lgkmcnt(0)
    v_mfma_f32_16x16x32_bf16 v[116:119], v[92:95], a[120:123], v[116:119]
    v_mfma_f32_16x16x32_bf16 v[120:123], v[92:95], a[124:127], v[120:123]
    v_mfma_f32_16x16x32_bf16 v[124:127], v[92:95], a[128:131], v[124:127]
    buffer_load_dwordx4 v30, s[52:55], s81 offen offset:2048 lds
    s_lshl_b32 s56, s48, 8
    s_add_u32 s56, s56, s66
    s_lshl_b32 s60, s45, 1
    s_add_u32 s60, s60, s48
    s_and_b32 s61, s49, 1
    s_lshl_b32 s57, s61, 1
    s_xor_b32 s57, s57, s47
    s_lshl_b32 s57, s57, 12
    s_lshl_b32 s63, s60, 14
    s_add_u32 s57, s57, s63
    s_add_u32 s57, s57, 524288
    s_lshl_b32 s82, s60, 17
    s_lshl_b32 s63, s61, 16
    s_add_u32 s82, s82, s63
    s_add_u32 s82, s82, s83
    s_add_u32 s82, s82, 2097152
    s_lshl_b32 s63, s78, 10
    s_xor_b32 s82, s82, s63
    s_mov_b32 s64, 30000
    buffer_load_dword v17, v4, s[36:39], s56 offen offset:1536 sc1
    v_add_u32 v18, 65536, v2
    v_add_u32 v25, 4096, v2
    v_add_u32 v26, 8192, v2
    v_lshlrev_b32 v14, 4, v10
    v_add_u32 v19, 160256, v14
    v_lshlrev_b32 v20, 3, v10
    v_add_u32 v20, 162304, v20
    v_lshl_add_u32 v21, v8, 7, v20
    v_lshl_add_u32 v14, v8, 8, v14
    v_and_b32 v15, 1, v9
    s_lshr_b32 s4, s49, 1
    s_lshr_b32 s5, s47, 1
    s_and_b32 s6, s47, 1
    s_lshl_b32 s7, s4, 4
    s_lshl_b32 s63, s47, 2
    s_add_u32 s7, s7, s63
    v_min_u32 v16, 1, v1
    v_lshl_add_u32 v24, v16, 30, s7
    s_mul_i32 s4, s4, 6
    s_mul_i32 s63, s5, 3
    s_add_u32 s4, s4, s63
    s_lshl1_add_u32 s5, s6, s4
    s_and_b32 s7, s5, 3
    s_lshr_b32 s5, s5, 2
    s_lshl_b32 s5, s5, 10
    s_mul_i32 s63, s7, 12288
    s_add_u32 s5, s5, s63
    v_lshl_add_u32 v16, v15, 9, v14
    v_add_u32 v22, s5, v16
    s_add_u32 s5, s4, 1
    s_and_b32 s7, s5, 3
    s_lshr_b32 s5, s5, 2
    s_lshl_b32 s5, s5, 10
    s_mul_i32 s63, s7, 12288
    s_add_u32 s5, s5, s63
    s_lshl_b32 s63, s6, 9
    s_add_u32 s5, s5, s63
    v_lshl_add_u32 v16, v15, 30, v14
    v_add_u32 v23, s5, v16
    s_lshl_b32 s4, s60, 1
    s_add_u32 s4, s4, s61
    s_xor_b32 s5, s4, 1
    s_mul_i32 s16, s4, 98304
    s_add_u32 s16, s16, 4194304
    s_add_u32 s17, s16, 49152
    s_lshl_b32 s18, s5, 16
    s_add_u32 s18, s18, 7340032
    s_add_u32 s19, s18, 4289724416
    s_and_b32 s4, s4, 3
    s_lshl_b32 s20, s4, 9
    s_add_u32 s20, s20, s66
    s_xor_b32 s21, s20, 512
    s_lshl_b32 s22, s50, 9
    s_add_u32 s22, s22, s66
    s_mul_i32 s4, s47, 12288
    s_mul_i32 s8, s59, 98304
    s_add_u32 s8, s8, s4
    s_add_u32 s8, s8, 4194304
    s_add_u32 s9, s8, 49152
    s_lshl_b32 s10, s59, 16
    s_add_u32 s10, s10, s4
    s_add_u32 s10, s10, 7340032
    s_add_u32 s11, s10, 4289724416
    s_andn2_b32 s13, s22, 512
    v_lshl_add_u32 v58, v8, 9, v5
    s_mul_i32 s12, s47, 14336
    s_add_u32 s12, s12, 98304
    v_add_u32 v56, s12, v6
    s_lshl_b32 s4, s51, 7
    v_add_u32 v62, s4, v62
    v_add_u32 v0, 7168, v62
    s_and_b32 s4, s50, 1
    s_mul_i32 s4, s4, 98304
    s_lshr_b32 s5, s47, 1
    s_lshl_b32 s68, s47, 14
    s_add_u32 s68, s68, s4
    s_mul_i32 s69, s5, 98304
    s_add_u32 s69, s69, s68
    s_lshl_b32 s4, s4, 1
    s_sub_u32 s4, 98304, s4
    s_add_u32 s70, s68, s4
    s_add_u32 s71, s69, s4
    s_waitcnt vmcnt(0)
PP_52:
    v_cmp_ne_u32 vcc, s44, v17
    s_cbranch_vccnz PR_54
PC_53:
    s_barrier
    buffer_load_dwordx4 v[96:99], v2, s[36:39], s57 offen offset:0 sc1
    buffer_load_dwordx4 v[100:103], v2, s[36:39], s57 offen offset:1024 sc1
    buffer_load_dwordx4 v[104:107], v2, s[36:39], s57 offen offset:2048 sc1
    buffer_load_dwordx4 v[108:111], v2, s[36:39], s57 offen offset:3072 sc1
    s_add_u32 m0, s83, 65536
    s_xor_b32 s23, s82, 0
    buffer_load_dwordx4 v2, s[36:39], s23 offen offset:0 sc1 lds
    v_and_b32 v12, 1, v1
    v_lshlrev_b32 v12, 10, v12
    v_sub_u32 v12, 158208, v12
    v_lshl_add_u32 v12, v9, 4, v12
    ds_read_b128 v[128:131], v12 offset:704
    ds_read_b128 v[132:135], v12 offset:768
    ds_read_b128 v[136:139], v12 offset:832
    buffer_load_dwordx4 v2, s[36:39], s23 offen offset:1024 sc1 lds
    ds_read_b128 v[140:143], v12 offset:896
    ds_read_b128 v[144:147], v12 offset:960
    v_add_u32 v12, 24704, v60
    v_add_u32 v13, 24704, v61
    ds_read_b64_tr_b16 a[132:133], v12 offset:0
    ds_read_b64_tr_b16 a[134:135], v12 offset:768
    ds_read_b64_tr_b16 a[136:137], v12 offset:3088
    buffer_load_dwordx4 v2, s[36:39], s23 offen offset:2048 sc1 lds
    ds_read_b64_tr_b16 a[138:139], v12 offset:3856
    ds_read_b64_tr_b16 a[140:141], v13 offset:0
    ds_read_b64_tr_b16 a[142:143], v13 offset:768
    ds_read_b64_tr_b16 a[144:145], v12 offset:12352
    ds_read_b64_tr_b16 a[146:147], v12 offset:13120
    ds_read_b64_tr_b16 a[148:149], v12 offset:15440
    ds_read_b64_tr_b16 a[150:151], v12 offset:16208
    buffer_load_dwordx4 v2, s[36:39], s23 offen offset:3072 sc1 lds
    ds_read_b64_tr_b16 a[152:153], v13 offset:12352
    ds_read_b64_tr_b16 a[154:155], v13 offset:13120
    ds_read_b64_tr_b16 a[156:157], v12 offset:24704
    ds_read_b64_tr_b16 a[158:159], v12 offset:25472
    ds_read_b64_tr_b16 a[160:161], v12 offset:27792
    ds_read_b64_tr_b16 a[162:163], v12 offset:28560
    ds_read_b64_tr_b16 a[164:165], v13 offset:24704
    s_add_u32 m0, s83, 69632
    s_xor_b32 s23, s82, 4096
    buffer_load_dwordx4 v2, s[36:39], s23 offen offset:0 sc1 lds
    ds_read_b64_tr_b16 a[166:167], v13 offset:25472
    s_waitcnt lgkmcnt(12)
    v_mfma_f32_16x16x32_bf16 v[116:119], v[128:131], a[132:135], v[116:119]
    v_mfma_f32_16x16x32_bf16 v[120:123], v[128:131], a[136:139], v[120:123]
    v_mfma_f32_16x16x32_bf16 v[124:127], v[128:131], a[140:143], v[124:127]
    v_add_u32 v12, 98304, v60
    v_add_u32 v13, 98304, v61
    ds_read_b64_tr_b16 a[168:169], v12 offset:0
    buffer_load_dwordx4 v2, s[36:39], s23 offen offset:1024 sc1 lds
    ds_read_b64_tr_b16 a[170:171], v12 offset:768
    ds_read_b64_tr_b16 a[172:173], v12 offset:3088
    ds_read_b64_tr_b16 a[174:175], v12 offset:3856
    ds_read_b64_tr_b16 a[176:177], v13 offset:0
    ds_read_b64_tr_b16 a[178:179], v13 offset:768
    s_waitcnt lgkmcnt(12)
    v_mfma_f32_16x16x32_bf16 v[116:119], v[132:135], a[144:147], v[116:119]
    v_mfma_f32_16x16x32_bf16 v[120:123], v[132:135], a[148:151], v[120:123]
    buffer_load_dwordx4 v2, s[36:39], s23 offen offset:2048 sc1 lds
    v_mfma_f32_16x16x32_bf16 v[124:127], v[132:135], a[152:155], v[124:127]
    ds_read_b64_tr_b16 a[180:181], v12 offset:12352
    ds_read_b64_tr_b16 a[182:183], v12 offset:13120
    ds_read_b64_tr_b16 a[184:185], v12 offset:15440
    ds_read_b64_tr_b16 a[186:187], v12 offset:16208
    ds_read_b64_tr_b16 a[188:189], v13 offset:12352
    ds_read_b64_tr_b16 a[190:191], v13 offset:13120
    buffer_load_dwordx4 v2, s[36:39], s23 offen offset:3072 sc1 lds
    s_waitcnt lgkmcnt(12)
    v_mfma_f32_16x16x32_bf16 v[116:119], v[136:139], a[156:159], v[116:119]
    v_mfma_f32_16x16x32_bf16 v[120:123], v[136:139], a[160:163], v[120:123]
    v_mfma_f32_16x16x32_bf16 v[124:127], v[136:139], a[164:167], v[124:127]
    s_waitcnt lgkmcnt(6)
    v_mfma_f32_16x16x32_bf16 v[116:119], v[140:143], a[168:171], v[116:119]
    v_mfma_f32_16x16x32_bf16 v[120:123], v[140:143], a[172:175], v[120:123]
    v_mfma_f32_16x16x32_bf16 v[124:127], v[140:143], a[176:179], v[124:127]
    s_waitcnt lgkmcnt(0)
    v_mfma_f32_16x16x32_bf16 v[116:119], v[144:147], a[180:183], v[116:119]
    v_mfma_f32_16x16x32_bf16 v[120:123], v[144:147], a[184:187], v[120:123]
    v_mfma_f32_16x16x32_bf16 v[124:127], v[144:147], a[188:191], v[124:127]
    s_waitcnt vmcnt(8)
    s_barrier
    s_add_u32 m0, s83, 0
    s_xor_b32 s23, s82, 32768
    buffer_load_dwordx4 v2, s[36:39], s23 offen offset:0 sc1 lds
    v_pk_add_f32 v[96:97], v[96:97], v[100:101]
    v_pk_add_f32 v[98:99], v[98:99], v[102:103]
    v_pk_add_f32 v[104:105], v[104:105], v[108:109]
    v_pk_add_f32 v[106:107], v[106:107], v[110:111]
    v_pk_add_f32 v[96:97], v[96:97], v[104:105]
    v_pk_add_f32 v[98:99], v[98:99], v[106:107]
    buffer_load_dwordx4 v2, s[36:39], s23 offen offset:1024 sc1 lds
    s_nop 0
    v_permlane32_swap_b32 v96, v98
    v_permlane32_swap_b32 v97, v99
    v_add_f32 v96, v96, v98
    v_add_f32 v97, v97, v99
    s_nop 1
    v_permlane16_swap_b32 v96, v97
    v_add_f32 v96, v96, v97
    buffer_load_dwordx4 v2, s[36:39], s23 offen offset:2048 sc1 lds
    v_mul_f32 v96, 0x3b000000, v96
    s_nop 1
    v_mov_b32_dpp v97, v96 row_ror:8 row_mask:0xf bank_mask:0xf
    v_fma_f32 v97, -v96, v96, v97
    v_max_f32 v97, 0, v97
    v_add_f32 v97, 0x3727c5ac, v97
    v_rsq_f32 v98, v97
    buffer_load_dwordx4 v2, s[36:39], s23 offen offset:3072 sc1 lds
    v_sub_f32 v96, 0, v96
    v_mul_f32 v97, v97, v98
    v_cvt_pk_bf16_f32 v100, v96, v96
    v_cvt_pk_bf16_f32 v104, v97, v97
    v_and_b32 v105, 0xffff0000, v100
    v_and_b32 v104, 0xffff0000, v104
    s_add_u32 m0, s83, 4096
    s_xor_b32 s23, s82, 36864
    buffer_load_dwordx4 v2, s[36:39], s23 offen offset:0 sc1 lds
    v_sub_f32 v96, v96, v105
    v_sub_f32 v97, v97, v104
    v_cvt_pk_bf16_f32 v101, v96, v104
    v_cvt_pk_bf16_f32 v102, v104, v97
    v_mov_b32 v103, 0
    v_mul_f32 v99, v98, v98
    buffer_load_dwordx4 v2, s[36:39], s23 offen offset:1024 sc1 lds
    v_mul_f32 v104, 0xc0135761, v98
    v_mul_f32 v105, 0xbdd2d3e8, v98
    v_mul_f32 v105, v105, v99
    v_and_b32 v14, 7, v1
    v_lshl_add_u32 v14, v14, 2, v9
    s_lshl_b32 s56, s47, 5
    buffer_load_dwordx4 v2, s[36:39], s23 offen offset:2048 sc1 lds
    v_add_u32 v14, s56, v14
    v_lshlrev_b32 v15, 4, v14
    v_add_u32 v15, 160256, v15
    v_lshlrev_b32 v16, 3, v14
    v_add_u32 v16, 162304, v16
    v_lshlrev_b32 v17, 2, v14
    buffer_load_dwordx4 v2, s[36:39], s23 offen offset:3072 sc1 lds
    v_add_u32 v17, 163328, v17
    s_mov_b32 exec_lo, 0x00ff00ff
    s_mov_b32 exec_hi, 0x00ff00ff
    ds_write_b128 v15, v[100:103]
    ds_write_b64 v16, v[104:105]
    ds_write_b32 v17, v99
    s_mov_b64 exec, -1
    s_mov_b32 s64, 30000
    v_cmp_gt_u32 vcc, 16, v1
    s_waitcnt vmcnt(8) lgkmcnt(0)
    s_barrier
    ds_read_b128 v[92:95], v18 offset:0
    s_waitcnt lgkmcnt(0)
    ds_read_b128 v[96:99], v18 offset:1024
    ds_read_b128 v[100:103], v18 offset:2048
    ds_read_b128 v[104:107], v18 offset:3072
    v_mfma_f32_16x16x32_bf16 v[80:83], a[0:3], v[92:95], 0
    ds_read_b128 v[108:111], v18 offset:4096
    ds_read_b128 v[112:115], v18 offset:5120
    v_mfma_f32_16x16x32_bf16 v[84:87], a[4:7], v[92:95], 0
    v_cndmask_b32 v116, 0, v116, vcc
    v_cndmask_b32 v117, 0, v117, vcc
    v_mfma_f32_16x16x32_bf16 v[88:91], a[8:11], v[92:95], 0
    s_waitcnt lgkmcnt(4)
    ds_read_b128 v[92:95], v18 offset:6144
    v_cvt_pk_bf16_f32 v45, v116, v117
    v_mfma_f32_16x16x32_bf16 v[80:83], a[12:15], v[96:99], v[80:83]
    v_lshlrev_b32 v118, 16, v45
    v_and_b32 v119, 0xffff0000, v45
    v_mfma_f32_16x16x32_bf16 v[84:87], a[16:19], v[96:99], v[84:87]
    v_sub_f32 v116, v116, v118
    v_sub_f32 v117, v117, v119
    v_mfma_f32_16x16x32_bf16 v[88:91], a[20:23], v[96:99], v[88:91]
    s_add_u32 m0, s12, 0
    s_waitcnt lgkmcnt(4)
    ds_read_b128 v[96:99], v18 offset:7168
    v_cvt_pk_bf16_f32 v44, v118, v116
    v_mfma_f32_16x16x32_bf16 v[80:83], a[24:27], v[100:103], v[80:83]
    s_add_u32 s14, s68, 0
    v_cvt_pk_bf16_f32 v46, v117, v119
    v_mov_b32 v47, 0
    v_mfma_f32_16x16x32_bf16 v[84:87], a[28:31], v[100:103], v[84:87]
    v_cndmask_b32 v120, 0, v120, vcc
    v_cndmask_b32 v121, 0, v121, vcc
    v_mfma_f32_16x16x32_bf16 v[88:91], a[32:35], v[100:103], v[88:91]
    s_waitcnt lgkmcnt(4)
    buffer_load_dwordx4 v62, s[24:27], s14 offen offset:0 lds
    ds_read_b128 v[100:103], v18 offset:8192
    v_mfma_f32_16x16x32_bf16 v[80:83], a[36:39], v[104:107], v[80:83]
    v_cvt_pk_bf16_f32 v49, v120, v121
    v_lshlrev_b32 v122, 16, v49
    v_mfma_f32_16x16x32_bf16 v[84:87], a[40:43], v[104:107], v[84:87]
    s_waitcnt lgkmcnt(4)
    v_and_b32 v123, 0xffff0000, v49
    v_sub_f32 v120, v120, v122
    v_mfma_f32_16x16x32_bf16 v[88:91], a[44:47], v[104:107], v[88:91]
    ds_read_b128 v[104:107], v18 offset:9216
    v_sub_f32 v121, v121, v123
    v_mfma_f32_16x16x32_bf16 v[80:83], a[48:51], v[108:111], v[80:83]
    v_cvt_pk_bf16_f32 v48, v122, v120
    v_cvt_pk_bf16_f32 v50, v121, v123
    v_mfma_f32_16x16x32_bf16 v[84:87], a[52:55], v[108:111], v[84:87]
    s_waitcnt lgkmcnt(4)
    v_mov_b32 v51, 0
    v_cndmask_b32 v124, 0, v124, vcc
    v_mfma_f32_16x16x32_bf16 v[88:91], a[56:59], v[108:111], v[88:91]
    buffer_load_dwordx4 v0, s[24:27], s14 offen offset:1024 lds
    ds_read_b128 v[108:111], v18 offset:10240
    v_mfma_f32_16x16x32_bf16 v[80:83], a[60:63], v[112:115], v[80:83]
    v_cndmask_b32 v125, 0, v125, vcc
    v_cvt_pk_bf16_f32 v53, v124, v125
    v_mfma_f32_16x16x32_bf16 v[84:87], a[64:67], v[112:115], v[84:87]
    s_waitcnt lgkmcnt(4)
    v_lshlrev_b32 v126, 16, v53
    v_and_b32 v127, 0xffff0000, v53
    v_mfma_f32_16x16x32_bf16 v[88:91], a[68:71], v[112:115], v[88:91]
    s_add_u32 m0, s12, 2048
    ds_read_b128 v[112:115], v18 offset:11264
    v_sub_f32 v124, v124, v126
    v_mfma_f32_16x16x32_bf16 v[80:83], a[72:75], v[92:95], v[80:83]
    s_add_u32 s14, s69, 65536
    v_sub_f32 v125, v125, v127
    v_cvt_pk_bf16_f32 v52, v126, v124
    v_mfma_f32_16x16x32_bf16 v[84:87], a[76:79], v[92:95], v[84:87]
    s_waitcnt lgkmcnt(4)
    buffer_load_dwordx4 v62, s[24:27], s14 offen offset:0 lds
    v_cvt_pk_bf16_f32 v54, v125, v127
    v_mfma_f32_16x16x32_bf16 v[88:91], a[80:83], v[92:95], v[88:91]
    ds_read_b128 v[92:95], v18 offset:12288
    v_mov_b32 v55, 0
    v_mfma_f32_16x16x32_bf16 v[80:83], a[84:87], v[96:99], v[80:83]
    v_mfma_f32_16x16x32_bf16 v[84:87], a[88:91], v[96:99], v[84:87]
    s_waitcnt lgkmcnt(4)
    v_mfma_f32_16x16x32_bf16 v[88:91], a[92:95], v[96:99], v[88:91]
    ds_read_b128 v[96:99], v18 offset:13312
    v_mfma_f32_16x16x32_bf16 v[80:83], a[96:99], v[100:103], v[80:83]
    v_mfma_f32_16x16x32_bf16 v[84:87], a[100:103], v[100:103], v[84:87]
    s_waitcnt lgkmcnt(4)
    buffer_load_dwordx4 v0, s[24:27], s14 offen offset:1024 lds
    v_mfma_f32_16x16x32_bf16 v[88:91], a[104:107], v[100:103], v[88:91]
    ds_read_b128 v[100:103], v18 offset:14336
    v_mfma_f32_16x16x32_bf16 v[80:83], a[108:111], v[104:107], v[80:83]
    v_mfma_f32_16x16x32_bf16 v[84:87], a[112:115], v[104:107], v[84:87]
    s_waitcnt lgkmcnt(4)
    v_mfma_f32_16x16x32_bf16 v[88:91], a[116:119], v[104:107], v[88:91]
    s_add_u32 m0, s12, 4096
    ds_read_b128 v[104:107], v18 offset:15360
    v_mfma_f32_16x16x32_bf16 v[80:83], a[120:123], v[108:111], v[80:83]
    s_add_u32 s14, s68, 229376
    v_mfma_f32_16x16x32_bf16 v[84:87], a[124:127], v[108:111], v[84:87]
    s_waitcnt lgkmcnt(4)
    buffer_load_dwordx4 v62, s[24:27], s14 offen offset:0 lds
    v_mfma_f32_16x16x32_bf16 v[88:91], a[128:131], v[108:111], v[88:91]
    ds_read_b128 v[108:111], v19 offset:0
    v_mfma_f32_16x16x32_bf16 v[80:83], a[132:135], v[112:115], v[80:83]
    v_mfma_f32_16x16x32_bf16 v[84:87], a[136:139], v[112:115], v[84:87]
    s_waitcnt lgkmcnt(4)
    v_mfma_f32_16x16x32_bf16 v[88:91], a[140:143], v[112:115], v[88:91]
    ds_read_b128 v[112:115], v18 offset:16384
    v_mfma_f32_16x16x32_bf16 v[80:83], a[144:147], v[92:95], v[80:83]
    v_mfma_f32_16x16x32_bf16 v[84:87], a[148:151], v[92:95], v[84:87]
    s_waitcnt lgkmcnt(4)
    buffer_load_dwordx4 v0, s[24:27], s14 offen offset:1024 lds
    v_mfma_f32_16x16x32_bf16 v[88:91], a[152:155], v[92:95], v[88:91]
    ds_read_b128 v[92:95], v18 offset:17408
    v_mfma_f32_16x16x32_bf16 v[80:83], a[156:159], v[96:99], v[80:83]
    ds_read_b64 v[12:13], v20 offset:0
    v_mfma_f32_16x16x32_bf16 v[84:87], a[160:163], v[96:99], v[84:87]
    s_waitcnt lgkmcnt(5)
    v_mfma_f32_16x16x32_bf16 v[88:91], a[164:167], v[96:99], v[88:91]
    s_add_u32 m0, s12, 6144
    ds_read_b128 v[96:99], v18 offset:18432
    v_mfma_f32_16x16x32_bf16 v[80:83], a[168:171], v[100:103], v[80:83]
    s_add_u32 s14, s68, 393216
    v_mfma_f32_16x16x32_bf16 v[84:87], a[172:175], v[100:103], v[84:87]
    s_waitcnt lgkmcnt(5)
    buffer_load_dwordx4 v62, s[24:27], s14 offen offset:0 lds
    v_mfma_f32_16x16x32_bf16 v[88:91], a[176:179], v[100:103], v[88:91]
    ds_read_b128 v[100:103], v18 offset:19456
    v_mfma_f32_16x16x32_bf16 v[80:83], a[180:183], v[104:107], v[80:83]
    v_mfma_f32_16x16x32_bf16 v[84:87], a[184:187], v[104:107], v[84:87]
    s_waitcnt lgkmcnt(5)
    v_mfma_f32_16x16x32_bf16 v[88:91], a[188:191], v[104:107], v[88:91]
    ds_read_b128 v[104:107], v18 offset:20480
    v_mfma_f32_16x16x32_bf16 v[80:83], v[44:47], v[108:111], v[80:83]
    v_mfma_f32_16x16x32_bf16 v[84:87], v[48:51], v[108:111], v[84:87]
    s_waitcnt lgkmcnt(5)
    buffer_load_dwordx4 v0, s[24:27], s14 offen offset:1024 lds
    v_mfma_f32_16x16x32_bf16 v[88:91], v[52:55], v[108:111], v[88:91]
    ds_read_b128 v[108:111], v18 offset:21504
    v_mfma_f32_16x16x32_bf16 v[32:35], a[0:3], v[112:115], 0
    s_nop 1
    v_mul_f32 v128, v80, v80
    v_mul_f32 v129, v81, v81
    v_mfma_f32_16x16x32_bf16 v[36:39], a[4:7], v[112:115], 0
    s_add_u32 m0, s83, 32768
    s_waitcnt lgkmcnt(4)
    v_mfma_f32_16x16x32_bf16 v[116:119], a[8:11], v[112:115], 0
    s_xor_b32 s23, s82, 65536
    ds_read_b128 v[112:115], v18 offset:22528
    v_mul_f32 v130, v82, v82
    v_mfma_f32_16x16x32_bf16 v[32:35], a[12:15], v[92:95], v[32:35]
    v_mul_f32 v131, v83, v83
    v_fma_f32 v128, v128, v13, v12
    v_mfma_f32_16x16x32_bf16 v[36:39], a[16:19], v[92:95], v[36:39]
    s_waitcnt lgkmcnt(4)
    buffer_load_dwordx4 v2, s[36:39], s23 offen offset:0 sc1 lds
    v_fma_f32 v129, v129, v13, v12
    v_mfma_f32_16x16x32_bf16 v[116:119], a[20:23], v[92:95], v[116:119]
    ds_read_b128 v[92:95], v18 offset:23552
    v_fma_f32 v130, v130, v13, v12
    v_mfma_f32_16x16x32_bf16 v[32:35], a[24:27], v[96:99], v[32:35]
    v_fma_f32 v131, v131, v13, v12
    v_mul_f32 v128, v128, v80
    v_mfma_f32_16x16x32_bf16 v[36:39], a[28:31], v[96:99], v[36:39]
    s_waitcnt lgkmcnt(4)
    v_mul_f32 v129, v129, v81
    v_mul_f32 v130, v130, v82
    v_mfma_f32_16x16x32_bf16 v[116:119], a[32:35], v[96:99], v[116:119]
    buffer_load_dwordx4 v2, s[36:39], s23 offen offset:1024 sc1 lds
    ds_read_b128 v[96:99], v18 offset:24576
    v_mfma_f32_16x16x32_bf16 v[32:35], a[36:39], v[100:103], v[32:35]
    v_mul_f32 v131, v131, v83
    v_mul_f32 v84, v80, v84
    v_mfma_f32_16x16x32_bf16 v[36:39], a[40:43], v[100:103], v[36:39]
    s_waitcnt lgkmcnt(4)
    v_exp_f32 v128, v128
    v_mfma_f32_16x16x32_bf16 v[116:119], a[44:47], v[100:103], v[116:119]
    ds_read_b128 v[100:103], v18 offset:25600
    v_add_f32 v128, 1.0, v128
    v_mfma_f32_16x16x32_bf16 v[32:35], a[48:51], v[104:107], v[32:35]
    s_waitcnt vmcnt(8)
    buffer_load_dwordx4 v2, s[36:39], s23 offen offset:2048 sc1 lds
    ds_read_b64_tr_b16 a[192:193], v56 offset:0
    v_mfma_f32_16x16x32_bf16 v[36:39], a[52:55], v[104:107], v[36:39]
    s_waitcnt lgkmcnt(5)
    ds_read_b64_tr_b16 a[194:195], v56 offset:256
    v_mul_f32 v85, v81, v85
    v_mfma_f32_16x16x32_bf16 v[116:119], a[56:59], v[104:107], v[116:119]
    ds_read_b64_tr_b16 a[196:197], v56 offset:512
    ds_read_b128 v[104:107], v18 offset:26624
    v_mfma_f32_16x16x32_bf16 v[32:35], a[60:63], v[108:111], v[32:35]
    ds_read_b64_tr_b16 a[198:199], v56 offset:768
    v_mul_f32 v86, v82, v86
    v_mfma_f32_16x16x32_bf16 v[36:39], a[64:67], v[108:111], v[36:39]
    s_waitcnt lgkmcnt(8)
    v_exp_f32 v129, v129
    v_mfma_f32_16x16x32_bf16 v[116:119], a[68:71], v[108:111], v[116:119]
    buffer_load_dwordx4 v2, s[36:39], s23 offen offset:3072 sc1 lds
    ds_read_b128 v[108:111], v18 offset:27648
    v_mfma_f32_16x16x32_bf16 v[32:35], a[72:75], v[112:115], v[32:35]
    v_exp_f32 v130, v130
    v_mfma_f32_16x16x32_bf16 v[36:39], a[76:79], v[112:115], v[36:39]
    s_add_u32 m0, s12, 8192
    s_waitcnt lgkmcnt(8)
    v_add_f32 v129, 1.0, v129
    v_mfma_f32_16x16x32_bf16 v[116:119], a[80:83], v[112:115], v[116:119]
    s_add_u32 s14, s69, 458752
    ds_read_b128 v[112:115], v18 offset:28672
    v_add_f32 v130, 1.0, v130
    v_mfma_f32_16x16x32_bf16 v[32:35], a[84:87], v[92:95], v[32:35]
    buffer_load_dwordx4 v62, s[24:27], s14 offen offset:0 lds
    v_mul_f32 v87, v83, v87
    v_mfma_f32_16x16x32_bf16 v[36:39], a[88:91], v[92:95], v[36:39]
    s_waitcnt lgkmcnt(8)
    v_exp_f32 v131, v131
    v_mfma_f32_16x16x32_bf16 v[116:119], a[92:95], v[92:95], v[116:119]
    ds_read_b128 v[92:95], v18 offset:29696
    v_add_f32 v131, 1.0, v131
    v_mfma_f32_16x16x32_bf16 v[32:35], a[96:99], v[96:99], v[32:35]
    s_waitcnt vmcnt(9)
    v_rcp_f32 v128, v128
    v_mfma_f32_16x16x32_bf16 v[36:39], a[100:103], v[96:99], v[36:39]
    s_waitcnt lgkmcnt(8)
    ds_read_b64_tr_b16 a[200:201], v56 offset:2048
    ds_read_b64_tr_b16 a[202:203], v56 offset:2304
    v_mfma_f32_16x16x32_bf16 v[116:119], a[104:107], v[96:99], v[116:119]
    ds_read_b64_tr_b16 a[204:205], v56 offset:2560
    ds_read_b128 v[96:99], v18 offset:30720
    v_mfma_f32_16x16x32_bf16 v[32:35], a[108:111], v[100:103], v[32:35]
    s_waitcnt lgkmcnt(7)
    buffer_load_dwordx4 v0, s[24:27], s14 offen offset:1024 lds
    ds_read_b64_tr_b16 a[206:207], v56 offset:2816
    v_mfma_f32_16x16x32_bf16 v[36:39], a[112:115], v[100:103], v[36:39]
    v_rcp_f32 v129, v129
    v_mfma_f32_16x16x32_bf16 v[116:119], a[116:119], v[100:103], v[116:119]
    ds_read_b128 v[100:103], v18 offset:31744
    v_mul_f32 v84, v84, v128
    v_mfma_f32_16x16x32_bf16 v[32:35], a[120:123], v[104:107], v[32:35]
    v_rcp_f32 v130, v130
    v_mfma_f32_16x16x32_bf16 v[36:39], a[124:127], v[104:107], v[36:39]
    s_add_u32 m0, s12, 10240
    s_waitcnt lgkmcnt(8)
    v_mul_f32 v85, v85, v129
    v_mfma_f32_16x16x32_bf16 v[116:119], a[128:131], v[104:107], v[116:119]
    s_add_u32 s14, s68, 622592
    ds_read_b128 v[104:107], v19 offset:256
    v_mul_f32 v86, v86, v130
    v_mfma_f32_16x16x32_bf16 v[32:35], a[132:135], v[108:111], v[32:35]
    buffer_load_dwordx4 v62, s[24:27], s14 offen offset:0 lds
    v_cvt_pk_bf16_f32 v40, v84, v85
    v_mfma_f32_16x16x32_bf16 v[36:39], a[136:139], v[108:111], v[36:39]
    s_waitcnt lgkmcnt(8)
    v_rcp_f32 v131, v131
    v_mfma_f32_16x16x32_bf16 v[116:119], a[140:143], v[108:111], v[116:119]
    v_mul_f32 v87, v87, v131
    v_cvt_pk_bf16_f32 v41, v86, v87
    v_mfma_f32_16x16x32_bf16 v[32:35], a[144:147], v[112:115], v[32:35]
    s_waitcnt vmcnt(9)
    ds_read_b64_tr_b16 a[208:209], v56 offset:4096
    v_mfma_f32_16x16x32_bf16 v[36:39], a[148:151], v[112:115], v[36:39]
    s_waitcnt lgkmcnt(8)
    ds_read_b64_tr_b16 a[210:211], v56 offset:4352
    v_mfma_f32_16x16x32_bf16 v[116:119], a[152:155], v[112:115], v[116:119]
    ds_read_b64_tr_b16 a[212:213], v56 offset:4608
    v_mfma_f32_16x16x32_bf16 v[32:35], a[156:159], v[92:95], v[32:35]
    s_waitcnt lgkmcnt(5)
    buffer_load_dwordx4 v0, s[24:27], s14 offen offset:1024 lds
    ds_read_b64_tr_b16 a[214:215], v56 offset:4864
    v_mfma_f32_16x16x32_bf16 v[36:39], a[160:163], v[92:95], v[36:39]
    s_barrier
    ds_read_b128 v[108:111], v2 offset:0
    v_mfma_f32_16x16x32_bf16 v[116:119], a[164:167], v[92:95], v[116:119]
    ds_read_b128 v[112:115], v2 offset:1024
    ds_read_b64 v[14:15], v20 offset:128
    v_mfma_f32_16x16x32_bf16 v[32:35], a[168:171], v[96:99], v[32:35]
    s_add_u32 m0, s83, 36864
    ds_read_b64 v[16:17], v21 offset:0
    ds_read_b128 v[92:95], v2 offset:2048
    v_mfma_f32_16x16x32_bf16 v[36:39], a[172:175], v[96:99], v[36:39]
    s_xor_b32 s23, s82, 69632
    s_waitcnt lgkmcnt(10)
    v_mfma_f32_16x16x32_bf16 v[116:119], a[176:179], v[96:99], v[116:119]
    ds_read_b128 v[96:99], v2 offset:3072
    v_mfma_f32_16x16x32_bf16 v[32:35], a[180:183], v[100:103], v[32:35]
    buffer_load_dwordx4 v2, s[36:39], s23 offen offset:0 sc1 lds
    v_mfma_f32_16x16x32_bf16 v[36:39], a[184:187], v[100:103], v[36:39]
    s_waitcnt lgkmcnt(10)
    v_mfma_f32_16x16x32_bf16 v[116:119], a[188:191], v[100:103], v[116:119]
    ds_read_b128 v[100:103], v2 offset:4096
    v_mfma_f32_16x16x32_bf16 v[32:35], v[44:47], v[104:107], v[32:35]
    s_waitcnt vmcnt(9)
    ds_read_b64_tr_b16 a[216:217], v56 offset:6144
    v_mfma_f32_16x16x32_bf16 v[36:39], v[48:51], v[104:107], v[36:39]
    buffer_load_dwordx4 v2, s[36:39], s23 offen offset:1024 sc1 lds
    ds_read_b64_tr_b16 a[218:219], v56 offset:6400
    v_mfma_f32_16x16x32_bf16 v[116:119], v[52:55], v[104:107], v[116:119]
    s_waitcnt lgkmcnt(8)
    ds_read_b64_tr_b16 a[220:221], v56 offset:6656
    ds_read_b128 v[104:107], v2 offset:5120
    v_mfma_f32_16x16x32_bf16 v[80:83], a[0:3], v[108:111], 0
    ds_read_b64_tr_b16 a[222:223], v56 offset:6912
    v_mul_f32 v132, v32, v32
    v_mfma_f32_16x16x32_bf16 v[84:87], a[4:7], v[108:111], 0
    s_waitcnt lgkmcnt(8)
    v_mul_f32 v133, v33, v33
    v_mul_f32 v134, v34, v34
    v_mfma_f32_16x16x32_bf16 v[120:123], a[8:11], v[108:111], 0
    buffer_load_dwordx4 v2, s[36:39], s23 offen offset:2048 sc1 lds
    ds_read_b128 v[108:111], v2 offset:6144
    v_mfma_f32_16x16x32_bf16 v[80:83], a[12:15], v[112:115], v[80:83]
    v_mul_f32 v135, v35, v35
    v_fma_f32 v132, v132, v15, v14
    v_mfma_f32_16x16x32_bf16 v[84:87], a[16:19], v[112:115], v[84:87]
    s_waitcnt lgkmcnt(8)
    v_fma_f32 v133, v133, v15, v14
    v_fma_f32 v134, v134, v15, v14
    v_mfma_f32_16x16x32_bf16 v[120:123], a[20:23], v[112:115], v[120:123]
    ds_read_b128 v[112:115], v2 offset:7168
    v_fma_f32 v135, v135, v15, v14
    v_mfma_f32_16x16x32_bf16 v[80:83], a[24:27], v[92:95], v[80:83]
    v_mul_f32 v132, v132, v32
    v_mul_f32 v133, v133, v33
    v_mfma_f32_16x16x32_bf16 v[84:87], a[28:31], v[92:95], v[84:87]
    s_waitcnt lgkmcnt(8)
    buffer_load_dwordx4 v2, s[36:39], s23 offen offset:3072 sc1 lds
    v_mul_f32 v134, v134, v34
    v_mfma_f32_16x16x32_bf16 v[120:123], a[32:35], v[92:95], v[120:123]
    ds_read_b128 v[92:95], v2 offset:8192
    v_mul_f32 v135, v135, v35
    v_mfma_f32_16x16x32_bf16 v[80:83], a[36:39], v[96:99], v[80:83]
    s_add_u32 m0, s12, 12288
    v_exp_f32 v132, v132
    v_mfma_f32_16x16x32_bf16 v[84:87], a[40:43], v[96:99], v[84:87]
    s_add_u32 s14, s68, 786432
    s_waitcnt lgkmcnt(8)
    v_add_f32 v132, 1.0, v132
    v_mfma_f32_16x16x32_bf16 v[120:123], a[44:47], v[96:99], v[120:123]
    buffer_load_dwordx4 v62, s[24:27], s14 offen offset:0 lds
    ds_read_b128 v[96:99], v2 offset:9216
    v_mfma_f32_16x16x32_bf16 v[80:83], a[48:51], v[100:103], v[80:83]
    s_waitcnt lgkmcnt(4)
    v_exp_f32 v133, v133
    v_mfma_f32_16x16x32_bf16 v[84:87], a[52:55], v[100:103], v[84:87]
    v_exp_f32 v134, v134
    v_mfma_f32_16x16x32_bf16 v[120:123], a[56:59], v[100:103], v[120:123]
    ds_read_b128 v[100:103], v2 offset:10240
    v_add_f32 v133, 1.0, v133
    v_mfma_f32_16x16x32_bf16 v[80:83], a[60:63], v[104:107], v[80:83]
    v_exp_f32 v135, v135
    v_mfma_f32_16x16x32_bf16 v[84:87], a[64:67], v[104:107], v[84:87]
    s_waitcnt lgkmcnt(4)
    v_add_f32 v134, 1.0, v134
    v_add_f32 v135, 1.0, v135
    v_mfma_f32_16x16x32_bf16 v[120:123], a[68:71], v[104:107], v[120:123]
    buffer_load_dwordx4 v0, s[24:27], s14 offen offset:1024 lds
    ds_read_b128 v[104:107], v2 offset:11264
    v_mfma_f32_16x16x32_bf16 v[80:83], a[72:75], v[108:111], v[80:83]
    v_rcp_f32 v132, v132
    v_mfma_f32_16x16x32_bf16 v[84:87], a[76:79], v[108:111], v[84:87]
    s_waitcnt lgkmcnt(4)
    v_rcp_f32 v133, v133
    v_mfma_f32_16x16x32_bf16 v[120:123], a[80:83], v[108:111], v[120:123]
    s_add_u32 m0, s12, 0
    ds_read_b128 v[108:111], v2 offset:12288
    v_mul_f32 v36, v32, v36
    v_mfma_f32_16x16x32_bf16 v[80:83], a[84:87], v[112:115], v[80:83]
    s_add_u32 s14, s69, 851968
    v_rcp_f32 v134, v134
    v_mfma_f32_16x16x32_bf16 v[84:87], a[88:91], v[112:115], v[84:87]
    s_waitcnt lgkmcnt(4)
    v_rcp_f32 v135, v135
    v_mfma_f32_16x16x32_bf16 v[120:123], a[92:95], v[112:115], v[120:123]
    buffer_load_dwordx4 v62, s[24:27], s14 offen offset:0 lds
    ds_read_b128 v[112:115], v2 offset:13312
    v_mfma_f32_16x16x32_bf16 v[80:83], a[96:99], v[92:95], v[80:83]
    v_mul_f32 v37, v33, v37
    v_mul_f32 v38, v34, v38
    v_mfma_f32_16x16x32_bf16 v[84:87], a[100:103], v[92:95], v[84:87]
    s_waitcnt lgkmcnt(4)
    v_mul_f32 v39, v35, v39
    v_mul_f32 v36, v36, v132
    v_mfma_f32_16x16x32_bf16 v[120:123], a[104:107], v[92:95], v[120:123]
    s_waitcnt vmcnt(9)
    ds_read_b64_tr_b16 a[224:225], v56 offset:8192
    ds_read_b128 v[92:95], v2 offset:14336
    v_mfma_f32_16x16x32_bf16 v[80:83], a[108:111], v[96:99], v[80:83]
    ds_read_b64_tr_b16 a[226:227], v56 offset:8448
    v_mul_f32 v37, v37, v133
    v_mfma_f32_16x16x32_bf16 v[84:87], a[112:115], v[96:99], v[84:87]
    s_waitcnt lgkmcnt(6)
    ds_read_b64_tr_b16 a[228:229], v56 offset:8704
    v_mul_f32 v38, v38, v134
    v_mfma_f32_16x16x32_bf16 v[120:123], a[116:119], v[96:99], v[120:123]
    buffer_load_dwordx4 v0, s[24:27], s14 offen offset:1024 lds
    ds_read_b64_tr_b16 a[230:231], v56 offset:8960
    v_mfma_f32_16x16x32_bf16 v[80:83], a[120:123], v[100:103], v[80:83]
    v_mul_f32 v39, v39, v135
    v_cvt_pk_bf16_f32 v42, v36, v37
    v_mfma_f32_16x16x32_bf16 v[84:87], a[124:127], v[100:103], v[84:87]
    s_waitcnt lgkmcnt(7)
    ds_read_b128 v[96:99], v2 offset:15360
    v_cvt_pk_bf16_f32 v43, v38, v39
    v_mfma_f32_16x16x32_bf16 v[120:123], a[128:131], v[100:103], v[120:123]
    s_add_u32 m0, s12, 2048
    v_permlane32_swap_b32 v40, v42
    v_mfma_f32_16x16x32_bf16 v[80:83], a[132:135], v[104:107], v[80:83]
    s_add_u32 s14, s68, 1015808
    v_permlane32_swap_b32 v41, v43
    v_mfma_f32_16x16x32_bf16 v[84:87], a[136:139], v[104:107], v[84:87]
    s_waitcnt lgkmcnt(7)
    buffer_store_dwordx4 v[40:43], v22, s[36:39], s16 offen sc1
    ds_read_b128 v[100:103], v19 offset:512
    v_mfma_f32_16x16x32_bf16 v[120:123], a[140:143], v[104:107], v[120:123]
    v_permlane32_swap_b32 v88, v116
    v_mfma_f32_16x16x32_bf16 v[80:83], a[144:147], v[108:111], v[80:83]
    ds_read_b128 v[104:107], v2 offset:16384
    v_mul_f32 v136, v88, v88
    v_mfma_f32_16x16x32_bf16 v[84:87], a[148:151], v[108:111], v[84:87]
    s_waitcnt lgkmcnt(8)
    v_permlane32_swap_b32 v89, v117
    v_mfma_f32_16x16x32_bf16 v[120:123], a[152:155], v[108:111], v[120:123]
    s_waitcnt vmcnt(9)
    ds_read_b64_tr_b16 a[232:233], v56 offset:10240
    ds_read_b128 v[108:111], v2 offset:17408
    v_mfma_f32_16x16x32_bf16 v[80:83], a[156:159], v[112:115], v[80:83]
    buffer_load_dwordx4 v62, s[24:27], s14 offen offset:0 lds
    ds_read_b64_tr_b16 a[234:235], v56 offset:10496
    v_mfma_f32_16x16x32_bf16 v[84:87], a[160:163], v[112:115], v[84:87]
    s_waitcnt lgkmcnt(9)
    ds_read_b64_tr_b16 a[236:237], v56 offset:10752
    ds_read_b64 v[12:13], v20 offset:256
    v_mfma_f32_16x16x32_bf16 v[120:123], a[164:167], v[112:115], v[120:123]
    s_waitcnt lgkmcnt(8)
    ds_read_b64_tr_b16 a[238:239], v56 offset:11008
    ds_read_b128 v[112:115], v2 offset:18432
    v_mfma_f32_16x16x32_bf16 v[80:83], a[168:171], v[92:95], v[80:83]
    v_permlane32_swap_b32 v90, v118
    v_mfma_f32_16x16x32_bf16 v[84:87], a[172:175], v[92:95], v[84:87]
    s_waitcnt lgkmcnt(9)
    v_permlane32_swap_b32 v91, v119
    v_mfma_f32_16x16x32_bf16 v[120:123], a[176:179], v[92:95], v[120:123]
    ds_read_b128 v[92:95], v2 offset:19456
    v_mul_f32 v137, v89, v89
    v_mfma_f32_16x16x32_bf16 v[80:83], a[180:183], v[96:99], v[80:83]
    buffer_load_dwordx4 v0, s[24:27], s14 offen offset:1024 lds
    v_mul_f32 v138, v90, v90
    v_mfma_f32_16x16x32_bf16 v[84:87], a[184:187], v[96:99], v[84:87]
    s_add_u32 m0, s12, 4096
    s_waitcnt lgkmcnt(9)
    v_mul_f32 v139, v91, v91
    v_mfma_f32_16x16x32_bf16 v[120:123], a[188:191], v[96:99], v[120:123]
    s_add_u32 s14, s68, 1179648
    v_fma_f32 v136, v136, v17, v16
    v_fma_f32 v137, v137, v17, v16
    v_mfma_f32_16x16x32_bf16 v[80:83], v[44:47], v[100:103], v[80:83]
    v_fma_f32 v138, v138, v17, v16
    v_fma_f32 v139, v139, v17, v16
    v_mfma_f32_16x16x32_bf16 v[84:87], v[48:51], v[100:103], v[84:87]
    s_waitcnt lgkmcnt(8)
    v_mul_f32 v136, v136, v88
    v_mul_f32 v137, v137, v89
    v_mfma_f32_16x16x32_bf16 v[120:123], v[52:55], v[100:103], v[120:123]
    v_mul_f32 v138, v138, v90
    v_mul_f32 v139, v139, v91
    v_mfma_f32_16x16x32_bf16 v[32:35], a[0:3], v[104:107], 0
    buffer_load_dwordx4 v62, s[24:27], s14 offen offset:0 lds
    ds_read_b128 v[96:99], v2 offset:20480
    v_mfma_f32_16x16x32_bf16 v[36:39], a[4:7], v[104:107], 0
    s_waitcnt lgkmcnt(4)
    v_exp_f32 v136, v136
    v_mfma_f32_16x16x32_bf16 v[124:127], a[8:11], v[104:107], 0
    s_waitcnt lgkmcnt(3)
    v_exp_f32 v137, v137
    v_mfma_f32_16x16x32_bf16 v[32:35], a[12:15], v[108:111], v[32:35]
    v_exp_f32 v138, v138
    v_mfma_f32_16x16x32_bf16 v[36:39], a[16:19], v[108:111], v[36:39]
    s_waitcnt lgkmcnt(2)
    ds_read_b128 v[100:103], v2 offset:21504
    v_exp_f32 v139, v139
    v_mfma_f32_16x16x32_bf16 v[124:127], a[20:23], v[108:111], v[124:127]
    v_add_f32 v136, 1.0, v136
    v_add_f32 v137, 1.0, v137
    v_mfma_f32_16x16x32_bf16 v[32:35], a[24:27], v[112:115], v[32:35]
    buffer_load_dwordx4 v0, s[24:27], s14 offen offset:1024 lds
    v_add_f32 v138, 1.0, v138
    v_mfma_f32_16x16x32_bf16 v[36:39], a[28:31], v[112:115], v[36:39]
    s_add_u32 m0, s12, 6144
    ds_read_b128 v[104:107], v2 offset:22528
    v_add_f32 v139, 1.0, v139
    v_mul_f32 v116, v88, v116
    v_mfma_f32_16x16x32_bf16 v[124:127], a[32:35], v[112:115], v[124:127]
    s_add_u32 s14, s69, 1245184
    s_waitcnt lgkmcnt(3)
    v_rcp_f32 v136, v136
    v_mfma_f32_16x16x32_bf16 v[32:35], a[36:39], v[92:95], v[32:35]
    v_rcp_f32 v137, v137
    v_mfma_f32_16x16x32_bf16 v[36:39], a[40:43], v[92:95], v[36:39]
    s_waitcnt lgkmcnt(2)
    ds_read_b128 v[108:111], v2 offset:23552
    v_rcp_f32 v138, v138
    v_mfma_f32_16x16x32_bf16 v[124:127], a[44:47], v[92:95], v[124:127]
    v_rcp_f32 v139, v139
    v_mfma_f32_16x16x32_bf16 v[32:35], a[48:51], v[96:99], v[32:35]
    buffer_load_dwordx4 v62, s[24:27], s14 offen offset:0 lds
    v_mul_f32 v117, v89, v117
    v_mfma_f32_16x16x32_bf16 v[36:39], a[52:55], v[96:99], v[36:39]
    ds_read_b128 v[112:115], v2 offset:24576
    v_mul_f32 v118, v90, v118
    v_mul_f32 v119, v91, v119
    v_mfma_f32_16x16x32_bf16 v[124:127], a[56:59], v[96:99], v[124:127]
    s_waitcnt lgkmcnt(3)
    v_mul_f32 v116, v116, v136
    v_mul_f32 v117, v117, v137
    v_mfma_f32_16x16x32_bf16 v[32:35], a[60:63], v[100:103], v[32:35]
    v_mul_f32 v118, v118, v138
    v_mul_f32 v119, v119, v139
    v_mfma_f32_16x16x32_bf16 v[36:39], a[64:67], v[100:103], v[36:39]
    s_waitcnt vmcnt(8)
    ds_read_b64_tr_b16 a[240:241], v56 offset:12288
    ds_read_b128 v[92:95], v2 offset:25600
    v_cvt_pk_bf16_f32 v28, v116, v117
    v_mfma_f32_16x16x32_bf16 v[124:127], a[68:71], v[100:103], v[124:127]
    s_waitcnt lgkmcnt(4)
    buffer_load_dwordx4 v0, s[24:27], s14 offen offset:1024 lds
    ds_read_b64_tr_b16 a[242:243], v56 offset:12544
    v_mfma_f32_16x16x32_bf16 v[32:35], a[72:75], v[104:107], v[32:35]
    s_add_u32 m0, s12, 8192
    ds_read_b64_tr_b16 a[244:245], v56 offset:12800
    v_cvt_pk_bf16_f32 v29, v118, v119
    v_mfma_f32_16x16x32_bf16 v[36:39], a[76:79], v[104:107], v[36:39]
    s_add_u32 s14, s70, 0
    ds_read_b64_tr_b16 a[246:247], v56 offset:13056
    ds_read_b128 v[96:99], v2 offset:26624
    v_cvt_pk_bf16_f32 v30, v116, v117
    v_mfma_f32_16x16x32_bf16 v[124:127], a[80:83], v[104:107], v[124:127]
    s_waitcnt lgkmcnt(7)
    ds_read_b128 v[100:103], v2 offset:27648
    v_cvt_pk_bf16_f32 v31, v118, v119
    v_mfma_f32_16x16x32_bf16 v[32:35], a[84:87], v[108:111], v[32:35]
    v_permlane16_swap_b32 v28, v30
    v_mfma_f32_16x16x32_bf16 v[36:39], a[88:91], v[108:111], v[36:39]
    v_permlane16_swap_b32 v29, v31
    v_mfma_f32_16x16x32_bf16 v[124:127], a[92:95], v[108:111], v[124:127]
    s_waitcnt lgkmcnt(7)
    buffer_store_dwordx4 v[28:31], v23, s[36:39], s16 offen sc1
    ds_read_b128 v[104:107], v2 offset:28672
    v_mfma_f32_16x16x32_bf16 v[32:35], a[96:99], v[112:115], v[32:35]
    ds_read_b128 v[108:111], v2 offset:29696
    v_mul_f32 v128, v80, v80
    v_mfma_f32_16x16x32_bf16 v[36:39], a[100:103], v[112:115], v[36:39]
    buffer_load_dwordx4 v62, s[24:27], s14 offen offset:0 lds
    v_mul_f32 v129, v81, v81
    v_mfma_f32_16x16x32_bf16 v[124:127], a[104:107], v[112:115], v[124:127]
    s_waitcnt lgkmcnt(7)
    ds_read_b128 v[112:115], v2 offset:30720
    v_mul_f32 v130, v82, v82
    v_mfma_f32_16x16x32_bf16 v[32:35], a[108:111], v[92:95], v[32:35]
    s_waitcnt vmcnt(9)
    ds_read_b64_tr_b16 a[248:249], v56 offset:0
    v_mul_f32 v131, v83, v83
    v_mfma_f32_16x16x32_bf16 v[36:39], a[112:115], v[92:95], v[36:39]
    ds_read_b64_tr_b16 a[250:251], v56 offset:256
    v_fma_f32 v128, v128, v13, v12
    v_mfma_f32_16x16x32_bf16 v[124:127], a[116:119], v[92:95], v[124:127]
    s_waitcnt lgkmcnt(6)
    ds_read_b64_tr_b16 a[252:253], v56 offset:512
    ds_read_b128 v[92:95], v2 offset:31744
    v_mfma_f32_16x16x32_bf16 v[32:35], a[120:123], v[96:99], v[32:35]
    ds_read_b64_tr_b16 a[254:255], v56 offset:768
    v_fma_f32 v129, v129, v13, v12
    v_mfma_f32_16x16x32_bf16 v[36:39], a[124:127], v[96:99], v[36:39]
    s_waitcnt lgkmcnt(8)
    buffer_load_dwordx4 v0, s[24:27], s14 offen offset:1024 lds
    v_fma_f32 v130, v130, v13, v12
    v_mfma_f32_16x16x32_bf16 v[124:127], a[128:131], v[96:99], v[124:127]
    s_add_u32 m0, s12, 10240
    s_add_u32 s14, s71, 65536
    ds_read_b128 v[96:99], v19 offset:768
    v_mfma_f32_16x16x32_bf16 v[32:35], a[132:135], v[100:103], v[32:35]
    v_fma_f32 v131, v131, v13, v12
    v_mul_f32 v128, v128, v80
    v_mfma_f32_16x16x32_bf16 v[36:39], a[136:139], v[100:103], v[36:39]
    s_waitcnt lgkmcnt(8)
    v_mul_f32 v129, v129, v81
    v_mul_f32 v130, v130, v82
    v_mfma_f32_16x16x32_bf16 v[124:127], a[140:143], v[100:103], v[124:127]
    v_mul_f32 v131, v131, v83
    v_mul_f32 v84, v80, v84
    v_mfma_f32_16x16x32_bf16 v[32:35], a[144:147], v[104:107], v[32:35]
    v_exp_f32 v128, v128
    v_mfma_f32_16x16x32_bf16 v[36:39], a[148:151], v[104:107], v[36:39]
    s_waitcnt lgkmcnt(7)
    buffer_load_dwordx4 v62, s[24:27], s14 offen offset:0 lds
    v_add_f32 v128, 1.0, v128
    v_mfma_f32_16x16x32_bf16 v[124:127], a[152:155], v[104:107], v[124:127]
    v_exp_f32 v129, v129
    v_mfma_f32_16x16x32_bf16 v[32:35], a[156:159], v[108:111], v[32:35]
    v_exp_f32 v130, v130
    v_mfma_f32_16x16x32_bf16 v[36:39], a[160:163], v[108:111], v[36:39]
    s_xor_b32 s23, s82, 98304
    s_barrier
    ds_read_b128 v[100:103], v2 offset:32768
    v_mfma_f32_16x16x32_bf16 v[124:127], a[164:167], v[108:111], v[124:127]
    s_waitcnt lgkmcnt(7)
    ds_read_b128 v[104:107], v2 offset:33792
    v_add_f32 v129, 1.0, v129
    v_mfma_f32_16x16x32_bf16 v[32:35], a[168:171], v[112:115], v[32:35]
    s_waitcnt vmcnt(8) lgkmcnt(3)
    ds_read_b64_tr_b16 v[144:145], v56 offset:2048
    v_add_f32 v130, 1.0, v130
    v_mfma_f32_16x16x32_bf16 v[36:39], a[172:175], v[112:115], v[36:39]
    buffer_load_dwordx4 v0, s[24:27], s14 offen offset:1024 lds
    ds_read_b64_tr_b16 v[146:147], v56 offset:2304
    v_mfma_f32_16x16x32_bf16 v[124:127], a[176:179], v[112:115], v[124:127]
    s_add_u32 m0, s83, 65536
    ds_read_b64_tr_b16 v[148:149], v56 offset:2560
    ds_read_b64 v[14:15], v20 offset:384
    v_mfma_f32_16x16x32_bf16 v[32:35], a[180:183], v[92:95], v[32:35]
    ds_read_b64_tr_b16 v[150:151], v56 offset:2816
    ds_read_b64 v[16:17], v21 offset:256
    v_mfma_f32_16x16x32_bf16 v[36:39], a[184:187], v[92:95], v[36:39]
    s_waitcnt lgkmcnt(8)
    ds_read_b128 v[108:111], v2 offset:34816
    v_exp_f32 v131, v131
    v_mfma_f32_16x16x32_bf16 v[124:127], a[188:191], v[92:95], v[124:127]
    v_add_f32 v131, 1.0, v131
    v_mul_f32 v85, v81, v85
    v_mfma_f32_16x16x32_bf16 v[32:35], v[44:47], v[96:99], v[32:35]
    v_rcp_f32 v128, v128
    v_mfma_f32_16x16x32_bf16 v[36:39], v[48:51], v[96:99], v[36:39]
    buffer_load_dwordx4 v2, s[36:39], s23 offen offset:0 sc1 lds
    ds_read_b128 v[112:115], v2 offset:35840
    v_mul_f32 v86, v82, v86
    v_rcp_f32 v129, v129
    v_rcp_f32 v130, v130
    v_rcp_f32 v131, v131
    v_mfma_f32_16x16x32_bf16 v[124:127], v[52:55], v[96:99], v[124:127]
    s_waitcnt lgkmcnt(9)
    v_mul_f32 v87, v83, v87
    v_mul_f32 v84, v84, v128
    v_mul_f32 v85, v85, v129
    v_mul_f32 v86, v86, v130
    v_mul_f32 v87, v87, v131
    v_mfma_f32_16x16x32_bf16 v[80:83], a[0:3], v[100:103], 0
    v_cvt_pk_bf16_f32 v40, v84, v85
    v_cvt_pk_bf16_f32 v41, v86, v87
    v_mfma_f32_16x16x32_bf16 v[84:87], a[4:7], v[100:103], 0
    s_waitcnt lgkmcnt(2)
    ds_read_b128 v[92:95], v2 offset:36864
    ds_read_b128 v[96:99], v2 offset:37888
    v_mfma_f32_16x16x32_bf16 v[88:91], a[8:11], v[100:103], 0
    buffer_load_dwordx4 v2, s[36:39], s23 offen offset:1024 sc1 lds
    ds_read_b128 v[100:103], v2 offset:38912
    v_mfma_f32_16x16x32_bf16 v[80:83], a[12:15], v[104:107], v[80:83]
    s_waitcnt vmcnt(9)
    ds_read_b64_tr_b16 v[152:153], v56 offset:4096
    v_mul_f32 v132, v32, v32
    v_mfma_f32_16x16x32_bf16 v[84:87], a[16:19], v[104:107], v[84:87]
    ds_read_b64_tr_b16 v[154:155], v56 offset:4352
    v_mul_f32 v133, v33, v33
    v_mfma_f32_16x16x32_bf16 v[88:91], a[20:23], v[104:107], v[88:91]
    s_waitcnt lgkmcnt(6)
    ds_read_b64_tr_b16 v[156:157], v56 offset:4608
    ds_read_b128 v[104:107], v2 offset:39936
    v_mfma_f32_16x16x32_bf16 v[80:83], a[24:27], v[108:111], v[80:83]
    s_add_u32 s14, s70, 229376
    ds_read_b64_tr_b16 v[158:159], v56 offset:4864
    v_mul_f32 v134, v34, v34
    v_mfma_f32_16x16x32_bf16 v[84:87], a[28:31], v[108:111], v[84:87]
    buffer_load_dwordx4 v2, s[36:39], s23 offen offset:2048 sc1 lds
    v_mul_f32 v135, v35, v35
    v_mfma_f32_16x16x32_bf16 v[88:91], a[32:35], v[108:111], v[88:91]
    s_waitcnt lgkmcnt(8)
    ds_read_b128 v[108:111], v2 offset:40960
    v_fma_f32 v132, v132, v15, v14
    v_mfma_f32_16x16x32_bf16 v[80:83], a[36:39], v[112:115], v[80:83]
    v_fma_f32 v133, v133, v15, v14
    v_fma_f32 v134, v134, v15, v14
    v_mfma_f32_16x16x32_bf16 v[84:87], a[40:43], v[112:115], v[84:87]
    v_fma_f32 v135, v135, v15, v14
    v_mul_f32 v132, v132, v32
    v_mfma_f32_16x16x32_bf16 v[88:91], a[44:47], v[112:115], v[88:91]
    s_waitcnt lgkmcnt(8)
    buffer_load_dwordx4 v2, s[36:39], s23 offen offset:3072 sc1 lds
    ds_read_b128 v[112:115], v2 offset:41984
    v_mfma_f32_16x16x32_bf16 v[80:83], a[48:51], v[92:95], v[80:83]
    s_add_u32 m0, s12, 12288
    v_mul_f32 v133, v133, v33
    v_mul_f32 v134, v134, v34
    v_mfma_f32_16x16x32_bf16 v[84:87], a[52:55], v[92:95], v[84:87]
    s_waitcnt lgkmcnt(8)
    v_mul_f32 v135, v135, v35
    v_mul_f32 v36, v32, v36
    v_mfma_f32_16x16x32_bf16 v[88:91], a[56:59], v[92:95], v[88:91]
    s_waitcnt vmcnt(9)
    ds_read_b64_tr_b16 v[160:161], v56 offset:6144
    ds_read_b128 v[92:95], v2 offset:43008
    v_mfma_f32_16x16x32_bf16 v[80:83], a[60:63], v[96:99], v[80:83]
    buffer_load_dwordx4 v62, s[24:27], s14 offen offset:0 lds
    ds_read_b64_tr_b16 v[162:163], v56 offset:6400
    v_mfma_f32_16x16x32_bf16 v[84:87], a[64:67], v[96:99], v[84:87]
    s_waitcnt lgkmcnt(10)
    ds_read_b64_tr_b16 v[164:165], v56 offset:6656
    v_mul_f32 v37, v33, v37
    v_mfma_f32_16x16x32_bf16 v[88:91], a[68:71], v[96:99], v[88:91]
    ds_read_b64_tr_b16 v[166:167], v56 offset:6912
    ds_read_b128 v[96:99], v2 offset:44032
    v_mfma_f32_16x16x32_bf16 v[80:83], a[72:75], v[100:103], v[80:83]
    s_waitcnt lgkmcnt(8)
    s_xor_b32 s23, s82, 102400
    v_exp_f32 v132, v132
    v_mfma_f32_16x16x32_bf16 v[84:87], a[76:79], v[100:103], v[84:87]
    v_exp_f32 v133, v133
    v_mfma_f32_16x16x32_bf16 v[88:91], a[80:83], v[100:103], v[88:91]
    ds_read_b128 v[100:103], v2 offset:45056
    v_add_f32 v132, 1.0, v132
    v_mfma_f32_16x16x32_bf16 v[80:83], a[84:87], v[104:107], v[80:83]
    buffer_load_dwordx4 v0, s[24:27], s14 offen offset:1024 lds
    v_add_f32 v133, 1.0, v133
    v_mfma_f32_16x16x32_bf16 v[84:87], a[88:91], v[104:107], v[84:87]
    s_add_u32 m0, s83, 69632
    s_waitcnt lgkmcnt(8)
    v_mul_f32 v38, v34, v38
    v_mfma_f32_16x16x32_bf16 v[88:91], a[92:95], v[104:107], v[88:91]
    ds_read_b128 v[104:107], v2 offset:46080
    v_mul_f32 v39, v35, v39
    v_mfma_f32_16x16x32_bf16 v[80:83], a[96:99], v[108:111], v[80:83]
    v_exp_f32 v134, v134
    v_mfma_f32_16x16x32_bf16 v[84:87], a[100:103], v[108:111], v[84:87]
    s_waitcnt vmcnt(10) lgkmcnt(8)
    buffer_store_dword v3, v24, s[36:39], s20 offen offset:2048 sc1
    v_add_f32 v134, 1.0, v134
    v_mfma_f32_16x16x32_bf16 v[88:91], a[104:107], v[108:111], v[88:91]
    v_exp_f32 v135, v135
    v_mfma_f32_16x16x32_bf16 v[80:83], a[108:111], v[112:115], v[80:83]
    ds_read_b128 v[108:111], v2 offset:47104
    v_add_f32 v135, 1.0, v135
    v_mfma_f32_16x16x32_bf16 v[84:87], a[112:115], v[112:115], v[84:87]
    s_waitcnt vmcnt(9) lgkmcnt(7)
    buffer_load_dwordx4 v2, s[36:39], s23 offen offset:0 sc1 lds
    ds_read_b64_tr_b16 v[168:169], v56 offset:8192
    v_mfma_f32_16x16x32_bf16 v[88:91], a[116:119], v[112:115], v[88:91]
    s_waitcnt lgkmcnt(5)
    ds_read_b64_tr_b16 v[170:171], v56 offset:8448
    ds_read_b128 v[112:115], v2 offset:48128
    v_mfma_f32_16x16x32_bf16 v[80:83], a[120:123], v[92:95], v[80:83]
    v_rcp_f32 v132, v132
    v_mfma_f32_16x16x32_bf16 v[84:87], a[124:127], v[92:95], v[84:87]
    s_waitcnt lgkmcnt(6)
    ds_read_b64_tr_b16 v[172:173], v56 offset:8704
    ds_read_b64_tr_b16 v[174:175], v56 offset:8960
    v_mfma_f32_16x16x32_bf16 v[88:91], a[128:131], v[92:95], v[88:91]
    buffer_load_dwordx4 v2, s[36:39], s23 offen offset:1024 sc1 lds
    v_mul_f32 v36, v36, v132
    v_mfma_f32_16x16x32_bf16 v[80:83], a[132:135], v[96:99], v[80:83]
    v_rcp_f32 v133, v133
    v_mfma_f32_16x16x32_bf16 v[84:87], a[136:139], v[96:99], v[84:87]
    s_waitcnt lgkmcnt(7)
    v_rcp_f32 v134, v134
    v_mfma_f32_16x16x32_bf16 v[88:91], a[140:143], v[96:99], v[88:91]
    v_rcp_f32 v135, v135
    v_mfma_f32_16x16x32_bf16 v[80:83], a[144:147], v[100:103], v[80:83]
    s_add_u32 s14, s70, 393216
    v_mul_f32 v37, v37, v133
    v_mul_f32 v38, v38, v134
    v_mfma_f32_16x16x32_bf16 v[84:87], a[148:151], v[100:103], v[84:87]
    s_waitcnt lgkmcnt(6)
    buffer_load_dwordx4 v2, s[36:39], s23 offen offset:2048 sc1 lds
    ds_read_b128 v[92:95], v19 offset:1024
    v_mul_f32 v39, v39, v135
    v_mfma_f32_16x16x32_bf16 v[88:91], a[152:155], v[100:103], v[88:91]
    v_cvt_pk_bf16_f32 v42, v36, v37
    v_cvt_pk_bf16_f32 v43, v38, v39
    v_mfma_f32_16x16x32_bf16 v[80:83], a[156:159], v[104:107], v[80:83]
    v_permlane32_swap_b32 v40, v42
    v_mfma_f32_16x16x32_bf16 v[84:87], a[160:163], v[104:107], v[84:87]
    s_waitcnt vmcnt(10) lgkmcnt(6)
    ds_read_b64_tr_b16 v[176:177], v56 offset:10240
    ds_read_b128 v[96:99], v2 offset:49152
    v_mfma_f32_16x16x32_bf16 v[88:91], a[164:167], v[104:107], v[88:91]
    buffer_load_dwordx4 v2, s[36:39], s23 offen offset:3072 sc1 lds
    ds_read_b64_tr_b16 v[178:179], v56 offset:10496
    v_mfma_f32_16x16x32_bf16 v[80:83], a[168:171], v[108:111], v[80:83]
    s_add_u32 m0, s12, 0
    ds_read_b64_tr_b16 v[180:181], v56 offset:10752
    ds_read_b128 v[100:103], v2 offset:50176
    v_mfma_f32_16x16x32_bf16 v[84:87], a[172:175], v[108:111], v[84:87]
    s_waitcnt lgkmcnt(6)
    ds_read_b64_tr_b16 v[182:183], v56 offset:11008
    ds_read_b64 v[12:13], v20 offset:512
    v_mfma_f32_16x16x32_bf16 v[88:91], a[176:179], v[108:111], v[88:91]
    v_permlane32_swap_b32 v41, v43
    v_mfma_f32_16x16x32_bf16 v[80:83], a[180:183], v[112:115], v[80:83]
    buffer_store_dwordx4 v[40:43], v22, s[36:39], s17 offen sc1
    ds_read_b128 v[104:107], v2 offset:51200
    v_mfma_f32_16x16x32_bf16 v[84:87], a[184:187], v[112:115], v[84:87]
    v_permlane32_swap_b32 v120, v124
    v_mfma_f32_16x16x32_bf16 v[88:91], a[188:191], v[112:115], v[88:91]
    s_waitcnt lgkmcnt(8)
    ds_read_b128 v[108:111], v2 offset:52224
    v_mul_f32 v136, v120, v120
    v_mfma_f32_16x16x32_bf16 v[80:83], v[44:47], v[92:95], v[80:83]
    v_permlane32_swap_b32 v121, v125
    v_mfma_f32_16x16x32_bf16 v[84:87], v[48:51], v[92:95], v[84:87]
    v_permlane32_swap_b32 v122, v126
    v_mfma_f32_16x16x32_bf16 v[88:91], v[52:55], v[92:95], v[88:91]
    s_waitcnt lgkmcnt(7)
    buffer_load_dwordx4 v62, s[24:27], s14 offen offset:0 lds
    v_mul_f32 v137, v121, v121
    v_mfma_f32_16x16x32_bf16 v[32:35], a[0:3], v[96:99], 0
    v_permlane32_swap_b32 v123, v127
    v_mfma_f32_16x16x32_bf16 v[36:39], a[4:7], v[96:99], 0
    s_waitcnt lgkmcnt(2)
    ds_read_b128 v[112:115], v2 offset:53248
    v_mul_f32 v138, v122, v122
    v_mul_f32 v139, v123, v123
    v_mfma_f32_16x16x32_bf16 v[116:119], a[8:11], v[96:99], 0
    v_fma_f32 v136, v136, v17, v16
    v_fma_f32 v137, v137, v17, v16
    v_mfma_f32_16x16x32_bf16 v[32:35], a[12:15], v[100:103], v[32:35]
    v_fma_f32 v138, v138, v17, v16
    v_fma_f32 v139, v139, v17, v16
    v_mfma_f32_16x16x32_bf16 v[36:39], a[16:19], v[100:103], v[36:39]
    s_waitcnt lgkmcnt(2)
    ds_read_b128 v[92:95], v2 offset:54272
    v_mul_f32 v136, v136, v120
    v_mul_f32 v137, v137, v121
    v_mfma_f32_16x16x32_bf16 v[116:119], a[20:23], v[100:103], v[116:119]
    buffer_load_dwordx4 v0, s[24:27], s14 offen offset:1024 lds
    v_mul_f32 v138, v138, v122
    v_mfma_f32_16x16x32_bf16 v[32:35], a[24:27], v[104:107], v[32:35]
    s_add_u32 m0, s12, 2048
    s_add_u32 s14, s71, 458752
    v_mul_f32 v139, v139, v123
    v_mfma_f32_16x16x32_bf16 v[36:39], a[28:31], v[104:107], v[36:39]
    s_waitcnt lgkmcnt(2)
    ds_read_b128 v[96:99], v2 offset:55296
    v_exp_f32 v136, v136
    v_mfma_f32_16x16x32_bf16 v[116:119], a[32:35], v[104:107], v[116:119]
    v_exp_f32 v137, v137
    v_mfma_f32_16x16x32_bf16 v[32:35], a[36:39], v[108:111], v[32:35]
    v_exp_f32 v138, v138
    v_mfma_f32_16x16x32_bf16 v[36:39], a[40:43], v[108:111], v[36:39]
    ds_read_b128 v[100:103], v2 offset:56320
    v_exp_f32 v139, v139
    v_mfma_f32_16x16x32_bf16 v[116:119], a[44:47], v[108:111], v[116:119]
    s_waitcnt lgkmcnt(3)
    buffer_load_dwordx4 v62, s[24:27], s14 offen offset:0 lds
    v_add_f32 v136, 1.0, v136
    v_mfma_f32_16x16x32_bf16 v[32:35], a[48:51], v[112:115], v[32:35]
    v_add_f32 v137, 1.0, v137
    v_add_f32 v138, 1.0, v138
    v_mfma_f32_16x16x32_bf16 v[36:39], a[52:55], v[112:115], v[36:39]
    ds_read_b128 v[104:107], v2 offset:57344
    v_add_f32 v139, 1.0, v139
    v_mul_f32 v124, v120, v124
    v_mfma_f32_16x16x32_bf16 v[116:119], a[56:59], v[112:115], v[116:119]
    s_waitcnt lgkmcnt(3)
    v_rcp_f32 v136, v136
    v_mfma_f32_16x16x32_bf16 v[32:35], a[60:63], v[92:95], v[32:35]
    v_rcp_f32 v137, v137
    v_mfma_f32_16x16x32_bf16 v[36:39], a[64:67], v[92:95], v[36:39]
    ds_read_b128 v[108:111], v2 offset:58368
    v_rcp_f32 v138, v138
    v_mfma_f32_16x16x32_bf16 v[116:119], a[68:71], v[92:95], v[116:119]
    s_waitcnt lgkmcnt(3)
    buffer_load_dwordx4 v0, s[24:27], s14 offen offset:1024 lds
    v_mul_f32 v125, v121, v125
    v_mfma_f32_16x16x32_bf16 v[32:35], a[72:75], v[96:99], v[32:35]
    s_add_u32 m0, s12, 4096
    s_add_u32 s14, s70, 622592
    s_waitcnt vmcnt(10)
    v_mfma_f32_16x16x32_bf16 v[36:39], a[76:79], v[96:99], v[36:39]
    ds_read_b64_tr_b16 v[184:185], v56 offset:12288
    ds_read_b64_tr_b16 v[186:187], v56 offset:12544
    ds_read_b128 v[112:115], v2 offset:59392
    v_mfma_f32_16x16x32_bf16 v[116:119], a[80:83], v[96:99], v[116:119]
    s_waitcnt lgkmcnt(5)
    ds_read_b64_tr_b16 v[188:189], v56 offset:12800
    v_mul_f32 v126, v122, v126
    v_mfma_f32_16x16x32_bf16 v[32:35], a[84:87], v[100:103], v[32:35]
    ds_read_b64_tr_b16 v[190:191], v56 offset:13056
    v_mul_f32 v127, v123, v127
    v_mfma_f32_16x16x32_bf16 v[36:39], a[88:91], v[100:103], v[36:39]
    buffer_load_dwordx4 v62, s[24:27], s14 offen offset:0 lds
    ds_read_b128 v[92:95], v2 offset:60416
    v_mul_f32 v124, v124, v136
    v_mfma_f32_16x16x32_bf16 v[116:119], a[92:95], v[100:103], v[116:119]
    s_waitcnt lgkmcnt(7)
    v_rcp_f32 v139, v139
    v_mfma_f32_16x16x32_bf16 v[32:35], a[96:99], v[104:107], v[32:35]
    v_mul_f32 v125, v125, v137
    v_mul_f32 v126, v126, v138
    v_mfma_f32_16x16x32_bf16 v[36:39], a[100:103], v[104:107], v[36:39]
    buffer_load_dword v27, v5, s[36:39], s22 offen offset:2048 sc1
    ds_read_b128 v[96:99], v2 offset:61440
    v_mul_f32 v127, v127, v139
    v_mfma_f32_16x16x32_bf16 v[116:119], a[104:107], v[104:107], v[116:119]
    s_waitcnt lgkmcnt(7)
    v_cvt_pk_bf16_f32 v28, v124, v125
    v_cvt_pk_bf16_f32 v29, v126, v127
    v_mfma_f32_16x16x32_bf16 v[32:35], a[108:111], v[108:111], v[32:35]
    v_cvt_pk_bf16_f32 v30, v124, v125
    v_cvt_pk_bf16_f32 v31, v126, v127
    v_mfma_f32_16x16x32_bf16 v[36:39], a[112:115], v[108:111], v[36:39]
    ds_read_b128 v[100:103], v2 offset:62464
    v_permlane16_swap_b32 v28, v30
    v_mfma_f32_16x16x32_bf16 v[116:119], a[116:119], v[108:111], v[116:119]
    s_waitcnt lgkmcnt(5)
    buffer_load_dwordx4 v0, s[24:27], s14 offen offset:1024 lds
    ds_read_b128 v[104:107], v2 offset:63488
    v_mfma_f32_16x16x32_bf16 v[32:35], a[120:123], v[112:115], v[32:35]
    s_add_u32 m0, s12, 6144
    s_add_u32 s14, s70, 786432
    ds_read_b128 v[108:111], v2 offset:64512
    v_mfma_f32_16x16x32_bf16 v[36:39], a[124:127], v[112:115], v[36:39]
    v_permlane16_swap_b32 v29, v31
    v_mfma_f32_16x16x32_bf16 v[116:119], a[128:131], v[112:115], v[116:119]
    s_waitcnt lgkmcnt(4)
    buffer_store_dwordx4 v[28:31], v23, s[36:39], s17 offen sc1
    ds_read_b128 v[112:115], v19 offset:1280
    v_mfma_f32_16x16x32_bf16 v[32:35], a[132:135], v[92:95], v[32:35]
    v_mul_f32 v128, v80, v80
    v_mul_f32 v129, v81, v81
    v_mfma_f32_16x16x32_bf16 v[36:39], a[136:139], v[92:95], v[36:39]
    v_mul_f32 v130, v82, v82
    v_mul_f32 v131, v83, v83
    v_mfma_f32_16x16x32_bf16 v[116:119], a[140:143], v[92:95], v[116:119]
    s_waitcnt lgkmcnt(4)
    v_fma_f32 v128, v128, v13, v12
    v_fma_f32 v129, v129, v13, v12
    v_mfma_f32_16x16x32_bf16 v[32:35], a[144:147], v[96:99], v[32:35]
    v_fma_f32 v130, v130, v13, v12
    v_fma_f32 v131, v131, v13, v12
    v_mfma_f32_16x16x32_bf16 v[36:39], a[148:151], v[96:99], v[36:39]
    buffer_load_dwordx4 v62, s[24:27], s14 offen offset:0 lds
    v_mul_f32 v128, v128, v80
    v_mfma_f32_16x16x32_bf16 v[116:119], a[152:155], v[96:99], v[116:119]
    s_waitcnt lgkmcnt(3)
    v_mul_f32 v129, v129, v81
    v_mul_f32 v130, v130, v82
    v_mfma_f32_16x16x32_bf16 v[32:35], a[156:159], v[100:103], v[32:35]
    ds_read_b64 v[14:15], v20 offset:640
    v_mul_f32 v131, v131, v83
    v_mfma_f32_16x16x32_bf16 v[36:39], a[160:163], v[100:103], v[36:39]
    s_waitcnt vmcnt(10)
    s_barrier
    ds_read_b128 v[92:95], v18 offset:0
    v_mfma_f32_16x16x32_bf16 v[116:119], a[164:167], v[100:103], v[116:119]
    s_waitcnt lgkmcnt(4)
    ds_read_b128 v[96:99], v18 offset:1024
    ds_read_b64 v[16:17], v21 offset:512
    v_mfma_f32_16x16x32_bf16 v[32:35], a[168:171], v[104:107], v[32:35]
    v_exp_f32 v128, v128
    v_mfma_f32_16x16x32_bf16 v[36:39], a[172:175], v[104:107], v[36:39]
    s_waitcnt lgkmcnt(5)
    buffer_load_dwordx4 v0, s[24:27], s14 offen offset:1024 lds
    v_add_f32 v128, 1.0, v128
    v_mfma_f32_16x16x32_bf16 v[116:119], a[176:179], v[104:107], v[116:119]
    s_add_u32 m0, s12, 8192
    s_add_u32 s14, s71, 851968
    v_mul_f32 v84, v80, v84
    v_mfma_f32_16x16x32_bf16 v[32:35], a[180:183], v[108:111], v[32:35]
    v_exp_f32 v129, v129
    v_mfma_f32_16x16x32_bf16 v[36:39], a[184:187], v[108:111], v[36:39]
    s_waitcnt lgkmcnt(4)
    ds_read_b128 v[100:103], v18 offset:2048
    v_exp_f32 v130, v130
    v_mfma_f32_16x16x32_bf16 v[116:119], a[188:191], v[108:111], v[116:119]
    v_exp_f32 v131, v131
    v_mfma_f32_16x16x32_bf16 v[32:35], v[44:47], v[112:115], v[32:35]
    v_add_f32 v129, 1.0, v129
    v_add_f32 v130, 1.0, v130
    v_mfma_f32_16x16x32_bf16 v[36:39], v[48:51], v[112:115], v[36:39]
    buffer_load_dwordx4 v62, s[24:27], s14 offen offset:0 lds
    ds_read_b128 v[104:107], v18 offset:3072
    v_add_f32 v131, 1.0, v131
    v_rcp_f32 v128, v128
    v_rcp_f32 v129, v129
    v_rcp_f32 v130, v130
    v_rcp_f32 v131, v131
    v_mfma_f32_16x16x32_bf16 v[116:119], v[52:55], v[112:115], v[116:119]
    s_waitcnt lgkmcnt(4)
    v_mul_f32 v85, v81, v85
    v_mul_f32 v86, v82, v86
    v_mul_f32 v87, v83, v87
    v_mul_f32 v84, v84, v128
    v_mul_f32 v85, v85, v129
    v_mul_f32 v86, v86, v130
    v_mul_f32 v87, v87, v131
    v_mfma_f32_16x16x32_bf16 v[80:83], a[0:3], v[92:95], 0
    v_cvt_pk_bf16_f32 v40, v84, v85
    v_cvt_pk_bf16_f32 v41, v86, v87
    v_mfma_f32_16x16x32_bf16 v[84:87], a[4:7], v[92:95], 0
    s_waitcnt lgkmcnt(2)
    ds_read_b128 v[108:111], v18 offset:4096
    ds_read_b128 v[112:115], v18 offset:5120
    v_mfma_f32_16x16x32_bf16 v[120:123], a[8:11], v[92:95], 0
    s_waitcnt vmcnt(9)
    ds_read_b64_tr_b16 v[192:193], v56 offset:0
    ds_read_b128 v[92:95], v18 offset:6144
    v_mfma_f32_16x16x32_bf16 v[80:83], a[12:15], v[96:99], v[80:83]
    ds_read_b64_tr_b16 v[194:195], v56 offset:256
    v_mul_f32 v132, v32, v32
    v_mfma_f32_16x16x32_bf16 v[84:87], a[16:19], v[96:99], v[84:87]
    buffer_load_dwordx4 v0, s[24:27], s14 offen offset:1024 lds
    ds_read_b64_tr_b16 v[196:197], v56 offset:512
    v_mfma_f32_16x16x32_bf16 v[120:123], a[20:23], v[96:99], v[120:123]
    s_add_u32 m0, s12, 10240
    s_add_u32 s14, s70, 1015808
    s_waitcnt lgkmcnt(7)
    ds_read_b64_tr_b16 v[198:199], v56 offset:768
    v_mfma_f32_16x16x32_bf16 v[80:83], a[24:27], v[100:103], v[80:83]
    ds_read_b128 v[96:99], v18 offset:7168
    v_mul_f32 v133, v33, v33
    v_mfma_f32_16x16x32_bf16 v[84:87], a[28:31], v[100:103], v[84:87]
    v_mul_f32 v134, v34, v34
    v_mul_f32 v135, v35, v35
    v_mfma_f32_16x16x32_bf16 v[120:123], a[32:35], v[100:103], v[120:123]
    s_waitcnt lgkmcnt(8)
    ds_read_b128 v[100:103], v18 offset:8192
    v_fma_f32 v132, v132, v15, v14
    v_mfma_f32_16x16x32_bf16 v[80:83], a[36:39], v[104:107], v[80:83]
    s_waitcnt vmcnt(6)
PP_55:
    v_cmp_ne_u32 vcc, s44, v27
    s_cbranch_vccnz PR_57
PC_56:
    v_mfma_f32_16x16x32_bf16 v[84:87], a[40:43], v[104:107], v[84:87]
    buffer_load_dwordx4 v62, s[24:27], s14 offen offset:0 lds
    v_fma_f32 v133, v133, v15, v14
    v_mfma_f32_16x16x32_bf16 v[120:123], a[44:47], v[104:107], v[120:123]
    s_waitcnt lgkmcnt(8)
    ds_read_b128 v[104:107], v18 offset:9216
    v_fma_f32 v134, v134, v15, v14
    v_mfma_f32_16x16x32_bf16 v[80:83], a[48:51], v[108:111], v[80:83]
    v_fma_f32 v135, v135, v15, v14
    v_mul_f32 v132, v132, v32
    v_mfma_f32_16x16x32_bf16 v[84:87], a[52:55], v[108:111], v[84:87]
    s_waitcnt lgkmcnt(8)
    v_mul_f32 v133, v133, v33
    v_mul_f32 v134, v134, v34
    v_mfma_f32_16x16x32_bf16 v[120:123], a[56:59], v[108:111], v[120:123]
    ds_read_b128 v[108:111], v18 offset:10240
    v_mul_f32 v135, v135, v35
    v_mfma_f32_16x16x32_bf16 v[80:83], a[60:63], v[112:115], v[80:83]
    v_exp_f32 v132, v132
    v_mfma_f32_16x16x32_bf16 v[84:87], a[64:67], v[112:115], v[84:87]
    s_waitcnt lgkmcnt(7)
    buffer_load_dwordx4 v0, s[24:27], s14 offen offset:1024 lds
    v_add_f32 v132, 1.0, v132
    v_mfma_f32_16x16x32_bf16 v[120:123], a[68:71], v[112:115], v[120:123]
    s_waitcnt lgkmcnt(4)
    s_add_u32 m0, s12, 12288
    s_add_u32 s14, s70, 1179648
    ds_read_b128 v[112:115], v18 offset:11264
    v_mfma_f32_16x16x32_bf16 v[80:83], a[72:75], v[92:95], v[80:83]
    v_exp_f32 v133, v133
    v_mfma_f32_16x16x32_bf16 v[84:87], a[76:79], v[92:95], v[84:87]
    s_waitcnt lgkmcnt(4)
    v_exp_f32 v134, v134
    v_mfma_f32_16x16x32_bf16 v[120:123], a[80:83], v[92:95], v[120:123]
    ds_read_b128 v[92:95], v18 offset:12288
    v_add_f32 v133, 1.0, v133
    v_mfma_f32_16x16x32_bf16 v[80:83], a[84:87], v[96:99], v[80:83]
    v_exp_f32 v135, v135
    v_mfma_f32_16x16x32_bf16 v[84:87], a[88:91], v[96:99], v[84:87]
    s_waitcnt lgkmcnt(4)
    buffer_load_dwordx4 v[208:211], v2, s[36:39], s8 offen offset:0 sc1
    v_add_f32 v134, 1.0, v134
    v_mfma_f32_16x16x32_bf16 v[120:123], a[92:95], v[96:99], v[120:123]
    v_add_f32 v135, 1.0, v135
    v_mul_f32 v36, v32, v36
    v_mfma_f32_16x16x32_bf16 v[80:83], a[96:99], v[100:103], v[80:83]
    v_rcp_f32 v132, v132
    v_mfma_f32_16x16x32_bf16 v[84:87], a[100:103], v[100:103], v[84:87]
    s_waitcnt lgkmcnt(3)
    v_rcp_f32 v133, v133
    v_mfma_f32_16x16x32_bf16 v[120:123], a[104:107], v[100:103], v[120:123]
    buffer_load_dwordx4 v62, s[24:27], s14 offen offset:0 lds
    v_mul_f32 v37, v33, v37
    v_mfma_f32_16x16x32_bf16 v[80:83], a[108:111], v[104:107], v[80:83]
    v_rcp_f32 v134, v134
    v_mfma_f32_16x16x32_bf16 v[84:87], a[112:115], v[104:107], v[84:87]
    s_waitcnt lgkmcnt(2)
    ds_read_b128 v[96:99], v18 offset:13312
    v_rcp_f32 v135, v135
    v_mfma_f32_16x16x32_bf16 v[120:123], a[116:119], v[104:107], v[120:123]
    v_mul_f32 v38, v34, v38
    v_mul_f32 v39, v35, v39
    v_mfma_f32_16x16x32_bf16 v[80:83], a[120:123], v[108:111], v[80:83]
    v_mul_f32 v36, v36, v132
    v_mul_f32 v37, v37, v133
    v_mfma_f32_16x16x32_bf16 v[84:87], a[124:127], v[108:111], v[84:87]
    s_waitcnt lgkmcnt(2)
    ds_read_b128 v[100:103], v18 offset:14336
    v_mul_f32 v38, v38, v134
    v_mul_f32 v39, v39, v135
    v_mfma_f32_16x16x32_bf16 v[120:123], a[128:131], v[108:111], v[120:123]
    buffer_load_dwordx4 v[212:215], v2, s[36:39], s8 offen offset:1024 sc1
    v_cvt_pk_bf16_f32 v42, v36, v37
    v_mfma_f32_16x16x32_bf16 v[80:83], a[132:135], v[112:115], v[80:83]
    ds_read_b128 v[104:107], v18 offset:15360
    v_cvt_pk_bf16_f32 v43, v38, v39
    v_mfma_f32_16x16x32_bf16 v[84:87], a[136:139], v[112:115], v[84:87]
    s_waitcnt vmcnt(9) lgkmcnt(3)
    buffer_store_dword v3, v24, s[36:39], s20 offen offset:2176 sc1
    ds_read_b128 v[108:111], v19 offset:1536
    v_mfma_f32_16x16x32_bf16 v[120:123], a[140:143], v[112:115], v[120:123]
    v_permlane32_swap_b32 v40, v42
    v_mfma_f32_16x16x32_bf16 v[80:83], a[144:147], v[92:95], v[80:83]
    v_permlane32_swap_b32 v41, v43
    v_mfma_f32_16x16x32_bf16 v[84:87], a[148:151], v[92:95], v[84:87]
    buffer_store_dwordx4 v[40:43], v22, s[36:39], s18 offen sc1
    ds_read_b128 v[112:115], v18 offset:16384
    v_mfma_f32_16x16x32_bf16 v[120:123], a[152:155], v[92:95], v[120:123]
    s_waitcnt lgkmcnt(4)
    ds_read_b128 v[92:95], v18 offset:17408
    v_mfma_f32_16x16x32_bf16 v[80:83], a[156:159], v[96:99], v[80:83]
    ds_read_b64 v[12:13], v20 offset:768
    v_mfma_f32_16x16x32_bf16 v[84:87], a[160:163], v[96:99], v[84:87]
    v_permlane32_swap_b32 v88, v116
    v_mfma_f32_16x16x32_bf16 v[120:123], a[164:167], v[96:99], v[120:123]
    s_waitcnt lgkmcnt(5)
    buffer_load_dwordx4 v0, s[24:27], s14 offen offset:1024 lds
    ds_read_b128 v[96:99], v18 offset:18432
    v_mfma_f32_16x16x32_bf16 v[80:83], a[168:171], v[100:103], v[80:83]
    s_add_u32 m0, s12, 0
    s_add_u32 s14, s71, 1245184
    v_mul_f32 v136, v88, v88
    v_mfma_f32_16x16x32_bf16 v[84:87], a[172:175], v[100:103], v[84:87]
    s_waitcnt lgkmcnt(5)
    v_permlane32_swap_b32 v89, v117
    v_mfma_f32_16x16x32_bf16 v[120:123], a[176:179], v[100:103], v[120:123]
    v_permlane32_swap_b32 v90, v118
    v_mfma_f32_16x16x32_bf16 v[80:83], a[180:183], v[104:107], v[80:83]
    v_permlane32_swap_b32 v91, v119
    v_mfma_f32_16x16x32_bf16 v[84:87], a[184:187], v[104:107], v[84:87]
    s_waitcnt lgkmcnt(4)
    v_mul_f32 v137, v89, v89
    v_mul_f32 v138, v90, v90
    v_mfma_f32_16x16x32_bf16 v[120:123], a[188:191], v[104:107], v[120:123]
    buffer_load_dwordx4 v[216:219], v2, s[36:39], s8 offen offset:2048 sc1
    v_mul_f32 v139, v91, v91
    v_mfma_f32_16x16x32_bf16 v[80:83], v[44:47], v[108:111], v[80:83]
    v_fma_f32 v136, v136, v17, v16
    v_fma_f32 v137, v137, v17, v16
    v_mfma_f32_16x16x32_bf16 v[84:87], v[48:51], v[108:111], v[84:87]
    s_waitcnt lgkmcnt(3)
    ds_read_b128 v[100:103], v18 offset:19456
    v_fma_f32 v138, v138, v17, v16
    v_fma_f32 v139, v139, v17, v16
    v_mfma_f32_16x16x32_bf16 v[120:123], v[52:55], v[108:111], v[120:123]
    v_mul_f32 v136, v136, v88
    v_mul_f32 v137, v137, v89
    v_mfma_f32_16x16x32_bf16 v[32:35], a[0:3], v[112:115], 0
    buffer_load_dwordx4 v[220:223], v2, s[36:39], s8 offen offset:3072 sc1
    v_mul_f32 v138, v138, v90
    v_mfma_f32_16x16x32_bf16 v[36:39], a[4:7], v[112:115], 0
    s_waitcnt lgkmcnt(2)
    ds_read_b128 v[104:107], v18 offset:20480
    v_mul_f32 v139, v139, v91
    v_mul_f32 v116, v88, v116
    v_mfma_f32_16x16x32_bf16 v[124:127], a[8:11], v[112:115], 0
    v_exp_f32 v136, v136
    v_mfma_f32_16x16x32_bf16 v[32:35], a[12:15], v[92:95], v[32:35]
    v_exp_f32 v137, v137
    v_mfma_f32_16x16x32_bf16 v[36:39], a[16:19], v[92:95], v[36:39]
    s_waitcnt lgkmcnt(2)
    buffer_load_dwordx4 v62, s[24:27], s14 offen offset:0 lds
    ds_read_b128 v[108:111], v18 offset:21504
    v_add_f32 v136, 1.0, v136
    v_mfma_f32_16x16x32_bf16 v[124:127], a[20:23], v[92:95], v[124:127]
    v_exp_f32 v138, v138
    v_mfma_f32_16x16x32_bf16 v[32:35], a[24:27], v[96:99], v[32:35]
    v_exp_f32 v139, v139
    v_mfma_f32_16x16x32_bf16 v[36:39], a[28:31], v[96:99], v[36:39]
    ds_read_b128 v[112:115], v18 offset:22528
    v_add_f32 v137, 1.0, v137
    v_add_f32 v138, 1.0, v138
    v_mfma_f32_16x16x32_bf16 v[124:127], a[32:35], v[96:99], v[124:127]
    s_waitcnt lgkmcnt(3)
    v_add_f32 v139, 1.0, v139
    v_mul_f32 v117, v89, v117
    v_mfma_f32_16x16x32_bf16 v[32:35], a[36:39], v[100:103], v[32:35]
    v_rcp_f32 v136, v136
    v_mfma_f32_16x16x32_bf16 v[36:39], a[40:43], v[100:103], v[36:39]
    buffer_load_dwordx4 v[224:227], v25, s[36:39], s8 offen offset:0 sc1
    ds_read_b128 v[92:95], v18 offset:23552
    v_mul_f32 v118, v90, v118
    v_mfma_f32_16x16x32_bf16 v[124:127], a[44:47], v[100:103], v[124:127]
    s_waitcnt lgkmcnt(3)
    v_rcp_f32 v137, v137
    v_mfma_f32_16x16x32_bf16 v[32:35], a[48:51], v[104:107], v[32:35]
    v_rcp_f32 v138, v138
    v_mfma_f32_16x16x32_bf16 v[36:39], a[52:55], v[104:107], v[36:39]
    ds_read_b128 v[96:99], v18 offset:24576
    v_rcp_f32 v139, v139
    v_mfma_f32_16x16x32_bf16 v[124:127], a[56:59], v[104:107], v[124:127]
    s_waitcnt lgkmcnt(3)
    buffer_load_dwordx4 v0, s[24:27], s14 offen offset:1024 lds
    v_mul_f32 v119, v91, v119
    v_mfma_f32_16x16x32_bf16 v[32:35], a[60:63], v[108:111], v[32:35]
    v_mul_f32 v116, v116, v136
    v_mul_f32 v117, v117, v137
    v_mfma_f32_16x16x32_bf16 v[36:39], a[64:67], v[108:111], v[36:39]
    ds_read_b128 v[100:103], v18 offset:25600
    v_mul_f32 v118, v118, v138
    v_mul_f32 v119, v119, v139
    v_mfma_f32_16x16x32_bf16 v[124:127], a[68:71], v[108:111], v[124:127]
    s_waitcnt lgkmcnt(3)
    v_cvt_pk_bf16_f32 v28, v116, v117
    v_cvt_pk_bf16_f32 v29, v118, v119
    v_mfma_f32_16x16x32_bf16 v[32:35], a[72:75], v[112:115], v[32:35]
    v_cvt_pk_bf16_f32 v30, v116, v117
    v_cvt_pk_bf16_f32 v31, v118, v119
    v_mfma_f32_16x16x32_bf16 v[36:39], a[76:79], v[112:115], v[36:39]
    buffer_load_dword v27, v58, s[36:39], s13 offen offset:2176 sc1
    ds_read_b128 v[104:107], v18 offset:26624
    v_mfma_f32_16x16x32_bf16 v[124:127], a[80:83], v[112:115], v[124:127]
    s_waitcnt lgkmcnt(3)
    v_permlane16_swap_b32 v28, v30
    v_mfma_f32_16x16x32_bf16 v[32:35], a[84:87], v[92:95], v[32:35]
    buffer_load_dwordx4 v[228:231], v25, s[36:39], s8 offen offset:1024 sc1
    ds_read_b128 v[108:111], v18 offset:27648
    v_mfma_f32_16x16x32_bf16 v[36:39], a[88:91], v[92:95], v[36:39]
    v_permlane16_swap_b32 v29, v31
    v_mfma_f32_16x16x32_bf16 v[124:127], a[92:95], v[92:95], v[124:127]
    s_waitcnt lgkmcnt(3)
    buffer_store_dwordx4 v[28:31], v23, s[36:39], s18 offen sc1
    ds_read_b128 v[112:115], v18 offset:28672
    v_mfma_f32_16x16x32_bf16 v[32:35], a[96:99], v[96:99], v[32:35]
    ds_read_b128 v[92:95], v18 offset:29696
    v_mul_f32 v128, v80, v80
    v_mfma_f32_16x16x32_bf16 v[36:39], a[100:103], v[96:99], v[36:39]
    v_mul_f32 v129, v81, v81
    v_mul_f32 v130, v82, v82
    v_mfma_f32_16x16x32_bf16 v[124:127], a[104:107], v[96:99], v[124:127]
    s_waitcnt lgkmcnt(4)
    ds_read_b128 v[96:99], v18 offset:30720
    v_mul_f32 v131, v83, v83
    v_mfma_f32_16x16x32_bf16 v[32:35], a[108:111], v[100:103], v[32:35]
    buffer_load_dwordx4 v[232:235], v25, s[36:39], s8 offen offset:2048 sc1
    v_fma_f32 v128, v128, v13, v12
    v_mfma_f32_16x16x32_bf16 v[36:39], a[112:115], v[100:103], v[36:39]
    v_fma_f32 v129, v129, v13, v12
    v_fma_f32 v130, v130, v13, v12
    v_mfma_f32_16x16x32_bf16 v[124:127], a[116:119], v[100:103], v[124:127]
    s_waitcnt lgkmcnt(4)
    ds_read_b128 v[100:103], v18 offset:31744
    v_fma_f32 v131, v131, v13, v12
    v_mfma_f32_16x16x32_bf16 v[32:35], a[120:123], v[104:107], v[32:35]
    v_mul_f32 v128, v128, v80
    v_mul_f32 v129, v129, v81
    v_mfma_f32_16x16x32_bf16 v[36:39], a[124:127], v[104:107], v[36:39]
    s_waitcnt lgkmcnt(4)
    buffer_load_dwordx4 v[236:239], v25, s[36:39], s8 offen offset:3072 sc1
    v_mul_f32 v130, v130, v82
    v_mfma_f32_16x16x32_bf16 v[124:127], a[128:131], v[104:107], v[124:127]
    ds_read_b128 v[104:107], v19 offset:1792
    v_mul_f32 v131, v131, v83
    v_mfma_f32_16x16x32_bf16 v[32:35], a[132:135], v[108:111], v[32:35]
    v_exp_f32 v128, v128
    v_mfma_f32_16x16x32_bf16 v[36:39], a[136:139], v[108:111], v[36:39]
    s_waitcnt lgkmcnt(4)
    v_exp_f32 v129, v129
    v_mfma_f32_16x16x32_bf16 v[124:127], a[140:143], v[108:111], v[124:127]
    buffer_load_dwordx4 v[240:243], v26, s[36:39], s8 offen offset:0 sc1
    v_add_f32 v128, 1.0, v128
    v_mfma_f32_16x16x32_bf16 v[32:35], a[144:147], v[112:115], v[32:35]
    v_exp_f32 v130, v130
    v_mfma_f32_16x16x32_bf16 v[36:39], a[148:151], v[112:115], v[36:39]
    s_waitcnt lgkmcnt(3)
    v_exp_f32 v131, v131
    v_mfma_f32_16x16x32_bf16 v[124:127], a[152:155], v[112:115], v[124:127]
    v_add_f32 v129, 1.0, v129
    v_add_f32 v130, 1.0, v130
    v_mfma_f32_16x16x32_bf16 v[32:35], a[156:159], v[92:95], v[32:35]
    ds_read_b64 v[14:15], v20 offset:896
    v_add_f32 v131, 1.0, v131
    v_mfma_f32_16x16x32_bf16 v[36:39], a[160:163], v[92:95], v[36:39]
    s_waitcnt lgkmcnt(3)
    buffer_load_dwordx4 v[244:247], v26, s[36:39], s8 offen offset:1024 sc1
    ds_read_b64 v[16:17], v21 offset:768
    v_mfma_f32_16x16x32_bf16 v[124:127], a[164:167], v[92:95], v[124:127]
    v_rcp_f32 v128, v128
    v_mfma_f32_16x16x32_bf16 v[32:35], a[168:171], v[96:99], v[32:35]
    v_rcp_f32 v129, v129
    v_mfma_f32_16x16x32_bf16 v[36:39], a[172:175], v[96:99], v[36:39]
    s_waitcnt lgkmcnt(3)
    v_rcp_f32 v130, v130
    v_mfma_f32_16x16x32_bf16 v[124:127], a[176:179], v[96:99], v[124:127]
    buffer_load_dwordx4 v[248:251], v26, s[36:39], s8 offen offset:2048 sc1
    v_mul_f32 v84, v80, v84
    v_mfma_f32_16x16x32_bf16 v[32:35], a[180:183], v[100:103], v[32:35]
    v_rcp_f32 v131, v131
    v_mfma_f32_16x16x32_bf16 v[36:39], a[184:187], v[100:103], v[36:39]
    s_waitcnt lgkmcnt(2)
    v_mul_f32 v85, v81, v85
    v_mul_f32 v86, v82, v86
    v_mfma_f32_16x16x32_bf16 v[124:127], a[188:191], v[100:103], v[124:127]
    s_waitcnt vmcnt(5)
    buffer_store_dword v3, v24, s[36:39], s21 offen offset:2304 sc1
    v_mul_f32 v87, v83, v87
    v_mfma_f32_16x16x32_bf16 v[32:35], v[44:47], v[104:107], v[32:35]
    v_mul_f32 v84, v84, v128
    v_mul_f32 v85, v85, v129
    v_mfma_f32_16x16x32_bf16 v[36:39], v[48:51], v[104:107], v[36:39]
PP_58:
    v_cmp_ne_u32 vcc, s44, v27
    s_cbranch_vccnz PR_60
PC_59:
    v_mul_f32 v86, v86, v130
    v_mul_f32 v87, v87, v131
    v_mfma_f32_16x16x32_bf16 v[124:127], v[52:55], v[104:107], v[124:127]
    buffer_load_dwordx4 a[0:3], v2, s[36:39], s9 offen offset:0 sc1
    v_cvt_pk_bf16_f32 v40, v84, v85
    v_cvt_pk_bf16_f32 v41, v86, v87
    v_mfma_f32_32x32x16_bf16 v[80:95], a[192:195], v[208:211], 0
    v_mul_f32 v132, v32, v32
    v_mul_f32 v133, v33, v33
    v_mul_f32 v134, v34, v34
    v_mul_f32 v135, v35, v35
    v_mfma_f32_32x32x16_bf16 v[96:111], a[196:199], v[208:211], 0
    s_waitcnt lgkmcnt(0)
    buffer_load_dwordx4 a[4:7], v2, s[36:39], s9 offen offset:1024 sc1
    v_fma_f32 v132, v132, v15, v14
    v_fma_f32 v133, v133, v15, v14
    v_fma_f32 v134, v134, v15, v14
    v_fma_f32 v135, v135, v15, v14
    v_mul_f32 v132, v132, v32
    v_mfma_f32_32x32x16_bf16 v[80:95], a[200:203], v[212:215], v[80:95]
    v_permlane32_swap_b32 v120, v124
    v_permlane32_swap_b32 v121, v125
    v_permlane32_swap_b32 v122, v126
    v_mfma_f32_32x32x16_bf16 v[96:111], a[204:207], v[212:215], v[96:111]
    buffer_load_dwordx4 a[8:11], v2, s[36:39], s9 offen offset:2048 sc1
    v_permlane32_swap_b32 v123, v127
    v_mul_f32 v133, v133, v33
    v_mul_f32 v134, v134, v34
    v_mul_f32 v135, v135, v35
    v_mfma_f32_32x32x16_bf16 v[80:95], a[208:211], v[216:219], v[80:95]
    v_exp_f32 v132, v132
    v_exp_f32 v133, v133
    v_exp_f32 v134, v134
    v_mfma_f32_32x32x16_bf16 v[96:111], a[212:215], v[216:219], v[96:111]
    buffer_load_dwordx4 a[12:15], v2, s[36:39], s9 offen offset:3072 sc1
    v_exp_f32 v135, v135
    v_mul_f32 v136, v120, v120
    v_mul_f32 v137, v121, v121
    v_mul_f32 v138, v122, v122
    v_mfma_f32_32x32x16_bf16 v[80:95], a[216:219], v[220:223], v[80:95]
    v_mul_f32 v139, v123, v123
    v_fma_f32 v136, v136, v17, v16
    v_fma_f32 v137, v137, v17, v16
    v_fma_f32 v138, v138, v17, v16
    v_fma_f32 v139, v139, v17, v16
    v_mul_f32 v136, v136, v120
    v_mfma_f32_32x32x16_bf16 v[96:111], a[220:223], v[220:223], v[96:111]
    buffer_load_dwordx4 a[16:19], v25, s[36:39], s9 offen offset:0 sc1
    v_mul_f32 v137, v137, v121
    v_mul_f32 v138, v138, v122
    v_mul_f32 v139, v139, v123
    v_exp_f32 v136, v136
    v_mfma_f32_32x32x16_bf16 v[80:95], a[224:227], v[224:227], v[80:95]
    v_exp_f32 v137, v137
    v_exp_f32 v138, v138
    v_exp_f32 v139, v139
    v_mfma_f32_32x32x16_bf16 v[96:111], a[228:231], v[224:227], v[96:111]
    buffer_load_dwordx4 a[20:23], v25, s[36:39], s9 offen offset:1024 sc1
    v_add_f32 v132, 1.0, v132
    v_add_f32 v133, 1.0, v133
    v_add_f32 v134, 1.0, v134
    v_add_f32 v135, 1.0, v135
    v_add_f32 v136, 1.0, v136
    v_mfma_f32_32x32x16_bf16 v[80:95], a[232:235], v[228:231], v[80:95]
    s_waitcnt vmcnt(11)
    buffer_load_dword v27, v5, s[36:39], s22 offen offset:2304 sc1
    v_rcp_f32 v132, v132
    v_rcp_f32 v133, v133
    v_add_f32 v137, 1.0, v137
    v_mfma_f32_32x32x16_bf16 v[96:111], a[236:239], v[228:231], v[96:111]
    v_rcp_f32 v134, v134
    v_rcp_f32 v135, v135
    v_add_f32 v138, 1.0, v138
    v_add_f32 v139, 1.0, v139
    v_mfma_f32_32x32x16_bf16 v[80:95], a[240:243], v[232:235], v[80:95]
    s_waitcnt vmcnt(11)
    buffer_load_dwordx4 a[24:27], v25, s[36:39], s9 offen offset:2048 sc1
    v_rcp_f32 v136, v136
    v_rcp_f32 v137, v137
    v_mul_f32 v36, v32, v36
    v_mfma_f32_32x32x16_bf16 v[96:111], a[244:247], v[232:235], v[96:111]
    v_rcp_f32 v138, v138
    v_rcp_f32 v139, v139
    v_mul_f32 v37, v33, v37
    v_mul_f32 v38, v34, v38
    v_mfma_f32_32x32x16_bf16 v[80:95], a[248:251], v[236:239], v[80:95]
    s_waitcnt vmcnt(11)
    buffer_load_dwordx4 a[28:31], v25, s[36:39], s9 offen offset:3072 sc1
    v_mul_f32 v39, v35, v39
    v_mul_f32 v36, v36, v132
    v_mul_f32 v37, v37, v133
    v_mul_f32 v38, v38, v134
    v_mul_f32 v39, v39, v135
    v_mfma_f32_32x32x16_bf16 v[96:111], a[252:255], v[236:239], v[96:111]
    v_cvt_pk_bf16_f32 v42, v36, v37
    v_cvt_pk_bf16_f32 v43, v38, v39
    v_mul_f32 v124, v120, v124
    v_mul_f32 v125, v121, v125
    v_mul_f32 v126, v122, v126
    v_mul_f32 v127, v123, v127
    v_mfma_f32_32x32x16_bf16 v[80:95], v[144:147], v[240:243], v[80:95]
    s_waitcnt vmcnt(11)
    buffer_load_dwordx4 a[32:35], v26, s[36:39], s9 offen offset:0 sc1
    v_mul_f32 v124, v124, v136
    v_mul_f32 v125, v125, v137
    v_mul_f32 v126, v126, v138
    v_mul_f32 v127, v127, v139
    v_cvt_pk_bf16_f32 v28, v124, v125
    v_mfma_f32_32x32x16_bf16 v[96:111], v[148:151], v[240:243], v[96:111]
    v_cvt_pk_bf16_f32 v29, v126, v127
    v_cvt_pk_bf16_f32 v30, v124, v125
    v_cvt_pk_bf16_f32 v31, v126, v127
    v_permlane32_swap_b32 v40, v42
    v_mfma_f32_32x32x16_bf16 v[80:95], v[152:155], v[244:247], v[80:95]
    s_waitcnt vmcnt(11)
    buffer_load_dwordx4 a[36:39], v26, s[36:39], s9 offen offset:1024 sc1
    ds_read_b64_tr_b16 v[200:201], v56 offset:2048
    v_permlane32_swap_b32 v41, v43
    v_permlane16_swap_b32 v28, v30
    v_permlane16_swap_b32 v29, v31
    v_mfma_f32_32x32x16_bf16 v[96:111], v[156:159], v[244:247], v[96:111]
    buffer_store_dwordx4 v[40:43], v22, s[36:39], s19 offen sc1
    buffer_store_dwordx4 v[28:31], v23, s[36:39], s19 offen sc1
    v_mfma_f32_32x32x16_bf16 v[80:95], v[160:163], v[248:251], v[80:95]
    s_waitcnt vmcnt(12)
    ds_read_b64_tr_b16 v[202:203], v56 offset:2304
    ds_read_b64_tr_b16 v[204:205], v56 offset:2560
    v_and_b32 v40, 7, v1
    v_lshrrev_b32 v41, 3, v1
    v_lshlrev_b32 v42, 2, v8
    v_xor_b32 v42, v42, v40
    v_mfma_f32_32x32x16_bf16 v[96:111], v[164:167], v[248:251], v[96:111]
    s_xor_b32 s4, s50, s49
    ds_read_b64_tr_b16 v[206:207], v56 offset:2816
    v_lshl_add_u32 v43, v42, 4, s83
    v_lshl_add_u32 v12, v7, 8, v43
    v_lshl_add_u32 v43, v42, 4, s12
    v_lshl_add_u32 v18, v7, 7, v43
    v_lshl_add_u32 v42, s47, 3, v41
    v_mfma_f32_32x32x16_bf16 a[160:175], a[192:195], a[0:3], 0
    s_waitcnt vmcnt(11)
    ds_read_b64_tr_b16 v[208:209], v56 offset:4096
    v_lshlrev_b32 v43, 1, v40
    v_xor_b32 v43, v43, v41
    v_lshlrev_b32 v28, 8, v42
    v_lshl_add_u32 v16, v43, 4, v28
    v_lshrrev_b32 v28, 3, v43
    v_mfma_f32_32x32x16_bf16 a[176:191], a[196:199], a[0:3], 0
    s_and_b32 s4, s4, 1
    ds_read_b64_tr_b16 v[210:211], v56 offset:4352
    v_mul_u32_u24 v28, 14208, v28
    v_lshl_add_u32 v28, v43, 4, v28
    v_lshl_add_u32 v28, v42, 7, v28
    v_add_u32 v22, 98304, v28
    v_xor_b32 v13, 16, v12
    v_mfma_f32_32x32x16_bf16 a[160:175], a[200:203], a[4:7], a[160:175]
    s_waitcnt vmcnt(6)
PP_61:
    v_cmp_ne_u32 vcc, s44, v27
    s_cbranch_vccnz PR_63
PC_62:
    buffer_load_dwordx4 a[40:43], v26, s[36:39], s9 offen offset:2048 sc1
    ds_read_b64_tr_b16 v[212:213], v56 offset:4608
    v_xor_b32 v19, 16, v18
    v_mfma_f32_32x32x16_bf16 a[176:191], a[204:207], a[4:7], a[176:191]
    ds_read_b64_tr_b16 v[216:217], v56 offset:6144
    ds_read_b64_tr_b16 v[214:215], v56 offset:4864
    v_xor_b32 v14, 32, v12
    v_xor_b32 v20, 32, v18
    v_xor_b32 v15, 48, v12
    v_xor_b32 v21, 48, v18
    v_mfma_f32_32x32x16_bf16 a[160:175], a[208:211], a[8:11], a[160:175]
    buffer_load_dwordx4 a[44:47], v2, s[36:39], s10 offen offset:0 sc1
    ds_read_b64_tr_b16 v[218:219], v56 offset:6400
    v_xor_b32 v17, 16, v16
    v_xor_b32 v23, 16, v22
    v_mfma_f32_32x32x16_bf16 a[176:191], a[212:215], a[8:11], a[176:191]
    s_lshl_b32 s4, s4, 8
    ds_read_b64_tr_b16 v[220:221], v56 offset:6656
    v_mfma_f32_32x32x16_bf16 a[160:175], a[216:219], a[12:15], a[160:175]
    buffer_load_dwordx4 a[48:51], v2, s[36:39], s10 offen offset:1024 sc1
    ds_read_b64_tr_b16 v[224:225], v56 offset:8192
    v_mfma_f32_32x32x16_bf16 a[176:191], a[220:223], a[12:15], a[176:191]
    s_add_u32 s4, s4, 163328
    ds_read_b64_tr_b16 v[226:227], v56 offset:8448
    ds_read_b64_tr_b16 v[222:223], v56 offset:6912
    v_lshl_add_u32 v42, v42, 2, s4
    v_mfma_f32_32x32x16_bf16 a[160:175], a[224:227], a[16:19], a[160:175]
    buffer_load_dwordx4 a[52:55], v2, s[36:39], s10 offen offset:2048 sc1
    ds_read_b64_tr_b16 v[228:229], v56 offset:8704
    v_mfma_f32_32x32x16_bf16 a[176:191], a[228:231], a[16:19], a[176:191]
    s_waitcnt vmcnt(4)
    ds_read_b64_tr_b16 v[232:233], v56 offset:10240
    ds_read_b64_tr_b16 v[230:231], v56 offset:8960
    buffer_store_dword v3, v24, s[36:39], s21 offen offset:2432 sc1
    v_mfma_f32_32x32x16_bf16 a[160:175], a[232:235], a[20:23], a[160:175]
    ds_read_b64_tr_b16 v[234:235], v56 offset:10496
    ds_read2_b32 v[42:43], v42 offset1:32
    v_mfma_f32_32x32x16_bf16 a[176:191], a[236:239], a[20:23], a[176:191]
    s_lshl_b32 s5, s51, 1
    buffer_load_dwordx4 a[56:59], v2, s[36:39], s10 offen offset:3072 sc1
    ds_read_b64_tr_b16 v[236:237], v56 offset:10752
    v_mfma_f32_32x32x16_bf16 a[160:175], a[240:243], a[24:27], a[160:175]
    ds_read_b64_tr_b16 v[240:241], v56 offset:12288
    ds_read_b64_tr_b16 v[238:239], v56 offset:11008
    v_mfma_f32_32x32x16_bf16 a[176:191], a[244:247], a[24:27], a[176:191]
    s_xor_b32 s5, s5, s78
    buffer_load_dwordx4 a[60:63], v25, s[36:39], s10 offen offset:0 sc1
    ds_read_b64_tr_b16 v[242:243], v56 offset:12544
    v_mfma_f32_32x32x16_bf16 a[160:175], a[248:251], a[28:31], a[160:175]
    ds_read_b64_tr_b16 v[244:245], v56 offset:12800
    v_mfma_f32_32x32x16_bf16 a[176:191], a[252:255], a[28:31], a[176:191]
    buffer_load_dwordx4 a[64:67], v25, s[36:39], s10 offen offset:1024 sc1
    ds_read_b64_tr_b16 v[248:249], v56 offset:0
    v_mfma_f32_32x32x16_bf16 a[160:175], v[144:147], a[32:35], a[160:175]
    ds_read_b64_tr_b16 v[250:251], v56 offset:256
    ds_read_b64_tr_b16 v[246:247], v56 offset:13056
    v_mfma_f32_32x32x16_bf16 a[176:191], v[148:151], a[32:35], a[176:191]
    s_lshl_b32 s5, s5, 6
    ds_read_b64_tr_b16 v[252:253], v56 offset:512
    v_mfma_f32_32x32x16_bf16 a[160:175], v[152:155], a[36:39], a[160:175]
    s_waitcnt vmcnt(7)
    buffer_load_dwordx4 a[68:71], v25, s[36:39], s10 offen offset:2048 sc1
    ds_read_b64_tr_b16 v[254:255], v56 offset:768
    v_mfma_f32_32x32x16_bf16 a[176:191], v[156:159], a[36:39], a[176:191]
    s_add_u32 s5, s5, 159232
    v_lshl_add_u32 v40, v40, 4, s5
    v_mfma_f32_32x32x16_bf16 a[160:175], v[160:163], a[40:43], a[160:175]
    s_waitcnt vmcnt(7)
    buffer_load_dwordx4 a[72:75], v25, s[36:39], s10 offen offset:3072 sc1
    ds_read_b128 v[28:31], v40
    v_mfma_f32_32x32x16_bf16 a[176:191], v[164:167], a[40:43], a[176:191]
    s_add_u32 s6, s3, 32768
    buffer_load_dword v27, v5, s[36:39], s22 offen offset:2432 sc1
    v_mfma_f32_32x32x16_bf16 v[80:95], v[168:171], a[44:47], v[80:95]
    s_waitcnt vmcnt(8) lgkmcnt(0)
    v_lshlrev_b32 v32, 16, v28
    v_and_b32 v33, 0xffff0000, v28
    v_lshlrev_b32 v34, 16, v29
    v_and_b32 v35, 0xffff0000, v29
    v_lshlrev_b32 v36, 16, v30
    v_and_b32 v37, 0xffff0000, v30
    v_mfma_f32_32x32x16_bf16 v[96:111], v[172:175], a[44:47], v[96:111]
    buffer_load_dwordx4 a[76:79], v26, s[36:39], s10 offen offset:0 sc1
    v_lshlrev_b32 v38, 16, v31
    v_and_b32 v39, 0xffff0000, v31
    v_mul_f32 v44, v32, v43
    v_mul_f32 v32, v32, v42
    v_mul_f32 v45, v33, v43
    v_mfma_f32_32x32x16_bf16 v[80:95], v[176:179], a[48:51], v[80:95]
    s_waitcnt vmcnt(8)
    v_mul_f32 v33, v33, v42
    v_mul_f32 v46, v34, v43
    v_mul_f32 v34, v34, v42
    v_mul_f32 v47, v35, v43
    v_mul_f32 v35, v35, v42
    v_mul_f32 v48, v36, v43
    v_mfma_f32_32x32x16_bf16 v[96:111], v[180:183], a[48:51], v[96:111]
    buffer_load_dwordx4 a[80:83], v26, s[36:39], s10 offen offset:1024 sc1
    v_mul_f32 v36, v36, v42
    v_mul_f32 v49, v37, v43
    v_mul_f32 v37, v37, v42
    v_mul_f32 v50, v38, v43
    v_mul_f32 v38, v38, v42
    v_mfma_f32_32x32x16_bf16 v[80:95], v[184:187], a[52:55], v[80:95]
    s_waitcnt vmcnt(7)
    v_mul_f32 v51, v39, v43
    v_mul_f32 v39, v39, v42
    v_mfma_f32_32x32x16_bf16 v[96:111], v[188:191], a[52:55], v[96:111]
    buffer_load_dwordx4 a[84:87], v26, s[36:39], s10 offen offset:2048 sc1
    v_mfma_f32_32x32x16_bf16 v[80:95], v[192:195], a[56:59], v[80:95]
    s_waitcnt vmcnt(7)
    ds_write_b128 v18, v[64:67]
    v_mfma_f32_32x32x16_bf16 v[96:111], v[196:199], a[56:59], v[96:111]
    v_mfma_f32_32x32x16_bf16 v[80:95], v[200:203], a[60:63], v[80:95]
    s_waitcnt vmcnt(6)
    ds_write_b128 v19, v[68:71]
    v_mfma_f32_32x32x16_bf16 v[96:111], v[204:207], a[60:63], v[96:111]
    v_mfma_f32_32x32x16_bf16 v[80:95], v[208:211], a[64:67], v[80:95]
    s_waitcnt vmcnt(5)
    ds_write_b128 v20, v[72:75]
    v_mfma_f32_32x32x16_bf16 v[96:111], v[212:215], a[64:67], v[96:111]
    v_mfma_f32_32x32x16_bf16 v[80:95], v[216:219], a[68:71], v[80:95]
    s_waitcnt vmcnt(4)
    ds_write_b128 v21, v[76:79]
    v_mfma_f32_32x32x16_bf16 v[96:111], v[220:223], a[68:71], v[96:111]
    s_waitcnt vmcnt(3)
PP_64:
    v_cmp_ne_u32 vcc, s44, v27
    s_cbranch_vccnz PR_66
PC_65:
    buffer_load_dwordx4 a[88:91], v2, s[36:39], s11 offen offset:0 sc1
    v_mfma_f32_32x32x16_bf16 v[80:95], v[224:227], a[72:75], v[80:95]
    s_waitcnt vmcnt(3)
    buffer_load_dwordx4 a[92:95], v2, s[36:39], s11 offen offset:1024 sc1
    v_mfma_f32_32x32x16_bf16 v[96:111], v[228:231], a[72:75], v[96:111]
    v_mfma_f32_32x32x16_bf16 v[80:95], v[232:235], a[76:79], v[80:95]
    s_waitcnt vmcnt(3)
    buffer_load_dwordx4 a[96:99], v2, s[36:39], s11 offen offset:2048 sc1
    v_mfma_f32_32x32x16_bf16 v[96:111], v[236:239], a[76:79], v[96:111]
    v_mfma_f32_32x32x16_bf16 v[80:95], v[240:243], a[80:83], v[80:95]
    s_waitcnt vmcnt(3)
    buffer_load_dwordx4 a[100:103], v2, s[36:39], s11 offen offset:3072 sc1
    v_mfma_f32_32x32x16_bf16 v[96:111], v[244:247], a[80:83], v[96:111]
    v_mfma_f32_32x32x16_bf16 v[80:95], v[248:251], a[84:87], v[80:95]
    v_mfma_f32_32x32x16_bf16 v[96:111], v[252:255], a[84:87], v[96:111]
    s_waitcnt vmcnt(3)
    buffer_load_dwordx4 a[104:107], v25, s[36:39], s11 offen offset:0 sc1
    v_mfma_f32_32x32x16_bf16 a[160:175], v[168:171], a[88:91], a[160:175]
    s_waitcnt vmcnt(3)
    s_nop 6
    ds_write_b128 v12, v[80:83] offset:0
    ds_write_b128 v13, v[84:87] offset:0
    v_mfma_f32_32x32x16_bf16 a[176:191], v[172:175], a[88:91], a[176:191]
    buffer_load_dwordx4 a[108:111], v25, s[36:39], s11 offen offset:1024 sc1
    ds_write_b128 v14, v[88:91] offset:0
    v_mfma_f32_32x32x16_bf16 a[160:175], v[176:179], a[92:95], a[160:175]
    s_waitcnt vmcnt(3)
    ds_write_b128 v15, v[92:95] offset:0
    ds_write_b128 v12, v[96:99] offset:128
    v_mfma_f32_32x32x16_bf16 a[176:191], v[180:183], a[92:95], a[176:191]
    buffer_load_dwordx4 a[112:115], v25, s[36:39], s11 offen offset:2048 sc1
    ds_write_b128 v13, v[100:103] offset:128
    v_mfma_f32_32x32x16_bf16 a[160:175], v[184:187], a[96:99], a[160:175]
    s_waitcnt vmcnt(3)
    ds_write_b128 v14, v[104:107] offset:128
    ds_write_b128 v15, v[108:111] offset:128
    v_mfma_f32_32x32x16_bf16 a[176:191], v[188:191], a[96:99], a[176:191]
    s_waitcnt lgkmcnt(0)
    s_barrier
    buffer_load_dwordx4 a[116:119], v25, s[36:39], s11 offen offset:3072 sc1
    ds_read_b128 v[112:115], v16 offset:0
    v_mfma_f32_32x32x16_bf16 a[160:175], v[192:195], a[100:103], a[160:175]
    ds_read_b128 v[116:119], v17 offset:0
    ds_read_b128 v[120:123], v16 offset:8192
    v_mfma_f32_32x32x16_bf16 a[176:191], v[196:199], a[100:103], a[176:191]
    s_waitcnt vmcnt(3)
    ds_read_b128 v[124:127], v17 offset:8192
    ds_read_b128 v[128:131], v16 offset:16384
    buffer_load_dwordx4 a[120:123], v26, s[36:39], s11 offen offset:0 sc1
    v_mfma_f32_32x32x16_bf16 a[160:175], v[200:203], a[104:107], a[160:175]
    ds_read_b128 v[132:135], v17 offset:16384
    ds_read_b128 v[136:139], v16 offset:24576
    v_mfma_f32_32x32x16_bf16 a[176:191], v[204:207], a[104:107], a[176:191]
    s_waitcnt vmcnt(3)
    ds_read_b128 v[140:143], v17 offset:24576
    ds_read_b128 v[64:67], v22 offset:0
    buffer_load_dwordx4 a[124:127], v26, s[36:39], s11 offen offset:1024 sc1
    v_mfma_f32_32x32x16_bf16 a[160:175], v[208:211], a[108:111], a[160:175]
    s_waitcnt lgkmcnt(5)
    ds_read_b128 v[68:71], v23 offset:0
    ds_read_b128 v[72:75], v22 offset:28672
    v_add_f32 v112, v112, v120
    v_add_f32 v113, v113, v121
    v_add_f32 v114, v114, v122
    v_add_f32 v115, v115, v123
    v_mfma_f32_32x32x16_bf16 a[176:191], v[212:215], a[108:111], a[176:191]
    s_waitcnt vmcnt(3)
    ds_read_b128 v[76:79], v23 offset:28672
    buffer_load_dwordx4 a[128:131], v26, s[36:39], s11 offen offset:2048 sc1
    v_add_f32 v116, v116, v124
    v_add_f32 v117, v117, v125
    v_add_f32 v118, v118, v126
    v_add_f32 v119, v119, v127
    v_mfma_f32_32x32x16_bf16 a[160:175], v[216:219], a[112:115], a[160:175]
    s_waitcnt lgkmcnt(4)
    v_add_f32 v128, v128, v136
    v_add_f32 v129, v129, v137
    v_add_f32 v130, v130, v138
    v_add_f32 v131, v131, v139
    v_add_f32 v132, v132, v140
    v_add_f32 v133, v133, v141
    v_mfma_f32_32x32x16_bf16 a[176:191], v[220:223], a[112:115], a[176:191]
    s_waitcnt vmcnt(3)
    v_add_f32 v134, v134, v142
    v_add_f32 v135, v135, v143
    v_add_f32 v112, v112, v128
    v_add_f32 v113, v113, v129
    v_add_f32 v114, v114, v130
    v_add_f32 v115, v115, v131
    v_mfma_f32_32x32x16_bf16 a[160:175], v[224:227], a[116:119], a[160:175]
    s_waitcnt lgkmcnt(0)
    v_add_f32 v116, v116, v132
    v_add_f32 v117, v117, v133
    v_add_f32 v118, v118, v134
    v_add_f32 v119, v119, v135
    v_fma_f32 v112, v112, v32, v64
    v_fma_f32 v113, v113, v33, v65
    v_mfma_f32_32x32x16_bf16 a[176:191], v[228:231], a[116:119], a[176:191]
    s_waitcnt vmcnt(2)
    v_fma_f32 v114, v114, v34, v66
    v_fma_f32 v115, v115, v35, v67
    v_fma_f32 v116, v116, v36, v68
    v_fma_f32 v117, v117, v37, v69
    v_fma_f32 v118, v118, v38, v70
    v_fma_f32 v119, v119, v39, v71
    v_mfma_f32_32x32x16_bf16 a[160:175], v[232:235], a[120:123], a[160:175]
    v_cvt_pk_bf16_f32 v40, v112, v113
    v_cvt_pk_bf16_f32 v41, v114, v115
    v_cvt_pk_bf16_f32 v42, v116, v117
    v_cvt_pk_bf16_f32 v43, v118, v119
    v_mfma_f32_32x32x16_bf16 a[176:191], v[236:239], a[120:123], a[176:191]
    s_waitcnt vmcnt(1)
    buffer_store_dwordx4 v[40:43], v63, s[32:35], s3 offen
    v_mfma_f32_32x32x16_bf16 a[160:175], v[240:243], a[124:127], a[160:175]
    v_mfma_f32_32x32x16_bf16 a[176:191], v[244:247], a[124:127], a[176:191]
    s_waitcnt vmcnt(1)
    v_mfma_f32_32x32x16_bf16 a[160:175], v[248:251], a[128:131], a[160:175]
    v_mfma_f32_32x32x16_bf16 a[176:191], v[252:255], a[128:131], a[176:191]
    s_nop 10
    ds_write_b128 v12, a[160:163] offset:32768
    ds_write_b128 v13, a[164:167] offset:32768
    ds_write_b128 v14, a[168:171] offset:32768
    ds_write_b128 v15, a[172:175] offset:32768
    ds_write_b128 v12, a[176:179] offset:32896
    ds_write_b128 v13, a[180:183] offset:32896
    ds_write_b128 v14, a[184:187] offset:32896
    ds_write_b128 v15, a[188:191] offset:32896
    s_waitcnt lgkmcnt(0)
    s_barrier
    ds_read_b128 v[112:115], v16 offset:32768
    ds_read_b128 v[116:119], v17 offset:32768
    ds_read_b128 v[120:123], v16 offset:40960
    ds_read_b128 v[124:127], v17 offset:40960
    ds_read_b128 v[128:131], v16 offset:49152
    ds_read_b128 v[132:135], v17 offset:49152
    ds_read_b128 v[136:139], v16 offset:57344
    ds_read_b128 v[140:143], v17 offset:57344
    s_waitcnt lgkmcnt(4)
    v_pk_add_f32 v[112:113], v[112:113], v[120:121]
    v_pk_add_f32 v[114:115], v[114:115], v[122:123]
    v_pk_add_f32 v[116:117], v[116:117], v[124:125]
    v_pk_add_f32 v[118:119], v[118:119], v[126:127]
    s_waitcnt lgkmcnt(0)
    v_pk_add_f32 v[128:129], v[128:129], v[136:137]
    v_pk_add_f32 v[130:131], v[130:131], v[138:139]
    v_pk_add_f32 v[132:133], v[132:133], v[140:141]
    v_pk_add_f32 v[134:135], v[134:135], v[142:143]
    v_pk_add_f32 v[112:113], v[112:113], v[128:129]
    v_pk_add_f32 v[114:115], v[114:115], v[130:131]
    v_pk_add_f32 v[116:117], v[116:117], v[132:133]
    v_pk_add_f32 v[118:119], v[118:119], v[134:135]
    v_pk_fma_f32 v[112:113], v[112:113], v[44:45], v[72:73]
    v_pk_fma_f32 v[114:115], v[114:115], v[46:47], v[74:75]
    v_pk_fma_f32 v[116:117], v[116:117], v[48:49], v[76:77]
    v_pk_fma_f32 v[118:119], v[118:119], v[50:51], v[78:79]
    v_cvt_pk_bf16_f32 v40, v112, v113
    v_cvt_pk_bf16_f32 v41, v114, v115
    v_cvt_pk_bf16_f32 v42, v116, v117
    v_cvt_pk_bf16_f32 v43, v118, v119
    buffer_store_dwordx4 v[40:43], v63, s[32:35], s6 offen
    s_endpgm

PR_39:
    s_sub_u32 s64, s64, 1
    s_cbranch_scc1 PC_38
    s_nop 7
    buffer_load_dwordx4 v[64:67], v25, s[36:39], s56 offen sc1
    buffer_load_dwordx4 v[68:71], v25, s[36:39], s57 offen sc1
    buffer_load_dwordx4 v[72:75], v25, s[36:39], s58 offen sc1
    buffer_load_dwordx4 v[76:79], v25, s[36:39], s59 offen sc1
    buffer_load_dwordx4 v[80:83], v52, s[36:39], s60 offen sc1
    s_waitcnt vmcnt(0)
    s_branch PP_37
PR_42:
    s_sub_u32 s64, s64, 1
    s_cbranch_scc1 PC_41
    s_nop 7
    buffer_load_dword v13, v14, s[36:39], s56 offen offset:0 sc1
    s_waitcnt vmcnt(0)
    s_branch PP_40
PR_45:
    s_sub_u32 s64, s64, 1
    s_cbranch_scc1 PC_44
    s_nop 7
    buffer_load_dword v14, v31, s[36:39], 0 offen offset:0 sc1
    s_waitcnt vmcnt(0)
    s_branch PP_43
PR_48:
    s_sub_u32 s64, s64, 1
    s_cbranch_scc1 PC_47
    s_nop 7
    s_mov_b32 exec_lo, 0xffff
    s_mov_b32 exec_hi, 0xffff
    buffer_load_dwordx4 v[160:163], v14, s[36:39], s58 offen sc1
    s_mov_b64 exec, -1
    buffer_load_dwordx4 v[128:131], v2, s[36:39], s56 offen offset:0 sc1
    buffer_load_dwordx4 v[132:135], v2, s[36:39], s56 offen offset:1024 sc1
    buffer_load_dwordx4 v[136:139], v2, s[36:39], s56 offen offset:2048 sc1
    buffer_load_dwordx4 v[140:143], v2, s[36:39], s56 offen offset:3072 sc1
    buffer_load_dwordx4 v[144:147], v2, s[36:39], s57 offen offset:0 sc1
    buffer_load_dwordx4 v[148:151], v2, s[36:39], s57 offen offset:1024 sc1
    buffer_load_dwordx4 v[152:155], v2, s[36:39], s57 offen offset:2048 sc1
    buffer_load_dwordx4 v[156:159], v2, s[36:39], s57 offen offset:3072 sc1
    s_waitcnt vmcnt(0)
    s_branch PP_46
PR_51:
    s_sub_u32 s64, s64, 1
    s_cbranch_scc1 PC_50
    s_nop 7
    buffer_load_dword v17, v5, s[36:39], s56 offen offset:1024 sc1
    s_waitcnt vmcnt(0)
    s_branch PP_49
PR_54:
    s_sub_u32 s64, s64, 1
    s_cbranch_scc1 PC_53
    s_nop 7
    buffer_load_dword v17, v4, s[36:39], s56 offen offset:1536 sc1
    s_waitcnt vmcnt(0)
    s_branch PP_52
PR_57:
    s_cmp_eq_u32 s64, 0
    s_cbranch_scc1 PC_56
    s_sub_u32 s64, s64, 1
    s_nop 7
    buffer_load_dword v27, v5, s[36:39], s22 offen offset:2048 sc1
    s_waitcnt vmcnt(0)
    s_branch PP_55
PR_60:
    s_cmp_eq_u32 s64, 0
    s_cbranch_scc1 PC_59
    s_sub_u32 s64, s64, 1
    s_nop 7
    buffer_load_dword v27, v58, s[36:39], s13 offen offset:2176 sc1
    s_waitcnt vmcnt(0)
    s_branch PP_58
PR_63:
    s_cmp_eq_u32 s64, 0
    s_cbranch_scc1 PC_62
    s_sub_u32 s64, s64, 1
    s_nop 7
    buffer_load_dword v27, v5, s[36:39], s22 offen offset:2304 sc1
    s_waitcnt vmcnt(0)
    s_branch PP_61
PR_66:
    s_cmp_eq_u32 s64, 0
    s_cbranch_scc1 PC_65
    s_sub_u32 s64, s64, 1
    s_nop 7
    buffer_load_dword v27, v5, s[36:39], s22 offen offset:2432 sc1
    s_waitcnt vmcnt(0)
    s_branch PP_64
END:
    s_endpgm

.section .rodata,"a"
.p2align 6
.amdhsa_kernel adaLN_cond__linear_kernel_hedgehog__geglu_ffn__prompt_kernel
  .amdhsa_next_free_vgpr 512
  .amdhsa_next_free_sgpr 102
  .amdhsa_accum_offset 256
  .amdhsa_group_segment_fixed_size 0
  .amdhsa_kernarg_size 104
  .amdhsa_user_sgpr_count 2
  .amdhsa_user_sgpr_kernarg_segment_ptr 1
  .amdhsa_system_sgpr_workgroup_id_x 1
.end_amdhsa_kernel
```
